```python
import torch

def _softmax(x, axis=-1):
    return torch.softmax(x, dim=axis)
def _gelu(x):
    return torch.nn.functional.gelu(x, approximate="tanh")
def _silu(x):
    return torch.nn.functional.silu(x)
def _sigmoid(x):
    return torch.sigmoid(x)
def _layernorm(x, axis=-1, eps=1e-5):
    m = x.mean(dim=axis, keepdim=True)
    v = x.var(dim=axis, keepdim=True, unbiased=False)
    return (x - m) / torch.sqrt(v + eps)
def _scatter_add(tgt, idx, src, axis=0):
    return tgt.clone().index_add_(axis, idx, src)
def _segment_sum(src, seg, n):
    out = torch.zeros((n,) + src.shape[1:], dtype=src.dtype)
    return out.index_add_(0, seg, src)
def _pad(x, pw):
    flat = tuple(v for pair in reversed(pw) for v in pair)
    return torch.nn.functional.pad(x, flat)

kernel_name = 'concat_heads__linear_kernel_hedgehog__ssm_conv_s4d__prompt'

def setup_inputs():

    _w = (lambda a: (lambda t: t.to(torch.bfloat16) if t.is_floating_point() else t)(torch.as_tensor(a)))
    def _A_setup():
        B, S, D, H = 1, 2048, 640, 32
        Dh = D // H
        return {
            "x": _w((lambda *s: torch.randn(*s, dtype=torch.bfloat16) * 0.4)(B, S, D)),
            "wqkv": _w((lambda *s: torch.randn(*s, dtype=torch.bfloat16) * 0.4)(D, 3 * D)),
            "w_phi": _w((lambda *s: torch.randn(*s, dtype=torch.bfloat16) * 0.4)(H, Dh, Dh) * (Dh ** -0.5)),
            "wo": _w((lambda *s: torch.randn(*s, dtype=torch.bfloat16) * 0.05)(D, D)),
        }
    _A_in = _A_setup()

    def _B_setup():
        Bsz, L, D, N = 1, 2048, 640, 128
        return {
            "u": _w((lambda *s: torch.randn(*s, dtype=torch.bfloat16) * 0.05)(Bsz, L, D)),
            "log_A_real": _w((lambda *s: torch.randn(*s, dtype=torch.bfloat16) * 3.2)(D, N) * 0.5),
            "A_imag": _w((lambda *s: torch.randn(*s, dtype=torch.bfloat16) * 0.2)(D, N) * 3.14),
            "C_real": _w((lambda *s: torch.randn(*s, dtype=torch.bfloat16) * 3.2)(D, N) / N ** 0.5),
            "C_imag": _w((lambda *s: torch.randn(*s, dtype=torch.bfloat16) * 3.2)(D, N) / N ** 0.5),
            "log_dt": _w((lambda *s: torch.randn(*s, dtype=torch.bfloat16) * 0.2)(D) * 0.5 - 4.0),
            "D_skip": _w((lambda *s: torch.randn(*s, dtype=torch.bfloat16) * 0.4)(D)),
        }
    _B_in = _B_setup()

    return {
        "A_x": _A_in["x"],
        "A_wqkv": _A_in["wqkv"],
        "A_w_phi": _A_in["w_phi"],
        "A_wo": _A_in["wo"],
        "B_u": _B_in["u"],
        "B_log_A_real": _B_in["log_A_real"],
        "B_A_imag": _B_in["A_imag"],
        "B_C_real": _B_in["C_real"],
        "B_C_imag": _B_in["C_imag"],
        "B_log_dt": _B_in["log_dt"],
        "B_D_skip": _B_in["D_skip"],
    }

def reference(A_x, A_wqkv, A_w_phi, A_wo, B_u, B_log_A_real, B_A_imag, B_C_real, B_C_imag, B_log_dt, B_D_skip):
    def _A_ref(x, wqkv, w_phi, wo):
        B, S, D = x.shape
        H = 32; Dh = D // H
        qkv = (lambda x, *d: x.permute(*d))((x @ wqkv).reshape(B, S, 3, H, Dh), 2, 0, 3, 1, 4)
        q, k, v = qkv[0], qkv[1], qkv[2]
        pq = torch.einsum("bhsd,hdf->bhsf", q, w_phi)
        pk = torch.einsum("bhsd,hdf->bhsf", k, w_phi)
        phi_q = torch.concatenate([_softmax(pq, axis=-1), _softmax(-pq, axis=-1)], axis=-1)
        phi_k = torch.concatenate([_softmax(pk, axis=-1), _softmax(-pk, axis=-1)], axis=-1)
        kv = torch.einsum("bhsf,bhsd->bhfd", phi_k, v)
        z  = torch.einsum("bhsf->bhf", phi_k)
        num = torch.einsum("bhqf,bhfd->bhqd", phi_q, kv)
        den = torch.einsum("bhqf,bhf->bhq", phi_q, z)[..., None] + 1e-6
        o = num / den
        return (lambda x, *d: x.permute(*d))(o, 0, 2, 1, 3).reshape(B, S, D) @ wo

    def _B_ref(u, log_A_real, A_imag, C_real, C_imag, log_dt, D_skip):
        L = u.shape[1]
        dt = torch.exp(log_dt)
        A = -torch.exp(log_A_real) + 1j * A_imag
        C = (C_real + 1j * C_imag) * dt[:, None]
        pos = (lambda x, dt: x.to(dt))(torch.arange(L), log_dt.dtype)
        P = torch.exp((A * dt[:, None])[:, :, None] * pos[None, None, :])
        K = 2.0 * torch.einsum("dn,dnl->dl", C, P).real
        L2 = 2 * L
        u_t = (lambda x, *d: x.permute(*d))(u, 0, 2, 1)
        Kf = (lambda x, *a, **k: torch.fft.rfft(x.float(), *a, **k))(K, L2)
        Uf = (lambda x, *a, **k: torch.fft.rfft(x.float(), *a, **k))(u_t, L2)
        y = (lambda x, *a, **k: torch.fft.irfft(x, *a, **k).to(torch.bfloat16))(Uf * Kf[None, :, :], L2)[:, :, :L]
        y = (lambda x, *d: x.permute(*d))(y, 0, 2, 1)
        return y + u * D_skip[None, None, :]

    a = _A_ref(A_x, A_wqkv, A_w_phi, A_wo)
    b = _B_ref(B_u, B_log_A_real, B_A_imag, B_C_real, B_C_imag, B_log_dt, B_D_skip)
    return torch.concatenate([a, b], axis=-1)
```

```asm
; @launch grid=(256,1,1) block=(256,1,1) lds=160272
.amdgcn_target "amdgcn-amd-amdhsa--gfx950"
.text
.p2align 12
.globl concat_heads__linear_kernel_hedgehog__ssm_conv_s4d__prompt_kernel
.p2align 8
.type concat_heads__linear_kernel_hedgehog__ssm_conv_s4d__prompt_kernel,@function
concat_heads__linear_kernel_hedgehog__ssm_conv_s4d__prompt_kernel:
 s_cmp_ge_u32 s2, 256
 s_cbranch_scc1 done
 s_load_dwordx16 s[8:23], s[0:1], 0
 s_load_dwordx8 s[24:31], s[0:1], 64
 s_load_dwordx4 s[32:35], s[0:1], 96
 v_lshrrev_b32 v1, 6, v0
 s_nop 0
 v_readfirstlane_b32 s68, v1
 s_cmp_ge_u32 s2, 208
 s_cbranch_scc1 roleS
 s_cmp_ge_u32 s2, 128
 s_cbranch_scc1 roleB
roleA:
 s_lshr_b32 s73, s2, 3
 s_and_b32 s69, s2, 6
 s_lshl_b32 s69, s69, 1
 s_and_b32 s70, s2, 1
 s_lshl_b32 s70, s70, 2
 s_and_b32 s4, s73, 3
 s_add_u32 s70, s70, s4
 s_lshr_b32 s73, s73, 2
 s_add_u32 s69, s69, s73
 s_add_u32 s71, s69, s70
 s_mul_i32 s71, s71, 3
 s_mul_i32 s74, s71, 205
 s_lshr_b32 s74, s74, 11
 s_mul_i32 s74, s74, 10
 s_sub_u32 s71, s71, s74
 v_and_b32 v23, 63, v0
 v_mov_b32 v22, 0
 s_lshl_b32 s76, s68, 5
 v_lshrrev_b32 v24, 3, v23
 v_add_u32_e64 v24, s76, v24
 v_mul_u32_u24 v24, 1280, v24
 v_and_b32_e64 v25, 7, v0
 v_bfe_u32 v26, v0, 4, 2
 v_xor_b32_e64 v25, v25, v26
 v_lshl_add_u32 v5, v25, 4, v24
 v_xor_b32_e64 v6, 64, v5
 v_add_u32 v6, 10240, v6
 v_add_u32 v7, 20480, v5
 v_add_u32 v8, 20480, v6
 s_movk_i32 s78, 1120
 v_add_u32 v24, 0, v23
 v_mul_u32_u24 v25, 205, v24
 v_lshrrev_b32 v25, 12, v25
 v_mul_u32_u24 v26, 20, v25
 v_sub_u32_e64 v24, v24, v26
 v_mul_u32_u24 v25, 3840, v25
 v_cmp_le_u32_e64 vcc, 10, v24
 v_lshl_add_u32 v25, v24, 4, v25
 v_add_u32 v26, s78, v25
 v_cndmask_b32 v9, v25, v26, vcc
 v_add_u32_e64 v24, 64, v23
 v_mul_u32_u24 v25, 205, v24
 v_lshrrev_b32 v25, 12, v25
 v_mul_u32_u24 v26, 20, v25
 v_sub_u32_e64 v24, v24, v26
 v_mul_u32_u24 v25, 3840, v25
 v_cmp_le_u32_e64 vcc, 10, v24
 v_lshl_add_u32 v25, v24, 4, v25
 v_add_u32 v26, s78, v25
 v_cndmask_b32 v10, v25, v26, vcc
 v_add_u32 v24, 128, v23
 v_mul_u32_u24 v25, 205, v24
 v_lshrrev_b32 v25, 12, v25
 v_mul_u32_u24 v26, 20, v25
 v_sub_u32_e64 v24, v24, v26
 v_mul_u32_u24 v25, 3840, v25
 v_cmp_le_u32_e64 vcc, 10, v24
 v_lshl_add_u32 v25, v24, 4, v25
 v_add_u32 v26, s78, v25
 v_cndmask_b32 v11, v25, v26, vcc
 v_add_u32 v24, 192, v23
 v_mul_u32_u24 v25, 205, v24
 v_lshrrev_b32 v25, 12, v25
 v_mul_u32_u24 v26, 20, v25
 v_sub_u32_e64 v24, v24, v26
 v_mul_u32_u24 v25, 3840, v25
 v_cmp_le_u32_e64 vcc, 10, v24
 v_lshl_add_u32 v25, v24, 4, v25
 v_add_u32 v26, s78, v25
 v_cndmask_b32 v12, v25, v26, vcc
 v_add_u32 v24, 256, v23
 v_mul_u32_u24 v25, 205, v24
 v_lshrrev_b32 v25, 12, v25
 v_mul_u32_u24 v26, 20, v25
 v_sub_u32_e64 v24, v24, v26
 v_mul_u32_u24 v25, 3840, v25
 v_cmp_le_u32_e64 vcc, 10, v24
 v_lshl_add_u32 v25, v24, 4, v25
 v_add_u32 v26, s78, v25
 v_cndmask_b32_e64 v13, v25, v26, vcc
 s_mov_b32 s80, s71
 s_mul_i32 s75, s70, 160
 s_mul_i32 s82, s68, 61440
 s_add_u32 s82, s82, s75
 s_add_u32 s82, s82, 1280
 s_lshl_b32 s83, s70, 7
 s_mul_i32 s84, s68, 5120
 s_lshl_b32 s87, s68, 14
 s_add_u32 s87, s87, 81920
 s_mul_i32 s78, s69, 163840
 s_waitcnt lgkmcnt(0)
 s_add_u32 s40, s8, s78
 s_addc_u32 s41, s9, 0
 s_mov_b32 s42, 163840
 s_mov_b32 s43, 0x20000
 s_mov_b32 s44, s10
 s_mov_b32 s45, s11
 s_mov_b32 s46, 2457600
 s_mov_b32 s47, 0x20000
 s_mul_i32 s86, s80, 245760
 s_add_u32 s86, s86, s82
 s_lshl_b32 s81, s80, 7
 s_add_u32 s80, s80, 1
 s_cmp_eq_u32 s80, 10
 s_cselect_b32 s80, 0, s80
 s_add_u32 m0, s84, 0
 s_nop 0
 buffer_load_dwordx4 v9, s[44:47], s86 offen  lds
 s_add_u32 m0, s87, 0
 s_nop 0
 buffer_load_dwordx4 v5, s[40:43], s81 offen  lds
 s_add_u32 m0, s84, 1024
 s_nop 0
 buffer_load_dwordx4 v10, s[44:47], s86 offen  lds
 s_add_u32 m0, s87, 1024
 s_nop 0
 buffer_load_dwordx4 v6, s[40:43], s81 offen  lds
 s_add_u32 m0, s84, 2048
 s_nop 0
 buffer_load_dwordx4 v11, s[44:47], s86 offen  lds
 s_add_u32 m0, s87, 2048
 s_nop 0
 buffer_load_dwordx4 v7, s[40:43], s81 offen  lds
 s_add_u32 m0, s84, 3072
 s_nop 0
 buffer_load_dwordx4 v12, s[44:47], s86 offen  lds
 s_add_u32 m0, s87, 3072
 v_bfe_u32 v24, v0, 5, 1
 v_mul_u32_u24 v24, 2560, v24
 v_bfe_u32 v25, v0, 2, 2
 v_mul_u32_u24 v25, 320, v25
 v_bfe_u32 v26, v0, 4, 1
 v_lshl_add_u32 v24, v26, 5, v24
 v_and_b32_e64 v26, 3, v0
 v_lshl_add_u32 v24, v26, 3, v24
 v_add_u32_e64 v14, v24, v25
 v_add_u32 v15, 40960, v14
 v_and_b32_e64 v24, 31, v0
 v_bfe_u32 v25, v0, 1, 3
 v_bfe_u32 v26, v0, 5, 1
 v_xor_b32 v25, v25, v26
 v_lshlrev_b32 v25, 4, v25
 v_lshl_add_u32 v24, v24, 7, v25
 v_add_u32 v1, s87, v24
 v_xor_b32 v2, 32, v1
 v_xor_b32_e64 v3, 64, v1
 v_xor_b32 v4, 96, v1
 v_mov_b32 v244, 0
 v_mov_b32 v245, 0
 v_mov_b32 v246, 0
 v_mov_b32 v247, 0
 v_lshlrev_b32_e64 v24, 4, v0
 v_add_u32 v24, 147456, v24
 v_min_u32 v25, 147952, v24
 ds_write_b128 v24, v[244:247]
 ds_write_b128 v24, v[244:247] offset:4096
 ds_write_b128 v24, v[244:247] offset:8192
 buffer_load_dwordx4 v8, s[40:43], s81 offen  lds
 s_add_u32 m0, s84, 4096
 ds_write_b128 v25, v[244:247] offset:12288
 s_mov_b32 s88, 0x3fb8aa3b
 s_mov_b32 s89, 0x3fb8aa3b
 v_add_u32_e64 v24, 0, v0
 v_mul_u32_u24 v25, 205, v24
 v_lshrrev_b32 v25, 10, v25
 v_mul_u32_u24 v26, 41, v24
 v_lshrrev_b32_e64 v26, 12, v26
 v_mul_u32_u24 v25, 120, v25
 v_mad_u32_u24 v25, v26, 40, v25
 v_lshl_add_u32 v25, v24, 3, v25
 v_add_u32 v248, 147456, v25
 v_add_u32 v24, 256, v0
 v_mul_u32_u24 v25, 205, v24
 v_lshrrev_b32 v25, 10, v25
 v_mul_u32_u24 v26, 41, v24
 v_lshrrev_b32_e64 v26, 12, v26
 v_mul_u32_u24 v25, 120, v25
 v_mad_u32_u24 v25, v26, 40, v25
 v_lshl_add_u32 v25, v24, 3, v25
 v_add_u32 v249, 147456, v25
 v_mov_b32 v25, 160256
 v_cmp_gt_u32 vcc, 400, v24
 s_nop 1
 v_cndmask_b32 v249, v25, v249, vcc
 s_mov_b32 s60, s32
 s_mov_b32 s61, s33
 s_mov_b32 s62, 256
 s_mov_b32 s63, 0x20000
 v_add_u32_e64 v24, 0, v23
 v_mul_u32_u24 v25, 205, v24
 buffer_load_dwordx4 v13, s[44:47], s86 offen  lds
 v_lshrrev_b32 v25, 11, v25
 v_mul_u32_u24 v26, 10, v25
 v_sub_u32 v24, v24, v26
 v_and_b32 v26, 24, v25
 v_and_b32_e64 v27, 1, v25
 v_lshl_add_u32 v26, v27, 2, v26
 v_bfe_u32 v27, v25, 1, 2
 v_add_u32_e64 v26, v26, v27
 v_mul_u32_u24 v26, 3840, v26
 v_lshl_add_u32 v21, v24, 4, v26
 v_add_u32_e64 v24, 64, v23
 v_mul_u32_u24 v25, 205, v24
 v_lshrrev_b32 v25, 11, v25
 v_mul_u32_u24 v26, 10, v25
 v_sub_u32 v24, v24, v26
 v_and_b32 v26, 24, v25
 v_and_b32_e64 v27, 1, v25
 v_lshl_add_u32 v26, v27, 2, v26
 v_bfe_u32 v27, v25, 1, 2
 v_add_u32_e64 v26, v26, v27
 v_mul_u32_u24 v26, 3840, v26
 v_lshl_add_u32 v29, v24, 4, v26
 v_add_u32 v24, 128, v23
 v_mul_u32_u24 v25, 205, v24
 v_lshrrev_b32 v25, 11, v25
 v_mul_u32_u24 v26, 10, v25
 v_sub_u32 v24, v24, v26
 v_and_b32 v26, 24, v25
 v_and_b32_e64 v27, 1, v25
 v_lshl_add_u32 v26, v27, 2, v26
 s_mul_i32 s77, s70, 3200
 s_add_u32 s64, s12, s77
 s_addc_u32 s65, s13, 0
 s_mov_b32 s66, 3200
 s_mov_b32 s67, 0x20000
 v_lshlrev_b32_e64 v250, 3, v0
 buffer_load_dwordx2 v[240:241], v250, s[64:67], 0 offen
 buffer_load_dwordx2 v[242:243], v250, s[64:67], 0 offen offset:2048
 v_bfe_u32 v27, v25, 1, 2
 v_add_u32_e64 v26, v26, v27
 v_mul_u32_u24 v26, 3840, v26
 v_lshl_add_u32 v30, v24, 4, v26
 v_add_u32 v24, 192, v23
 v_mul_u32_u24 v25, 205, v24
 v_lshrrev_b32 v25, 11, v25
 v_mul_u32_u24 v26, 10, v25
 v_sub_u32 v24, v24, v26
 v_and_b32 v26, 24, v25
 v_and_b32_e64 v27, 1, v25
 v_lshl_add_u32 v26, v27, 2, v26
 v_bfe_u32 v27, v25, 1, 2
 v_add_u32_e64 v26, v26, v27
 v_mul_u32_u24 v26, 3840, v26
 v_lshl_add_u32 v31, v24, 4, v26
 v_add_u32 v24, 256, v23
 v_mul_u32_u24 v25, 205, v24
 v_lshrrev_b32 v25, 11, v25
 v_mul_u32_u24 v26, 10, v25
 v_sub_u32 v24, v24, v26
 v_and_b32 v26, 24, v25
 v_and_b32_e64 v27, 1, v25
 v_lshl_add_u32 v26, v27, 2, v26
 v_bfe_u32 v27, v25, 1, 2
 v_add_u32_e64 v26, v26, v27
 v_mul_u32_u24 v26, 3840, v26
 v_lshl_add_u32 v252, v24, 4, v26
 v_bfe_u32 v24, v0, 5, 1
 v_bfe_u32 v25, v0, 2, 2
 v_lshl_add_u32 v24, v24, 2, v25
 v_mul_u32_u24 v24, 160, v24
 v_and_b32_e64 v25, 1, v0
 v_mad_u32_u24 v24, v25, 40, v24
 v_bfe_u32 v25, v0, 4, 1
 v_bfe_u32 v26, v0, 1, 1
 v_lshl_add_u32 v25, v25, 1, v26
 v_lshl_add_u32 v24, v25, 3, v24
 v_add_u32 v18, 147456, v24
 v_cmp_eq_u32 vcc, 0, v25
 v_add_u32 v19, 32, v18
 v_add_u32 v26, 72, v18
 v_cndmask_b32 v19, v26, v19, vcc
 v_cmp_gt_u32 vcc, 2, v25
 v_add_u32 v20, 104, v18
 s_nop 0
 v_cndmask_b32 v20, v18, v20, vcc
 v_bfe_u32 v24, v0, 5, 1
 v_mul_u32_u24 v24, 1280, v24
 v_bfe_u32 v25, v0, 2, 2
 v_mul_u32_u24 v25, 320, v25
 v_bfe_u32 v26, v0, 4, 1
 v_lshl_add_u32 v24, v26, 5, v24
 v_and_b32_e64 v26, 3, v0
 v_lshl_add_u32 v24, v26, 3, v24
 v_add_u32_e64 v27, v24, v25
 v_accvgpr_write_b32 a204, v27
 v_and_b32 v24, 31, v0
 v_add_u32 v24, s76, v24
 v_bfe_u32 v25, v0, 5, 1
 v_mul_u32_u24 v26, 352, v24
 v_add_u32 v26, 81920, v26
 v_bfe_u32 v27, v0, 2, 1
 v_mul_u32_u24 v28, 5, v25
 v_xor_b32 v192, v28, v27
 v_lshl_add_u32 v192, v192, 4, v26
 v_add_u32 v28, 1, v28
 v_xor_b32 v193, v28, v27
 v_lshl_add_u32 v193, v193, 4, v26
 v_mul_u32_u24 v24, 160, v24
 v_add_u32 v24, 126976, v24
 v_bfe_u32 v27, v0, 2, 2
 v_xor_b32_e64 v27, v27, v25
 v_lshl_add_u32 v194, v27, 3, v24
 v_xor_b32_e64 v27, 2, v27
 v_lshl_add_u32 v195, v27, 3, v24
 v_accvgpr_write_b32 a205, v192
 v_accvgpr_write_b32 a206, v193
 v_accvgpr_write_b32 a207, v194
 v_accvgpr_write_b32 a208, v195
 v_bfe_u32 v24, v0, 2, 4
 v_bfe_u32 v25, v0, 4, 2
 s_mul_i32 s78, s68, 5
 v_bfe_u32 v26, v0, 1, 1
 v_add_u32 v26, s78, v26
 v_and_b32 v27, 1, v25
 v_xor_b32 v26, v26, v27
 v_and_b32 v27, 1, v0
 v_lshlrev_b32 v27, 3, v27
 v_lshl_add_u32 v26, v26, 4, v27
 v_mul_u32_u24 v27, 352, v24
 v_add_u32_e64 v26, v26, v27
 v_add_u32 v192, 81920, v26
 v_mul_u32_u24 v24, 160, v24
 v_add_u32 v24, 126976, v24
 v_and_b32 v26, 3, v0
 v_add_u32 v26, s78, v26
 v_xor_b32_e64 v26, v26, v25
 v_lshl_add_u32 v193, v26, 3, v24
 s_add_u32 s78, s78, 4
 v_xor_b32 v26, s78, v25
 v_lshl_add_u32 v194, v26, 3, v24
 v_accvgpr_write_b32 a209, v192
 v_accvgpr_write_b32 a210, v193
 v_accvgpr_write_b32 a211, v194
 v_and_b32_e64 v27, 15, v0
 v_bfe_u32 v28, v0, 4, 2
 v_cmp_gt_u32 s[90:91], 8, v27
 v_lshlrev_b32_e64 v24, 2, v27
 v_mul_u32_u24 v25, 768, v28
 v_add_u32_e64 v192, v24, v25
 v_add_u32 v25, 160, v192
 v_cndmask_b32 v193, v25, v192, s[90:91]
 v_mul_u32_u24 v25, 192, v28
 v_add_u32 v25, 3072, v25
 v_add_u32_e64 v194, v25, v24
 v_mov_b32 v26, 0x80000000
 v_cmp_gt_u32_e64 vcc, 40, v23
 v_cndmask_b32 v195, v26, v194, s[90:91]
 v_lshlrev_b32_e64 v25, 2, v23
 v_add_u32 v25, 3840, v25
 v_cndmask_b32 v196, v26, v25, vcc
 v_cmp_eq_u32 vcc, 0, v23
 v_cmp_gt_u32 s[90:91], 4, v27
 s_nop 0
 v_cndmask_b32 v198, v26, v22, vcc
 v_accvgpr_write_b32 a212, v192
 v_accvgpr_write_b32 a213, v193
 v_accvgpr_write_b32 a214, v194
 v_accvgpr_write_b32 a215, v195
 v_accvgpr_write_b32 a216, v196
 v_accvgpr_write_b32 a217, v198
 s_mul_i32 s85, s68, 1920
 s_add_u32 s85, s85, 81920
 v_mov_b32 v28, 91520
 v_add_u32_e64 v24, 0, v23
 v_mul_u32_u24 v25, 171, v24
 v_lshrrev_b32 v25, 11, v25
 v_mul_u32_u24 v26, 12, v25
 v_sub_u32 v26, v24, v26
 v_cmp_gt_u32 vcc, 10, v26
 v_mul_u32_u24 v25, 80, v25
 v_lshl_add_u32 v25, v26, 3, v25
 v_add_u32 v25, s85, v25
 v_cndmask_b32 v25, v28, v25, vcc
 v_accvgpr_write_b32 a218, v25
 v_add_u32_e64 v24, 64, v23
 v_mul_u32_u24 v25, 171, v24
 v_lshrrev_b32 v25, 11, v25
 v_mul_u32_u24 v26, 12, v25
 v_sub_u32 v26, v24, v26
 v_cmp_gt_u32 vcc, 10, v26
 v_mul_u32_u24 v25, 80, v25
 v_lshl_add_u32 v25, v26, 3, v25
 v_add_u32 v25, s85, v25
 v_cndmask_b32 v25, v28, v25, vcc
 v_accvgpr_write_b32 a219, v25
 v_add_u32 v24, 128, v23
 v_mul_u32_u24 v25, 171, v24
 v_lshrrev_b32 v25, 11, v25
 v_mul_u32_u24 v26, 12, v25
 v_sub_u32 v26, v24, v26
 v_cmp_gt_u32 vcc, 10, v26
 v_mul_u32_u24 v25, 80, v25
 v_lshl_add_u32 v25, v26, 3, v25
 v_add_u32 v25, s85, v25
 v_cndmask_b32 v25, v28, v25, vcc
 v_accvgpr_write_b32 a220, v25
 v_add_u32 v24, 192, v23
 v_mul_u32_u24 v25, 171, v24
 v_lshrrev_b32 v25, 11, v25
 v_mul_u32_u24 v26, 12, v25
 v_sub_u32 v26, v24, v26
 v_cmp_gt_u32 vcc, 10, v26
 v_mul_u32_u24 v25, 80, v25
 v_lshl_add_u32 v25, v26, 3, v25
 v_add_u32 v25, s85, v25
 v_cndmask_b32 v25, v28, v25, vcc
 v_cmp_gt_u32 vcc, 60, v23
 s_nop 1
 v_cndmask_b32_e64 v25, v28, v25, vcc
 v_accvgpr_write_b32 a221, v25
 v_cmp_gt_u32 vcc, 120, v0
 v_lshlrev_b32_e64 v24, 4, v0
 v_add_u32 v24, 89600, v24
 v_cndmask_b32_e64 v24, v28, v24, vcc
 v_accvgpr_write_b32 a222, v24
 v_bfe_u32 v24, v0, 3, 2
 v_and_b32_e64 v25, 3, v0
 v_lshl_add_u32 v24, v24, 2, v25
 v_mul_u32_u24 v24, 80, v24
 v_bfe_u32 v25, v0, 2, 1
 v_bfe_u32 v28, v0, 5, 1
 v_cmp_eq_u32_e64 vcc, v25, v28
 v_mul_u32_u24 v26, 1920, v25
 v_add_u32_e64 v24, v24, v26
 v_add_u32 v24, 81920, v24
 v_add_u32 v27, 3840, v24
 v_mov_b32 v26, 89600
 v_cndmask_b32 v24, v26, v24, vcc
 v_cndmask_b32 v27, v26, v27, vcc
 v_accvgpr_write_b32 a223, v24
 v_accvgpr_write_b32 a224, v27
 s_mov_b32 s48, s14
 s_mov_b32 s49, s15
 s_mov_b32 s50, 819200
 s_mov_b32 s51, 0x20000
 s_mov_b32 s52, s34
 s_mov_b32 s53, s35
 s_mov_b32 s54, 13631488
 s_mov_b32 s55, 0x20000
 s_mul_i32 s78, s69, 327680
 s_add_u32 s78, s78, s83
 s_add_u32 s56, s30, s78
 s_addc_u32 s57, s31, 0
 s_mov_b32 s58, 0
 s_mov_b32 s59, 0x20000
 s_sub_u32 s58, 5242880, s78
 s_lshr_b32 s100, s83, 7
 s_and_b32 s79, s100, 3
 s_cmp_ge_u32 s100, 8
 s_cselect_b32 s100, 4, s79
 s_mul_i32 s100, s100, 0
 s_lshr_b32 s100, s100, 3
 s_lshr_b32 s79, s68, 1
 s_add_u32 s79, s79, s100
 s_and_b32 s85, s68, 1
 s_mul_i32 s85, s85, 40
 s_lshl_b32 s78, s69, 2
 s_add_u32 s78, s78, s68
 s_mul_i32 s78, s78, 40960
 s_add_u32 s92, s78, 393216
 v_lshrrev_b32 v24, 3, v23
 v_add_u32 v24, s85, v24
 v_add_u32 v24, 0, v24
 v_lshrrev_b32 v25, 4, v24
 v_and_b32_e64 v26, 7, v24
 v_lshl_add_u32 v25, v25, 3, v26
 v_bfe_u32 v26, v24, 3, 1
 v_mad_u32_u24 v26, v26, 20, v25
 v_add_u32 v27, 20, v26
 v_cmp_le_u32 vcc, 20, v25
 s_nop 1
 v_cndmask_b32 v26, v26, v27, vcc
 v_mul_u32_u24 v26, 1280, v26
 v_bfe_u32 v24, v24, 1, 1
 v_lshlrev_b32 v24, 2, v24
 v_and_b32 v25, 7, v0
 v_xor_b32_e64 v24, v24, v25
 v_lshl_add_u32 v24, v24, 4, v26
 v_accvgpr_write_b32 a225, v24
 v_lshrrev_b32 v24, 3, v23
 v_add_u32 v24, s85, v24
 v_add_u32 v24, 8, v24
 v_lshrrev_b32 v25, 4, v24
 v_and_b32_e64 v26, 7, v24
 v_lshl_add_u32 v25, v25, 3, v26
 v_bfe_u32 v26, v24, 3, 1
 v_mad_u32_u24 v26, v26, 20, v25
 v_add_u32 v27, 20, v26
 v_cmp_le_u32 vcc, 20, v25
 s_branch pg0_skip
.p2align 12
pg0:
 s_setpc_b64 s[4:5]
 s_nop 0
pg0_skip:
 s_nop 1
 v_cndmask_b32 v26, v26, v27, vcc
 v_mul_u32_u24 v26, 1280, v26
 v_bfe_u32 v24, v24, 1, 1
 v_lshlrev_b32 v24, 2, v24
 v_and_b32 v25, 7, v0
 v_xor_b32_e64 v24, v24, v25
 v_lshl_add_u32 v24, v24, 4, v26
 v_accvgpr_write_b32 a226, v24
 v_lshrrev_b32 v24, 3, v23
 v_add_u32 v24, s85, v24
 v_add_u32 v24, 16, v24
 v_lshrrev_b32 v25, 4, v24
 v_and_b32_e64 v26, 7, v24
 v_lshl_add_u32 v25, v25, 3, v26
 v_bfe_u32 v26, v24, 3, 1
 v_mad_u32_u24 v26, v26, 20, v25
 v_add_u32 v27, 20, v26
 v_cmp_le_u32 vcc, 20, v25
 s_nop 1
 v_cndmask_b32 v26, v26, v27, vcc
 v_mul_u32_u24 v26, 1280, v26
 v_bfe_u32 v24, v24, 1, 1
 v_lshlrev_b32 v24, 2, v24
 v_and_b32 v25, 7, v0
 v_xor_b32_e64 v24, v24, v25
 v_lshl_add_u32 v24, v24, 4, v26
 v_accvgpr_write_b32 a227, v24
 v_lshrrev_b32 v24, 3, v23
 v_add_u32 v24, s85, v24
 v_add_u32 v24, 24, v24
 v_lshrrev_b32 v25, 4, v24
 v_and_b32_e64 v26, 7, v24
 v_lshl_add_u32 v25, v25, 3, v26
 v_bfe_u32 v26, v24, 3, 1
 v_mad_u32_u24 v26, v26, 20, v25
 v_add_u32 v27, 20, v26
 v_cmp_le_u32 vcc, 20, v25
 s_nop 1
 v_cndmask_b32 v26, v26, v27, vcc
 v_mul_u32_u24 v26, 1280, v26
 v_bfe_u32 v24, v24, 1, 1
 v_lshlrev_b32 v24, 2, v24
 v_and_b32 v25, 7, v0
 v_xor_b32_e64 v24, v24, v25
 v_lshl_add_u32 v24, v24, 4, v26
 v_accvgpr_write_b32 a228, v24
 v_lshrrev_b32 v24, 3, v23
 v_add_u32 v24, s85, v24
 v_add_u32 v24, 32, v24
 v_lshrrev_b32 v25, 4, v24
 v_and_b32_e64 v26, 7, v24
 v_lshl_add_u32 v25, v25, 3, v26
 v_bfe_u32 v26, v24, 3, 1
 v_mad_u32_u24 v26, v26, 20, v25
 v_add_u32 v27, 20, v26
 v_cmp_le_u32 vcc, 20, v25
 s_nop 1
 v_cndmask_b32 v26, v26, v27, vcc
 v_mul_u32_u24 v26, 1280, v26
 v_bfe_u32 v24, v24, 1, 1
 v_lshlrev_b32 v24, 2, v24
 v_and_b32 v25, 7, v0
 v_xor_b32_e64 v24, v24, v25
 v_lshl_add_u32 v24, v24, 4, v26
 v_accvgpr_write_b32 a229, v24
 v_bfe_u32 v24, v0, 5, 1
 v_mul_u32_u24 v24, 1024, v24
 v_bfe_u32 v25, v0, 2, 2
 v_mul_u32_u24 v25, 128, v25
 v_bfe_u32 v26, v0, 4, 1
 v_lshl_add_u32 v24, v26, 5, v24
 v_and_b32_e64 v26, 3, v0
 v_lshl_add_u32 v24, v26, 3, v24
 v_add_u32_e64 v27, v24, v25
 v_bfe_u32 v24, v0, 3, 1
 v_lshl_add_u32 v27, v24, 6, v27
 v_accvgpr_write_b32 a230, v27
 s_add_u32 s78, s84, 126976
 v_and_b32_e64 v24, 31, v0
 v_mul_u32_u24 v24, 144, v24
 v_bfe_u32 v25, v0, 5, 1
 v_lshl_add_u32 v24, v25, 3, v24
 v_add_u32_e64 v24, s78, v24
 v_accvgpr_write_b32 a231, v24
 v_lshrrev_b32 v24, 3, v23
 v_and_b32 v25, 7, v0
 v_lshlrev_b32_e64 v25, 4, v25
 v_mul_u32_u24 v26, 144, v24
 v_add3_u32 v26, v26, v25, s78
 v_mul_u32_u24 v24, 2560, v24
 v_add_u32_e64 v24, v24, v25
 v_accvgpr_write_b32 a232, v26
 v_accvgpr_write_b32 a233, v24
 s_mov_b32 s4, 385024
 buffer_load_dword v253, v22, s[52:55], s4 offen sc1
 s_cmp_lg_u32 s68, 0
 s_cbranch_scc1 a_t0
 s_call_b64 s[4:5], pg0
 s_call_b64 s[4:5], pg4
a_t0:
 s_cmp_lg_u32 s68, 1
 s_cbranch_scc1 a_t1
 s_call_b64 s[4:5], pg1
 s_call_b64 s[4:5], pg5
a_t1:
 s_cmp_lg_u32 s68, 2
 s_cbranch_scc1 a_t2
 s_call_b64 s[4:5], pg2
a_t2:
 s_cmp_lg_u32 s68, 3
 s_cbranch_scc1 a_t3
 s_call_b64 s[4:5], pg3
a_t3:
 s_mul_i32 s86, s80, 245760
 s_add_u32 s86, s86, s82
 s_lshl_b32 s81, s80, 7
 s_add_u32 s80, s80, 1
 s_cmp_eq_u32 s80, 10
 s_cselect_b32 s80, 0, s80
 s_add_u32 m0, s84, 20480
 s_nop 0
 buffer_load_dwordx4 v9, s[44:47], s86 offen  lds
 s_add_u32 m0, s87, 4096
 s_nop 0
 buffer_load_dwordx4 v5, s[40:43], s81 offen  lds
 s_add_u32 m0, s84, 21504
 s_nop 0
 buffer_load_dwordx4 v10, s[44:47], s86 offen  lds
 s_add_u32 m0, s87, 5120
 s_nop 0
 buffer_load_dwordx4 v6, s[40:43], s81 offen  lds
 s_add_u32 m0, s84, 22528
 s_nop 0
 buffer_load_dwordx4 v11, s[44:47], s86 offen  lds
 s_add_u32 m0, s87, 6144
 s_nop 0
 buffer_load_dwordx4 v7, s[40:43], s81 offen  lds
 s_add_u32 m0, s84, 23552
 s_nop 0
 buffer_load_dwordx4 v12, s[44:47], s86 offen  lds
 s_add_u32 m0, s87, 7168
 s_nop 0
 buffer_load_dwordx4 v8, s[40:43], s81 offen  lds
 s_add_u32 m0, s84, 24576
 s_nop 0
 buffer_load_dwordx4 v13, s[44:47], s86 offen  lds
 s_waitcnt lgkmcnt(0)
 s_waitcnt vmcnt(12)
 s_barrier
 ds_read_b128 a[0:3], v1 offset:0
 ds_read_b64_tr_b16 v[32:33], v14 offset:0
 ds_read_b64_tr_b16 v[34:35], v14 offset:1280
 ds_read_b64_tr_b16 v[36:37], v14 offset:64
 ds_read_b64_tr_b16 v[38:39], v14 offset:1344
 ds_read_b64_tr_b16 v[40:41], v14 offset:128
 ds_read_b64_tr_b16 v[42:43], v14 offset:1408
 ds_read_b64_tr_b16 v[44:45], v14 offset:192
 ds_read_b64_tr_b16 v[46:47], v14 offset:1472
 ds_read_b64_tr_b16 v[48:49], v14 offset:256
 ds_read_b64_tr_b16 v[50:51], v14 offset:1536
 ds_read_b128 a[4:7], v2 offset:0
 ds_read_b64_tr_b16 v[52:53], v14 offset:5120
 ds_read_b64_tr_b16 v[54:55], v14 offset:6400
 ds_read_b64_tr_b16 v[56:57], v14 offset:5184
 ds_read_b64_tr_b16 v[58:59], v14 offset:6464
 ds_read_b64_tr_b16 v[60:61], v14 offset:5248
 ds_read_b64_tr_b16 v[62:63], v14 offset:6528
 ds_read_b64_tr_b16 v[64:65], v14 offset:5312
 ds_read_b64_tr_b16 v[66:67], v14 offset:6592
 ds_read_b64_tr_b16 v[68:69], v14 offset:5376
 ds_read_b64_tr_b16 v[70:71], v14 offset:6656
 s_waitcnt lgkmcnt(11)
 v_mfma_f32_32x32x16_bf16 v[112:127], v[32:35], a[0:3], 0
 ds_read_b128 a[8:11], v3 offset:0
 ds_read_b64_tr_b16 v[72:73], v14 offset:10240
 s_mul_i32 s86, s80, 245760
 s_add_u32 s86, s86, s82
 s_lshl_b32 s81, s80, 7
 s_add_u32 s80, s80, 1
 s_cmp_eq_u32 s80, 10
 s_cselect_b32 s80, 0, s80
 s_add_u32 m0, s84, 40960
 v_mfma_f32_32x32x16_bf16 v[128:143], v[36:39], a[0:3], 0
 ds_read_b64_tr_b16 v[74:75], v14 offset:11520
 ds_read_b64_tr_b16 v[76:77], v14 offset:10304
 buffer_load_dwordx4 v9, s[44:47], s86 offen  lds
 s_add_u32 m0, s87, 8192
 v_mfma_f32_32x32x16_bf16 v[144:159], v[40:43], a[0:3], 0
 ds_read_b64_tr_b16 v[78:79], v14 offset:11584
 ds_read_b64_tr_b16 v[80:81], v14 offset:10368
 ds_read_b64_tr_b16 v[82:83], v14 offset:11648
 v_mfma_f32_32x32x16_bf16 v[160:175], v[44:47], a[0:3], 0
 ds_read_b64_tr_b16 v[84:85], v14 offset:10432
 ds_read_b64_tr_b16 v[86:87], v14 offset:11712
 buffer_load_dwordx4 v5, s[40:43], s81 offen  lds
 s_add_u32 m0, s84, 41984
 v_mfma_f32_32x32x16_bf16 v[176:191], v[48:51], a[0:3], 0
 ds_read_b64_tr_b16 v[88:89], v14 offset:10496
 ds_read_b64_tr_b16 v[90:91], v14 offset:11776
 buffer_load_dwordx4 v10, s[44:47], s86 offen  lds
 s_add_u32 m0, s87, 9216
 s_waitcnt lgkmcnt(11)
 v_mfma_f32_32x32x16_bf16 v[112:127], v[52:55], a[4:7], v[112:127]
 buffer_load_dwordx4 v6, s[40:43], s81 offen  lds
 s_add_u32 m0, s84, 43008
 ds_read_b128 a[12:15], v4 offset:0
 v_mfma_f32_32x32x16_bf16 v[128:143], v[56:59], a[4:7], v[128:143]
 buffer_load_dwordx4 v11, s[44:47], s86 offen  lds
 s_add_u32 m0, s87, 10240
 ds_read_b64_tr_b16 v[32:33], v14 offset:15360
 ds_read_b64_tr_b16 v[34:35], v14 offset:16640
 v_mfma_f32_32x32x16_bf16 v[144:159], v[60:63], a[4:7], v[144:159]
 buffer_load_dwordx4 v7, s[40:43], s81 offen  lds
 s_add_u32 m0, s84, 44032
 ds_read_b64_tr_b16 v[36:37], v14 offset:15424
 ds_read_b64_tr_b16 v[38:39], v14 offset:16704
 v_mfma_f32_32x32x16_bf16 v[160:175], v[64:67], a[4:7], v[160:175]
 ds_read_b64_tr_b16 v[40:41], v14 offset:15488
 buffer_load_dwordx4 v12, s[44:47], s86 offen  lds
 s_add_u32 m0, s87, 11264
 ds_read_b64_tr_b16 v[42:43], v14 offset:16768
 v_mfma_f32_32x32x16_bf16 v[176:191], v[68:71], a[4:7], v[176:191]
 ds_read_b64_tr_b16 v[44:45], v14 offset:15552
 buffer_load_dwordx4 v8, s[40:43], s81 offen  lds
 s_add_u32 m0, s84, 45056
 ds_read_b64_tr_b16 v[46:47], v14 offset:16832
 ds_read_b64_tr_b16 v[48:49], v14 offset:15616
 buffer_load_dwordx4 v13, s[44:47], s86 offen  lds
 ds_read_b64_tr_b16 v[50:51], v14 offset:16896
 s_waitcnt vmcnt(9)
 s_barrier
 s_waitcnt lgkmcnt(11)
 v_mfma_f32_32x32x16_bf16 v[112:127], v[72:75], a[8:11], v[112:127]
 ds_read_b128 a[16:19], v1 offset:4096
 ds_read_b64_tr_b16 v[52:53], v14 offset:20480
 v_mfma_f32_32x32x16_bf16 v[128:143], v[76:79], a[8:11], v[128:143]
 ds_read_b64_tr_b16 v[54:55], v14 offset:21760
 ds_read_b64_tr_b16 v[56:57], v14 offset:20544
 s_mul_i32 s86, s80, 245760
 s_add_u32 s86, s86, s82
 s_lshl_b32 s81, s80, 7
 s_add_u32 s80, s80, 1
 s_cmp_eq_u32 s80, 10
 s_cselect_b32 s80, 0, s80
 s_add_u32 m0, s84, 61440
 v_mfma_f32_32x32x16_bf16 v[144:159], v[80:83], a[8:11], v[144:159]
 ds_read_b64_tr_b16 v[58:59], v14 offset:21824
 ds_read_b64_tr_b16 v[60:61], v14 offset:20608
 ds_read_b64_tr_b16 v[62:63], v14 offset:21888
 v_mfma_f32_32x32x16_bf16 v[160:175], v[84:87], a[8:11], v[160:175]
 ds_read_b64_tr_b16 v[64:65], v14 offset:20672
 ds_read_b64_tr_b16 v[66:67], v14 offset:21952
 buffer_load_dwordx4 v9, s[44:47], s86 offen  lds
 s_add_u32 m0, s87, 12288
 v_mfma_f32_32x32x16_bf16 v[176:191], v[88:91], a[8:11], v[176:191]
 ds_read_b64_tr_b16 v[68:69], v14 offset:20736
 ds_read_b64_tr_b16 v[70:71], v14 offset:22016
 s_waitcnt lgkmcnt(11)
 v_mfma_f32_32x32x16_bf16 v[112:127], v[32:35], a[12:15], v[112:127]
 ds_read_b128 a[20:23], v2 offset:4096
 ds_read_b64_tr_b16 v[72:73], v14 offset:25600
 v_mfma_f32_32x32x16_bf16 v[128:143], v[36:39], a[12:15], v[128:143]
 ds_read_b64_tr_b16 v[74:75], v14 offset:26880
 ds_read_b64_tr_b16 v[76:77], v14 offset:25664
 v_mfma_f32_32x32x16_bf16 v[144:159], v[40:43], a[12:15], v[144:159]
 ds_read_b64_tr_b16 v[78:79], v14 offset:26944
 ds_read_b64_tr_b16 v[80:81], v14 offset:25728
 ds_read_b64_tr_b16 v[82:83], v14 offset:27008
 v_mfma_f32_32x32x16_bf16 v[160:175], v[44:47], a[12:15], v[160:175]
 ds_read_b64_tr_b16 v[84:85], v14 offset:25792
 ds_read_b64_tr_b16 v[86:87], v14 offset:27072
 v_mfma_f32_32x32x16_bf16 v[176:191], v[48:51], a[12:15], v[176:191]
 ds_read_b64_tr_b16 v[88:89], v14 offset:25856
 ds_read_b64_tr_b16 v[90:91], v14 offset:27136
 s_waitcnt lgkmcnt(11)
 v_mfma_f32_32x32x16_bf16 v[112:127], v[52:55], a[16:19], v[112:127]
 ds_write_b64 v248, v[240:241]
 v_mfma_f32_32x32x16_bf16 v[128:143], v[56:59], a[16:19], v[128:143]
 ds_write_b64 v249, v[242:243]
 ds_read_b128 a[24:27], v3 offset:4096
 v_mfma_f32_32x32x16_bf16 v[144:159], v[60:63], a[16:19], v[144:159]
 ds_read_b64_tr_b16 v[32:33], v14 offset:30720
 ds_read_b64_tr_b16 v[34:35], v14 offset:32000
 ds_read_b64_tr_b16 v[36:37], v14 offset:30784
 ds_read_b64_tr_b16 v[38:39], v14 offset:32064
 ds_read_b64_tr_b16 v[40:41], v14 offset:30848
 ds_read_b64_tr_b16 v[42:43], v14 offset:32128
 v_mfma_f32_32x32x16_bf16 v[160:175], v[64:67], a[16:19], v[160:175]
 ds_read_b64_tr_b16 v[44:45], v14 offset:30912
 ds_read_b64_tr_b16 v[46:47], v14 offset:32192
 buffer_load_dwordx4 v5, s[40:43], s81 offen  lds
 s_add_u32 m0, s84, 62464
 v_mfma_f32_32x32x16_bf16 v[176:191], v[68:71], a[16:19], v[176:191]
 ds_read_b64_tr_b16 v[48:49], v14 offset:30976
 ds_read_b64_tr_b16 v[50:51], v14 offset:32256
 buffer_load_dwordx4 v10, s[44:47], s86 offen  lds
 s_add_u32 m0, s87, 13312
 s_waitcnt lgkmcnt(13)
 v_mfma_f32_32x32x16_bf16 v[112:127], v[72:75], a[20:23], v[112:127]
 buffer_load_dwordx4 v6, s[40:43], s81 offen  lds
 s_add_u32 m0, s84, 63488
 v_mfma_f32_32x32x16_bf16 v[128:143], v[76:79], a[20:23], v[128:143]
 buffer_load_dwordx4 v11, s[44:47], s86 offen  lds
 s_add_u32 m0, s87, 14336
 v_mfma_f32_32x32x16_bf16 v[144:159], v[80:83], a[20:23], v[144:159]
 buffer_load_dwordx4 v7, s[40:43], s81 offen  lds
 s_add_u32 m0, s84, 64512
 v_mfma_f32_32x32x16_bf16 v[160:175], v[84:87], a[20:23], v[160:175]
 buffer_load_dwordx4 v12, s[44:47], s86 offen  lds
 s_add_u32 m0, s87, 15360
 ds_read_b128 a[28:31], v4 offset:4096
 ds_read_b64_tr_b16 v[52:53], v14 offset:35840
 v_mfma_f32_32x32x16_bf16 v[176:191], v[88:91], a[20:23], v[176:191]
 ds_read_b64_tr_b16 v[54:55], v14 offset:37120
 ds_read_b64_tr_b16 v[56:57], v14 offset:35904
 buffer_load_dwordx4 v8, s[40:43], s81 offen  lds
 s_add_u32 m0, s84, 65536
 ds_read_b64_tr_b16 v[58:59], v14 offset:37184
 ds_read_b64_tr_b16 v[60:61], v14 offset:35968
 ds_read_b64_tr_b16 v[62:63], v14 offset:37248
 ds_read_b64_tr_b16 v[64:65], v14 offset:36032
 ds_read_b64_tr_b16 v[66:67], v14 offset:37312
 buffer_load_dwordx4 v13, s[44:47], s86 offen  lds
 ds_read_b64_tr_b16 v[68:69], v14 offset:36096
 ds_read_b64_tr_b16 v[70:71], v14 offset:37376
 s_waitcnt vmcnt(9)
 s_barrier
 s_waitcnt lgkmcnt(11)
 v_mfma_f32_32x32x16_bf16 v[112:127], v[32:35], a[24:27], v[112:127]
 ds_read_b128 a[32:35], v1 offset:8192
 ds_read_b64_tr_b16 v[72:73], v15 offset:0
 v_mfma_f32_32x32x16_bf16 v[128:143], v[36:39], a[24:27], v[128:143]
 ds_read_b64_tr_b16 v[74:75], v15 offset:1280
 ds_read_b64_tr_b16 v[76:77], v15 offset:64
 s_mul_i32 s86, s80, 245760
 s_add_u32 s86, s86, s82
 s_lshl_b32 s81, s80, 7
 s_add_u32 s80, s80, 1
 s_cmp_eq_u32 s80, 10
 s_cselect_b32 s80, 0, s80
 s_add_u32 m0, s84, 0
 v_mfma_f32_32x32x16_bf16 v[144:159], v[40:43], a[24:27], v[144:159]
 ds_read_b64_tr_b16 v[78:79], v15 offset:1344
 ds_read_b64_tr_b16 v[80:81], v15 offset:128
 ds_read_b64_tr_b16 v[82:83], v15 offset:1408
 v_mfma_f32_32x32x16_bf16 v[160:175], v[44:47], a[24:27], v[160:175]
 ds_read_b64_tr_b16 v[84:85], v15 offset:192
 ds_read_b64_tr_b16 v[86:87], v15 offset:1472
 buffer_load_dwordx4 v9, s[44:47], s86 offen  lds
 s_add_u32 m0, s87, 0
 v_mfma_f32_32x32x16_bf16 v[176:191], v[48:51], a[24:27], v[176:191]
 ds_read_b64_tr_b16 v[88:89], v15 offset:256
 ds_read_b64_tr_b16 v[90:91], v15 offset:1536
 s_mov_b32 s4, 0x9e3779b1
 s_waitcnt lgkmcnt(11)
 v_mfma_f32_32x32x16_bf16 v[112:127], v[52:55], a[28:31], v[112:127]
 ds_read_b128 a[36:39], v2 offset:8192
 ds_read_b64_tr_b16 v[32:33], v15 offset:5120
 buffer_load_dwordx4 v5, s[40:43], s81 offen  lds
 s_add_u32 m0, s84, 1024
 v_mfma_f32_32x32x16_bf16 v[128:143], v[56:59], a[28:31], v[128:143]
 ds_read_b64_tr_b16 v[34:35], v15 offset:6400
 ds_read_b64_tr_b16 v[36:37], v15 offset:5184
 v_mfma_f32_32x32x16_bf16 v[144:159], v[60:63], a[28:31], v[144:159]
 ds_read_b64_tr_b16 v[38:39], v15 offset:6464
 ds_read_b64_tr_b16 v[40:41], v15 offset:5248
 ds_read_b64_tr_b16 v[42:43], v15 offset:6528
 v_mfma_f32_32x32x16_bf16 v[160:175], v[64:67], a[28:31], v[160:175]
 ds_read_b64_tr_b16 v[44:45], v15 offset:5312
 ds_read_b64_tr_b16 v[46:47], v15 offset:6592
 buffer_load_dwordx4 v10, s[44:47], s86 offen  lds
 s_add_u32 m0, s87, 1024
 v_mfma_f32_32x32x16_bf16 v[176:191], v[68:71], a[28:31], v[176:191]
 ds_read_b64_tr_b16 v[48:49], v15 offset:5376
 ds_read_b64_tr_b16 v[50:51], v15 offset:6656
 buffer_load_dwordx4 v6, s[40:43], s81 offen  lds
 s_add_u32 m0, s84, 2048
 s_waitcnt lgkmcnt(11)
 v_mfma_f32_32x32x16_bf16 v[112:127], v[72:75], a[32:35], v[112:127]
 ds_read_b128 a[40:43], v3 offset:8192
 ds_read_b64_tr_b16 v[52:53], v15 offset:10240
 v_mul_lo_u32 v253, v253, s4
 v_mfma_f32_32x32x16_bf16 v[128:143], v[76:79], a[32:35], v[128:143]
 ds_read_b64_tr_b16 v[54:55], v15 offset:11520
 ds_read_b64_tr_b16 v[56:57], v15 offset:10304
 buffer_load_dwordx4 v11, s[44:47], s86 offen  lds
 s_add_u32 m0, s87, 2048
 v_mfma_f32_32x32x16_bf16 v[144:159], v[80:83], a[32:35], v[144:159]
 ds_read_b64_tr_b16 v[58:59], v15 offset:11584
 ds_read_b64_tr_b16 v[60:61], v15 offset:10368
 ds_read_b64_tr_b16 v[62:63], v15 offset:11648
 v_mfma_f32_32x32x16_bf16 v[160:175], v[84:87], a[32:35], v[160:175]
 ds_read_b64_tr_b16 v[64:65], v15 offset:10432
 ds_read_b64_tr_b16 v[66:67], v15 offset:11712
 buffer_load_dwordx4 v7, s[40:43], s81 offen  lds
 s_add_u32 m0, s84, 3072
 v_mfma_f32_32x32x16_bf16 v[176:191], v[88:91], a[32:35], v[176:191]
 ds_read_b64_tr_b16 v[68:69], v15 offset:10496
 ds_read_b64_tr_b16 v[70:71], v15 offset:11776
 s_waitcnt lgkmcnt(11)
 v_mfma_f32_32x32x16_bf16 v[112:127], v[32:35], a[36:39], v[112:127]
 buffer_load_dwordx4 v12, s[44:47], s86 offen  lds
 s_add_u32 m0, s87, 3072
 ds_read_b128 a[44:47], v4 offset:8192
 ds_read_b64_tr_b16 v[72:73], v15 offset:15360
 v_mfma_f32_32x32x16_bf16 v[128:143], v[36:39], a[36:39], v[128:143]
 ds_read_b64_tr_b16 v[74:75], v15 offset:16640
 ds_read_b64_tr_b16 v[76:77], v15 offset:15424
 v_add_u32 v253, 0x7f4a7c15, v253
 v_mfma_f32_32x32x16_bf16 v[144:159], v[40:43], a[36:39], v[144:159]
 buffer_load_dwordx4 v8, s[40:43], s81 offen  lds
 s_add_u32 m0, s84, 4096
 ds_read_b64_tr_b16 v[78:79], v15 offset:16704
 ds_read_b64_tr_b16 v[80:81], v15 offset:15488
 v_mfma_f32_32x32x16_bf16 v[160:175], v[44:47], a[36:39], v[160:175]
 ds_read_b64_tr_b16 v[82:83], v15 offset:16768
 ds_read_b64_tr_b16 v[84:85], v15 offset:15552
 ds_read_b64_tr_b16 v[86:87], v15 offset:16832
 v_mfma_f32_32x32x16_bf16 v[176:191], v[48:51], a[36:39], v[176:191]
 buffer_load_dwordx4 v13, s[44:47], s86 offen  lds
 ds_read_b64_tr_b16 v[88:89], v15 offset:15616
 ds_read_b64_tr_b16 v[90:91], v15 offset:16896
 s_waitcnt vmcnt(9)
 s_barrier
 s_waitcnt lgkmcnt(11)
 v_mfma_f32_32x32x16_bf16 v[112:127], v[52:55], a[40:43], v[112:127]
 ds_read_b128 a[48:51], v1 offset:12288
 ds_read_b64_tr_b16 v[32:33], v15 offset:20480
 v_mfma_f32_32x32x16_bf16 v[128:143], v[56:59], a[40:43], v[128:143]
 ds_read_b64_tr_b16 v[34:35], v15 offset:21760
 ds_read_b64_tr_b16 v[36:37], v15 offset:20544
 s_mul_i32 s86, s80, 245760
 s_add_u32 s86, s86, s82
 s_lshl_b32 s81, s80, 7
 s_add_u32 s80, s80, 1
 s_cmp_eq_u32 s80, 10
 s_cselect_b32 s80, 0, s80
 s_add_u32 m0, s84, 20480
 v_mfma_f32_32x32x16_bf16 v[144:159], v[60:63], a[40:43], v[144:159]
 ds_read_b64_tr_b16 v[38:39], v15 offset:21824
 ds_read_b64_tr_b16 v[40:41], v15 offset:20608
 ds_read_b64_tr_b16 v[42:43], v15 offset:21888
 v_mfma_f32_32x32x16_bf16 v[160:175], v[64:67], a[40:43], v[160:175]
 ds_read_b64_tr_b16 v[44:45], v15 offset:20672
 ds_read_b64_tr_b16 v[46:47], v15 offset:21952
 buffer_load_dwordx4 v9, s[44:47], s86 offen  lds
 s_add_u32 m0, s87, 4096
 v_mfma_f32_32x32x16_bf16 v[176:191], v[68:71], a[40:43], v[176:191]
 ds_read_b64_tr_b16 v[48:49], v15 offset:20736
 ds_read_b64_tr_b16 v[50:51], v15 offset:22016
 s_waitcnt lgkmcnt(11)
 v_mfma_f32_32x32x16_bf16 v[112:127], v[72:75], a[44:47], v[112:127]
 ds_read_b128 a[52:55], v2 offset:12288
 ds_read_b64_tr_b16 v[52:53], v15 offset:25600
 buffer_load_dwordx4 v5, s[40:43], s81 offen  lds
 s_add_u32 m0, s84, 21504
 v_mfma_f32_32x32x16_bf16 v[128:143], v[76:79], a[44:47], v[128:143]
 ds_read_b64_tr_b16 v[54:55], v15 offset:26880
 ds_read_b64_tr_b16 v[56:57], v15 offset:25664
 v_mfma_f32_32x32x16_bf16 v[144:159], v[80:83], a[44:47], v[144:159]
 ds_read_b64_tr_b16 v[58:59], v15 offset:26944
 ds_read_b64_tr_b16 v[60:61], v15 offset:25728
 ds_read_b64_tr_b16 v[62:63], v15 offset:27008
 v_mfma_f32_32x32x16_bf16 v[160:175], v[84:87], a[44:47], v[160:175]
 ds_read_b64_tr_b16 v[64:65], v15 offset:25792
 ds_read_b64_tr_b16 v[66:67], v15 offset:27072
 buffer_load_dwordx4 v10, s[44:47], s86 offen  lds
 s_add_u32 m0, s87, 5120
 v_mfma_f32_32x32x16_bf16 v[176:191], v[88:91], a[44:47], v[176:191]
 ds_read_b64_tr_b16 v[68:69], v15 offset:25856
 ds_read_b64_tr_b16 v[70:71], v15 offset:27136
 buffer_load_dwordx4 v6, s[40:43], s81 offen  lds
 s_add_u32 m0, s84, 22528
 s_waitcnt lgkmcnt(11)
 v_mfma_f32_32x32x16_bf16 v[112:127], v[32:35], a[48:51], v[112:127]
 ds_read_b128 a[56:59], v3 offset:12288
 ds_read_b64_tr_b16 v[72:73], v15 offset:30720
 v_mfma_f32_32x32x16_bf16 v[128:143], v[36:39], a[48:51], v[128:143]
 ds_read_b64_tr_b16 v[74:75], v15 offset:32000
 ds_read_b64_tr_b16 v[76:77], v15 offset:30784
 buffer_load_dwordx4 v11, s[44:47], s86 offen  lds
 s_add_u32 m0, s87, 6144
 v_mfma_f32_32x32x16_bf16 v[144:159], v[40:43], a[48:51], v[144:159]
 ds_read_b64_tr_b16 v[78:79], v15 offset:32064
 ds_read_b64_tr_b16 v[80:81], v15 offset:30848
 ds_read_b64_tr_b16 v[82:83], v15 offset:32128
 v_mfma_f32_32x32x16_bf16 v[160:175], v[44:47], a[48:51], v[160:175]
 ds_read_b64_tr_b16 v[84:85], v15 offset:30912
 ds_read_b64_tr_b16 v[86:87], v15 offset:32192
 buffer_load_dwordx4 v7, s[40:43], s81 offen  lds
 s_add_u32 m0, s84, 23552
 v_mfma_f32_32x32x16_bf16 v[176:191], v[48:51], a[48:51], v[176:191]
 ds_read_b64_tr_b16 v[88:89], v15 offset:30976
 ds_read_b64_tr_b16 v[90:91], v15 offset:32256
 s_waitcnt lgkmcnt(11)
 v_mfma_f32_32x32x16_bf16 v[112:127], v[52:55], a[52:55], v[112:127]
 buffer_load_dwordx4 v12, s[44:47], s86 offen  lds
 s_add_u32 m0, s87, 7168
 ds_read_b128 a[60:63], v4 offset:12288
 ds_read_b64_tr_b16 v[32:33], v15 offset:35840
 v_mfma_f32_32x32x16_bf16 v[128:143], v[56:59], a[52:55], v[128:143]
 ds_read_b64_tr_b16 v[34:35], v15 offset:37120
 ds_read_b64_tr_b16 v[36:37], v15 offset:35904
 v_mfma_f32_32x32x16_bf16 v[144:159], v[60:63], a[52:55], v[144:159]
 buffer_load_dwordx4 v8, s[40:43], s81 offen  lds
 s_add_u32 m0, s84, 24576
 ds_read_b64_tr_b16 v[38:39], v15 offset:37184
 ds_read_b64_tr_b16 v[40:41], v15 offset:35968
 v_mfma_f32_32x32x16_bf16 v[160:175], v[64:67], a[52:55], v[160:175]
 ds_read_b64_tr_b16 v[42:43], v15 offset:37248
 ds_read_b64_tr_b16 v[44:45], v15 offset:36032
 ds_read_b64_tr_b16 v[46:47], v15 offset:37312
 v_mfma_f32_32x32x16_bf16 v[176:191], v[68:71], a[52:55], v[176:191]
 buffer_load_dwordx4 v13, s[44:47], s86 offen  lds
 ds_read_b64_tr_b16 v[48:49], v15 offset:36096
 ds_read_b64_tr_b16 v[50:51], v15 offset:37376
 s_waitcnt vmcnt(9)
 s_barrier
 s_waitcnt lgkmcnt(11)
 v_mfma_f32_32x32x16_bf16 v[112:127], v[72:75], a[56:59], v[112:127]
 ds_read_b128 a[64:67], v1 offset:0
 ds_read_b64_tr_b16 v[52:53], v14 offset:0
 v_mfma_f32_32x32x16_bf16 v[128:143], v[76:79], a[56:59], v[128:143]
 ds_read_b64_tr_b16 v[54:55], v14 offset:1280
 ds_read_b64_tr_b16 v[56:57], v14 offset:64
 s_mul_i32 s86, s80, 245760
 s_add_u32 s86, s86, s82
 s_lshl_b32 s81, s80, 7
 s_add_u32 s80, s80, 1
 s_cmp_eq_u32 s80, 10
 s_cselect_b32 s80, 0, s80
 s_add_u32 m0, s84, 40960
 v_mfma_f32_32x32x16_bf16 v[144:159], v[80:83], a[56:59], v[144:159]
 ds_read_b64_tr_b16 v[58:59], v14 offset:1344
 ds_read_b64_tr_b16 v[60:61], v14 offset:128
 ds_read_b64_tr_b16 v[62:63], v14 offset:1408
 v_mfma_f32_32x32x16_bf16 v[160:175], v[84:87], a[56:59], v[160:175]
 ds_read_b64_tr_b16 v[64:65], v14 offset:192
 ds_read_b64_tr_b16 v[66:67], v14 offset:1472
 buffer_load_dwordx4 v9, s[44:47], s86 offen  lds
 s_add_u32 m0, s87, 8192
 v_mfma_f32_32x32x16_bf16 v[176:191], v[88:91], a[56:59], v[176:191]
 ds_read_b64_tr_b16 v[68:69], v14 offset:256
 ds_read_b64_tr_b16 v[70:71], v14 offset:1536
 s_waitcnt lgkmcnt(11)
 v_mfma_f32_32x32x16_bf16 v[112:127], v[32:35], a[60:63], v[112:127]
 ds_read_b128 a[68:71], v2 offset:0
 ds_read_b64_tr_b16 v[72:73], v14 offset:5120
 buffer_load_dwordx4 v5, s[40:43], s81 offen  lds
 s_add_u32 m0, s84, 41984
 v_mfma_f32_32x32x16_bf16 v[128:143], v[36:39], a[60:63], v[128:143]
 ds_read_b64_tr_b16 v[74:75], v14 offset:6400
 ds_read_b64_tr_b16 v[76:77], v14 offset:5184
 v_mfma_f32_32x32x16_bf16 v[144:159], v[40:43], a[60:63], v[144:159]
 ds_read_b64_tr_b16 v[78:79], v14 offset:6464
 ds_read_b64_tr_b16 v[80:81], v14 offset:5248
 ds_read_b64_tr_b16 v[82:83], v14 offset:6528
 v_mfma_f32_32x32x16_bf16 v[160:175], v[44:47], a[60:63], v[160:175]
 ds_read_b64_tr_b16 v[84:85], v14 offset:5312
 ds_read_b64_tr_b16 v[86:87], v14 offset:6592
 buffer_load_dwordx4 v10, s[44:47], s86 offen  lds
 s_branch pg1_skip
.p2align 12
pg1:
 s_setpc_b64 s[4:5]
 s_nop 0
pg1_skip:
 s_add_u32 m0, s87, 9216
 v_mfma_f32_32x32x16_bf16 v[176:191], v[48:51], a[60:63], v[176:191]
 ds_read_b64_tr_b16 v[88:89], v14 offset:5376
 ds_read_b64_tr_b16 v[90:91], v14 offset:6656
 buffer_load_dwordx4 v6, s[40:43], s81 offen  lds
 s_add_u32 m0, s84, 43008
 s_waitcnt lgkmcnt(11)
 v_mfma_f32_32x32x16_bf16 v[112:127], v[52:55], a[64:67], v[112:127]
 ds_read_b128 a[72:75], v3 offset:0
 ds_read_b64_tr_b16 v[32:33], v14 offset:10240
 v_mfma_f32_32x32x16_bf16 v[128:143], v[56:59], a[64:67], v[128:143]
 ds_read_b64_tr_b16 v[34:35], v14 offset:11520
 ds_read_b64_tr_b16 v[36:37], v14 offset:10304
 buffer_load_dwordx4 v11, s[44:47], s86 offen  lds
 s_add_u32 m0, s87, 10240
 v_mfma_f32_32x32x16_bf16 v[144:159], v[60:63], a[64:67], v[144:159]
 ds_read_b64_tr_b16 v[38:39], v14 offset:11584
 ds_read_b64_tr_b16 v[40:41], v14 offset:10368
 ds_read_b64_tr_b16 v[42:43], v14 offset:11648
 v_mfma_f32_32x32x16_bf16 v[160:175], v[64:67], a[64:67], v[160:175]
 ds_read_b64_tr_b16 v[44:45], v14 offset:10432
 ds_read_b64_tr_b16 v[46:47], v14 offset:11712
 buffer_load_dwordx4 v7, s[40:43], s81 offen  lds
 s_add_u32 m0, s84, 44032
 v_mfma_f32_32x32x16_bf16 v[176:191], v[68:71], a[64:67], v[176:191]
 ds_read_b64_tr_b16 v[48:49], v14 offset:10496
 ds_read_b64_tr_b16 v[50:51], v14 offset:11776
 s_waitcnt lgkmcnt(11)
 v_mfma_f32_32x32x16_bf16 v[112:127], v[72:75], a[68:71], v[112:127]
 buffer_load_dwordx4 v12, s[44:47], s86 offen  lds
 s_add_u32 m0, s87, 11264
 ds_read_b128 a[76:79], v4 offset:0
 ds_read_b64_tr_b16 v[52:53], v14 offset:15360
 v_mfma_f32_32x32x16_bf16 v[128:143], v[76:79], a[68:71], v[128:143]
 ds_read_b64_tr_b16 v[54:55], v14 offset:16640
 ds_read_b64_tr_b16 v[56:57], v14 offset:15424
 v_mfma_f32_32x32x16_bf16 v[144:159], v[80:83], a[68:71], v[144:159]
 buffer_load_dwordx4 v8, s[40:43], s81 offen  lds
 s_add_u32 m0, s84, 45056
 ds_read_b64_tr_b16 v[58:59], v14 offset:16704
 ds_read_b64_tr_b16 v[60:61], v14 offset:15488
 v_mfma_f32_32x32x16_bf16 v[160:175], v[84:87], a[68:71], v[160:175]
 ds_read_b64_tr_b16 v[62:63], v14 offset:16768
 ds_read_b64_tr_b16 v[64:65], v14 offset:15552
 ds_read_b64_tr_b16 v[66:67], v14 offset:16832
 v_mfma_f32_32x32x16_bf16 v[176:191], v[88:91], a[68:71], v[176:191]
 buffer_load_dwordx4 v13, s[44:47], s86 offen  lds
 ds_read_b64_tr_b16 v[68:69], v14 offset:15616
 ds_read_b64_tr_b16 v[70:71], v14 offset:16896
 s_waitcnt vmcnt(9)
 s_barrier
 s_waitcnt lgkmcnt(11)
 v_mfma_f32_32x32x16_bf16 v[112:127], v[32:35], a[72:75], v[112:127]
 ds_read_b128 a[80:83], v1 offset:4096
 ds_read_b64_tr_b16 v[72:73], v14 offset:20480
 v_mfma_f32_32x32x16_bf16 v[128:143], v[36:39], a[72:75], v[128:143]
 ds_read_b64_tr_b16 v[74:75], v14 offset:21760
 ds_read_b64_tr_b16 v[76:77], v14 offset:20544
 s_mul_i32 s86, s80, 245760
 s_add_u32 s86, s86, s82
 s_lshl_b32 s81, s80, 7
 s_add_u32 s80, s80, 1
 s_cmp_eq_u32 s80, 10
 s_cselect_b32 s80, 0, s80
 s_add_u32 m0, s84, 61440
 v_mfma_f32_32x32x16_bf16 v[144:159], v[40:43], a[72:75], v[144:159]
 ds_read_b64_tr_b16 v[78:79], v14 offset:21824
 ds_read_b64_tr_b16 v[80:81], v14 offset:20608
 ds_read_b64_tr_b16 v[82:83], v14 offset:21888
 v_mfma_f32_32x32x16_bf16 v[160:175], v[44:47], a[72:75], v[160:175]
 ds_read_b64_tr_b16 v[84:85], v14 offset:20672
 ds_read_b64_tr_b16 v[86:87], v14 offset:21952
 buffer_load_dwordx4 v9, s[44:47], s86 offen  lds
 s_add_u32 m0, s87, 12288
 v_mfma_f32_32x32x16_bf16 v[176:191], v[48:51], a[72:75], v[176:191]
 ds_read_b64_tr_b16 v[88:89], v14 offset:20736
 ds_read_b64_tr_b16 v[90:91], v14 offset:22016
 s_waitcnt lgkmcnt(11)
 v_mfma_f32_32x32x16_bf16 v[112:127], v[52:55], a[76:79], v[112:127]
 ds_read_b128 a[84:87], v2 offset:4096
 ds_read_b64_tr_b16 v[32:33], v14 offset:25600
 buffer_load_dwordx4 v5, s[40:43], s81 offen  lds
 s_add_u32 m0, s84, 62464
 v_mfma_f32_32x32x16_bf16 v[128:143], v[56:59], a[76:79], v[128:143]
 ds_read_b64_tr_b16 v[34:35], v14 offset:26880
 ds_read_b64_tr_b16 v[36:37], v14 offset:25664
 v_mfma_f32_32x32x16_bf16 v[144:159], v[60:63], a[76:79], v[144:159]
 ds_read_b64_tr_b16 v[38:39], v14 offset:26944
 ds_read_b64_tr_b16 v[40:41], v14 offset:25728
 ds_read_b64_tr_b16 v[42:43], v14 offset:27008
 v_mfma_f32_32x32x16_bf16 v[160:175], v[64:67], a[76:79], v[160:175]
 ds_read_b64_tr_b16 v[44:45], v14 offset:25792
 ds_read_b64_tr_b16 v[46:47], v14 offset:27072
 buffer_load_dwordx4 v10, s[44:47], s86 offen  lds
 s_add_u32 m0, s87, 13312
 v_mfma_f32_32x32x16_bf16 v[176:191], v[68:71], a[76:79], v[176:191]
 ds_read_b64_tr_b16 v[48:49], v14 offset:25856
 ds_read_b64_tr_b16 v[50:51], v14 offset:27136
 buffer_load_dwordx4 v6, s[40:43], s81 offen  lds
 s_add_u32 m0, s84, 63488
 s_waitcnt lgkmcnt(11)
 v_mfma_f32_32x32x16_bf16 v[112:127], v[72:75], a[80:83], v[112:127]
 ds_read_b128 a[88:91], v3 offset:4096
 ds_read_b64_tr_b16 v[52:53], v14 offset:30720
 v_mfma_f32_32x32x16_bf16 v[128:143], v[76:79], a[80:83], v[128:143]
 ds_read_b64_tr_b16 v[54:55], v14 offset:32000
 ds_read_b64_tr_b16 v[56:57], v14 offset:30784
 buffer_load_dwordx4 v11, s[44:47], s86 offen  lds
 s_add_u32 m0, s87, 14336
 v_mfma_f32_32x32x16_bf16 v[144:159], v[80:83], a[80:83], v[144:159]
 ds_read_b64_tr_b16 v[58:59], v14 offset:32064
 ds_read_b64_tr_b16 v[60:61], v14 offset:30848
 ds_read_b64_tr_b16 v[62:63], v14 offset:32128
 v_mfma_f32_32x32x16_bf16 v[160:175], v[84:87], a[80:83], v[160:175]
 ds_read_b64_tr_b16 v[64:65], v14 offset:30912
 ds_read_b64_tr_b16 v[66:67], v14 offset:32192
 buffer_load_dwordx4 v7, s[40:43], s81 offen  lds
 s_add_u32 m0, s84, 64512
 v_mfma_f32_32x32x16_bf16 v[176:191], v[88:91], a[80:83], v[176:191]
 ds_read_b64_tr_b16 v[68:69], v14 offset:30976
 ds_read_b64_tr_b16 v[70:71], v14 offset:32256
 s_waitcnt lgkmcnt(11)
 v_mfma_f32_32x32x16_bf16 v[112:127], v[32:35], a[84:87], v[112:127]
 buffer_load_dwordx4 v12, s[44:47], s86 offen  lds
 s_add_u32 m0, s87, 15360
 ds_read_b128 a[92:95], v4 offset:4096
 ds_read_b64_tr_b16 v[72:73], v14 offset:35840
 v_mfma_f32_32x32x16_bf16 v[128:143], v[36:39], a[84:87], v[128:143]
 ds_read_b64_tr_b16 v[74:75], v14 offset:37120
 ds_read_b64_tr_b16 v[76:77], v14 offset:35904
 v_mfma_f32_32x32x16_bf16 v[144:159], v[40:43], a[84:87], v[144:159]
 buffer_load_dwordx4 v8, s[40:43], s81 offen  lds
 s_add_u32 m0, s84, 65536
 ds_read_b64_tr_b16 v[78:79], v14 offset:37184
 ds_read_b64_tr_b16 v[80:81], v14 offset:35968
 v_mfma_f32_32x32x16_bf16 v[160:175], v[44:47], a[84:87], v[160:175]
 ds_read_b64_tr_b16 v[82:83], v14 offset:37248
 ds_read_b64_tr_b16 v[84:85], v14 offset:36032
 ds_read_b64_tr_b16 v[86:87], v14 offset:37312
 v_mfma_f32_32x32x16_bf16 v[176:191], v[48:51], a[84:87], v[176:191]
 buffer_load_dwordx4 v13, s[44:47], s86 offen  lds
 ds_read_b64_tr_b16 v[88:89], v14 offset:36096
 ds_read_b64_tr_b16 v[90:91], v14 offset:37376
 s_waitcnt vmcnt(9)
 s_barrier
 s_waitcnt lgkmcnt(11)
 v_mfma_f32_32x32x16_bf16 v[112:127], v[52:55], a[88:91], v[112:127]
 ds_read_b128 a[96:99], v1 offset:8192
 ds_read_b64_tr_b16 v[32:33], v15 offset:0
 v_mfma_f32_32x32x16_bf16 v[128:143], v[56:59], a[88:91], v[128:143]
 ds_read_b64_tr_b16 v[34:35], v15 offset:1280
 ds_read_b64_tr_b16 v[36:37], v15 offset:64
 s_mul_i32 s86, s80, 245760
 s_add_u32 s86, s86, s82
 s_lshl_b32 s81, s80, 7
 s_add_u32 s80, s80, 1
 s_cmp_eq_u32 s80, 10
 s_cselect_b32 s80, 0, s80
 s_add_u32 m0, s84, 0
 v_mfma_f32_32x32x16_bf16 v[144:159], v[60:63], a[88:91], v[144:159]
 ds_read_b64_tr_b16 v[38:39], v15 offset:1344
 ds_read_b64_tr_b16 v[40:41], v15 offset:128
 ds_read_b64_tr_b16 v[42:43], v15 offset:1408
 v_mfma_f32_32x32x16_bf16 v[160:175], v[64:67], a[88:91], v[160:175]
 ds_read_b64_tr_b16 v[44:45], v15 offset:192
 ds_read_b64_tr_b16 v[46:47], v15 offset:1472
 buffer_load_dwordx4 v9, s[44:47], s86 offen  lds
 s_add_u32 m0, s87, 0
 v_mfma_f32_32x32x16_bf16 v[176:191], v[68:71], a[88:91], v[176:191]
 ds_read_b64_tr_b16 v[48:49], v15 offset:256
 ds_read_b64_tr_b16 v[50:51], v15 offset:1536
 s_waitcnt lgkmcnt(11)
 v_mfma_f32_32x32x16_bf16 v[112:127], v[72:75], a[92:95], v[112:127]
 ds_read_b128 a[100:103], v2 offset:8192
 ds_read_b64_tr_b16 v[52:53], v15 offset:5120
 buffer_load_dwordx4 v5, s[40:43], s81 offen  lds
 s_add_u32 m0, s84, 1024
 v_mfma_f32_32x32x16_bf16 v[128:143], v[76:79], a[92:95], v[128:143]
 ds_read_b64_tr_b16 v[54:55], v15 offset:6400
 ds_read_b64_tr_b16 v[56:57], v15 offset:5184
 v_mfma_f32_32x32x16_bf16 v[144:159], v[80:83], a[92:95], v[144:159]
 ds_read_b64_tr_b16 v[58:59], v15 offset:6464
 ds_read_b64_tr_b16 v[60:61], v15 offset:5248
 ds_read_b64_tr_b16 v[62:63], v15 offset:6528
 v_mfma_f32_32x32x16_bf16 v[160:175], v[84:87], a[92:95], v[160:175]
 ds_read_b64_tr_b16 v[64:65], v15 offset:5312
 ds_read_b64_tr_b16 v[66:67], v15 offset:6592
 buffer_load_dwordx4 v10, s[44:47], s86 offen  lds
 s_add_u32 m0, s87, 1024
 v_mfma_f32_32x32x16_bf16 v[176:191], v[88:91], a[92:95], v[176:191]
 ds_read_b64_tr_b16 v[68:69], v15 offset:5376
 ds_read_b64_tr_b16 v[70:71], v15 offset:6656
 buffer_load_dwordx4 v6, s[40:43], s81 offen  lds
 s_add_u32 m0, s84, 2048
 s_waitcnt lgkmcnt(11)
 v_mfma_f32_32x32x16_bf16 v[112:127], v[32:35], a[96:99], v[112:127]
 ds_read_b128 a[104:107], v3 offset:8192
 ds_read_b64_tr_b16 v[72:73], v15 offset:10240
 v_mfma_f32_32x32x16_bf16 v[128:143], v[36:39], a[96:99], v[128:143]
 ds_read_b64_tr_b16 v[74:75], v15 offset:11520
 ds_read_b64_tr_b16 v[76:77], v15 offset:10304
 buffer_load_dwordx4 v11, s[44:47], s86 offen  lds
 s_add_u32 m0, s87, 2048
 v_mfma_f32_32x32x16_bf16 v[144:159], v[40:43], a[96:99], v[144:159]
 ds_read_b64_tr_b16 v[78:79], v15 offset:11584
 ds_read_b64_tr_b16 v[80:81], v15 offset:10368
 ds_read_b64_tr_b16 v[82:83], v15 offset:11648
 v_mfma_f32_32x32x16_bf16 v[160:175], v[44:47], a[96:99], v[160:175]
 ds_read_b64_tr_b16 v[84:85], v15 offset:10432
 ds_read_b64_tr_b16 v[86:87], v15 offset:11712
 buffer_load_dwordx4 v7, s[40:43], s81 offen  lds
 s_add_u32 m0, s84, 3072
 v_mfma_f32_32x32x16_bf16 v[176:191], v[48:51], a[96:99], v[176:191]
 ds_read_b64_tr_b16 v[88:89], v15 offset:10496
 ds_read_b64_tr_b16 v[90:91], v15 offset:11776
 s_waitcnt lgkmcnt(11)
 v_mfma_f32_32x32x16_bf16 v[112:127], v[52:55], a[100:103], v[112:127]
 buffer_load_dwordx4 v12, s[44:47], s86 offen  lds
 s_add_u32 m0, s87, 3072
 ds_read_b128 a[108:111], v4 offset:8192
 ds_read_b64_tr_b16 v[32:33], v15 offset:15360
 v_mfma_f32_32x32x16_bf16 v[128:143], v[56:59], a[100:103], v[128:143]
 ds_read_b64_tr_b16 v[34:35], v15 offset:16640
 ds_read_b64_tr_b16 v[36:37], v15 offset:15424
 v_mfma_f32_32x32x16_bf16 v[144:159], v[60:63], a[100:103], v[144:159]
 buffer_load_dwordx4 v8, s[40:43], s81 offen  lds
 s_add_u32 m0, s84, 4096
 ds_read_b64_tr_b16 v[38:39], v15 offset:16704
 ds_read_b64_tr_b16 v[40:41], v15 offset:15488
 v_mfma_f32_32x32x16_bf16 v[160:175], v[64:67], a[100:103], v[160:175]
 ds_read_b64_tr_b16 v[42:43], v15 offset:16768
 ds_read_b64_tr_b16 v[44:45], v15 offset:15552
 ds_read_b64_tr_b16 v[46:47], v15 offset:16832
 v_mfma_f32_32x32x16_bf16 v[176:191], v[68:71], a[100:103], v[176:191]
 buffer_load_dwordx4 v13, s[44:47], s86 offen  lds
 ds_read_b64_tr_b16 v[48:49], v15 offset:15616
 ds_read_b64_tr_b16 v[50:51], v15 offset:16896
 s_waitcnt vmcnt(9)
 s_barrier
 s_waitcnt lgkmcnt(11)
 v_mfma_f32_32x32x16_bf16 v[112:127], v[72:75], a[104:107], v[112:127]
 ds_read_b128 a[112:115], v1 offset:12288
 ds_read_b64_tr_b16 v[52:53], v15 offset:20480
 v_mfma_f32_32x32x16_bf16 v[128:143], v[76:79], a[104:107], v[128:143]
 ds_read_b64_tr_b16 v[54:55], v15 offset:21760
 ds_read_b64_tr_b16 v[56:57], v15 offset:20544
 s_mul_i32 s86, s80, 245760
 s_add_u32 s86, s86, s82
 s_lshl_b32 s81, s80, 7
 s_add_u32 s80, s80, 1
 s_cmp_eq_u32 s80, 10
 s_cselect_b32 s80, 0, s80
 s_add_u32 m0, s84, 20480
 v_mfma_f32_32x32x16_bf16 v[144:159], v[80:83], a[104:107], v[144:159]
 ds_read_b64_tr_b16 v[58:59], v15 offset:21824
 ds_read_b64_tr_b16 v[60:61], v15 offset:20608
 ds_read_b64_tr_b16 v[62:63], v15 offset:21888
 v_mfma_f32_32x32x16_bf16 v[160:175], v[84:87], a[104:107], v[160:175]
 ds_read_b64_tr_b16 v[64:65], v15 offset:20672
 ds_read_b64_tr_b16 v[66:67], v15 offset:21952
 buffer_load_dwordx4 v9, s[44:47], s86 offen  lds
 s_add_u32 m0, s87, 4096
 v_mfma_f32_32x32x16_bf16 v[176:191], v[88:91], a[104:107], v[176:191]
 ds_read_b64_tr_b16 v[68:69], v15 offset:20736
 ds_read_b64_tr_b16 v[70:71], v15 offset:22016
 s_waitcnt lgkmcnt(11)
 v_mfma_f32_32x32x16_bf16 v[112:127], v[32:35], a[108:111], v[112:127]
 ds_read_b128 a[116:119], v2 offset:12288
 ds_read_b64_tr_b16 v[72:73], v15 offset:25600
 buffer_load_dwordx4 v5, s[40:43], s81 offen  lds
 s_add_u32 m0, s84, 21504
 v_mfma_f32_32x32x16_bf16 v[128:143], v[36:39], a[108:111], v[128:143]
 ds_read_b64_tr_b16 v[74:75], v15 offset:26880
 ds_read_b64_tr_b16 v[76:77], v15 offset:25664
 v_mfma_f32_32x32x16_bf16 v[144:159], v[40:43], a[108:111], v[144:159]
 ds_read_b64_tr_b16 v[78:79], v15 offset:26944
 ds_read_b64_tr_b16 v[80:81], v15 offset:25728
 ds_read_b64_tr_b16 v[82:83], v15 offset:27008
 v_mfma_f32_32x32x16_bf16 v[160:175], v[44:47], a[108:111], v[160:175]
 ds_read_b64_tr_b16 v[84:85], v15 offset:25792
 ds_read_b64_tr_b16 v[86:87], v15 offset:27072
 buffer_load_dwordx4 v10, s[44:47], s86 offen  lds
 s_add_u32 m0, s87, 5120
 v_mfma_f32_32x32x16_bf16 v[176:191], v[48:51], a[108:111], v[176:191]
 ds_read_b64_tr_b16 v[88:89], v15 offset:25856
 ds_read_b64_tr_b16 v[90:91], v15 offset:27136
 buffer_load_dwordx4 v6, s[40:43], s81 offen  lds
 s_add_u32 m0, s84, 22528
 s_waitcnt lgkmcnt(11)
 v_mfma_f32_32x32x16_bf16 v[112:127], v[52:55], a[112:115], v[112:127]
 ds_read_b128 a[120:123], v3 offset:12288
 ds_read_b64_tr_b16 v[32:33], v15 offset:30720
 v_mfma_f32_32x32x16_bf16 v[128:143], v[56:59], a[112:115], v[128:143]
 ds_read_b64_tr_b16 v[34:35], v15 offset:32000
 ds_read_b64_tr_b16 v[36:37], v15 offset:30784
 buffer_load_dwordx4 v11, s[44:47], s86 offen  lds
 s_add_u32 m0, s87, 6144
 v_mfma_f32_32x32x16_bf16 v[144:159], v[60:63], a[112:115], v[144:159]
 ds_read_b64_tr_b16 v[38:39], v15 offset:32064
 ds_read_b64_tr_b16 v[40:41], v15 offset:30848
 ds_read_b64_tr_b16 v[42:43], v15 offset:32128
 v_mfma_f32_32x32x16_bf16 v[160:175], v[64:67], a[112:115], v[160:175]
 ds_read_b64_tr_b16 v[44:45], v15 offset:30912
 ds_read_b64_tr_b16 v[46:47], v15 offset:32192
 buffer_load_dwordx4 v7, s[40:43], s81 offen  lds
 s_add_u32 m0, s84, 23552
 v_mfma_f32_32x32x16_bf16 v[176:191], v[68:71], a[112:115], v[176:191]
 ds_read_b64_tr_b16 v[48:49], v15 offset:30976
 ds_read_b64_tr_b16 v[50:51], v15 offset:32256
 s_waitcnt lgkmcnt(11)
 v_mfma_f32_32x32x16_bf16 v[112:127], v[72:75], a[116:119], v[112:127]
 buffer_load_dwordx4 v12, s[44:47], s86 offen  lds
 s_add_u32 m0, s87, 7168
 ds_read_b128 a[124:127], v4 offset:12288
 ds_read_b64_tr_b16 v[52:53], v15 offset:35840
 v_mfma_f32_32x32x16_bf16 v[128:143], v[76:79], a[116:119], v[128:143]
 ds_read_b64_tr_b16 v[54:55], v15 offset:37120
 ds_read_b64_tr_b16 v[56:57], v15 offset:35904
 v_mfma_f32_32x32x16_bf16 v[144:159], v[80:83], a[116:119], v[144:159]
 buffer_load_dwordx4 v8, s[40:43], s81 offen  lds
 s_add_u32 m0, s84, 24576
 ds_read_b64_tr_b16 v[58:59], v15 offset:37184
 ds_read_b64_tr_b16 v[60:61], v15 offset:35968
 v_mfma_f32_32x32x16_bf16 v[160:175], v[84:87], a[116:119], v[160:175]
 ds_read_b64_tr_b16 v[62:63], v15 offset:37248
 ds_read_b64_tr_b16 v[64:65], v15 offset:36032
 ds_read_b64_tr_b16 v[66:67], v15 offset:37312
 v_mfma_f32_32x32x16_bf16 v[176:191], v[88:91], a[116:119], v[176:191]
 buffer_load_dwordx4 v13, s[44:47], s86 offen  lds
 ds_read_b64_tr_b16 v[68:69], v15 offset:36096
 ds_read_b64_tr_b16 v[70:71], v15 offset:37376
 s_waitcnt vmcnt(9)
 s_barrier
 s_waitcnt lgkmcnt(11)
 v_mfma_f32_32x32x16_bf16 v[112:127], v[32:35], a[120:123], v[112:127]
 buffer_load_dword v250, v22, s[60:63], 0 offen sc1
 ds_read_b128 a[128:131], v1 offset:0
 ds_read_b64_tr_b16 v[72:73], v14 offset:0
 v_mfma_f32_32x32x16_bf16 v[128:143], v[36:39], a[120:123], v[128:143]
 ds_read_b64_tr_b16 v[74:75], v14 offset:1280
 ds_read_b64_tr_b16 v[76:77], v14 offset:64
 v_mfma_f32_32x32x16_bf16 v[144:159], v[40:43], a[120:123], v[144:159]
 ds_read_b64_tr_b16 v[78:79], v14 offset:1344
 ds_read_b64_tr_b16 v[80:81], v14 offset:128
 ds_read_b64_tr_b16 v[82:83], v14 offset:1408
 v_mfma_f32_32x32x16_bf16 v[160:175], v[44:47], a[120:123], v[160:175]
 ds_read_b64_tr_b16 v[84:85], v14 offset:192
 ds_read_b64_tr_b16 v[86:87], v14 offset:1472
 v_mfma_f32_32x32x16_bf16 v[176:191], v[48:51], a[120:123], v[176:191]
 ds_read_b64_tr_b16 v[88:89], v14 offset:256
 ds_read_b64_tr_b16 v[90:91], v14 offset:1536
 s_waitcnt lgkmcnt(11)
 v_mfma_f32_32x32x16_bf16 v[112:127], v[52:55], a[124:127], v[112:127]
 ds_read_b128 a[132:135], v2 offset:0
 ds_read_b64_tr_b16 v[32:33], v14 offset:5120
 v_mfma_f32_32x32x16_bf16 v[128:143], v[56:59], a[124:127], v[128:143]
 ds_read_b64_tr_b16 v[34:35], v14 offset:6400
 ds_read_b64_tr_b16 v[36:37], v14 offset:5184
 v_mfma_f32_32x32x16_bf16 v[144:159], v[60:63], a[124:127], v[144:159]
 ds_read_b64_tr_b16 v[38:39], v14 offset:6464
 ds_read_b64_tr_b16 v[40:41], v14 offset:5248
 ds_read_b64_tr_b16 v[42:43], v14 offset:6528
 v_mfma_f32_32x32x16_bf16 v[160:175], v[64:67], a[124:127], v[160:175]
 ds_read_b64_tr_b16 v[44:45], v14 offset:5312
 ds_read_b64_tr_b16 v[46:47], v14 offset:6592
 v_mfma_f32_32x32x16_bf16 v[176:191], v[68:71], a[124:127], v[176:191]
 ds_read_b64_tr_b16 v[48:49], v14 offset:5376
 ds_read_b64_tr_b16 v[50:51], v14 offset:6656
 s_waitcnt lgkmcnt(11)
 v_mfma_f32_32x32x16_bf16 v[112:127], v[72:75], a[128:131], v[112:127]
 ds_read_b128 a[136:139], v3 offset:0
 ds_read_b64_tr_b16 v[52:53], v14 offset:10240
 v_mfma_f32_32x32x16_bf16 v[128:143], v[76:79], a[128:131], v[128:143]
 ds_read_b64_tr_b16 v[54:55], v14 offset:11520
 ds_read_b64_tr_b16 v[56:57], v14 offset:10304
 v_mfma_f32_32x32x16_bf16 v[144:159], v[80:83], a[128:131], v[144:159]
 ds_read_b64_tr_b16 v[58:59], v14 offset:11584
 ds_read_b64_tr_b16 v[60:61], v14 offset:10368
 ds_read_b64_tr_b16 v[62:63], v14 offset:11648
 v_mfma_f32_32x32x16_bf16 v[160:175], v[84:87], a[128:131], v[160:175]
 ds_read_b64_tr_b16 v[64:65], v14 offset:10432
 ds_read_b64_tr_b16 v[66:67], v14 offset:11712
 v_mfma_f32_32x32x16_bf16 v[176:191], v[88:91], a[128:131], v[176:191]
 ds_read_b64_tr_b16 v[68:69], v14 offset:10496
 ds_read_b64_tr_b16 v[70:71], v14 offset:11776
 s_waitcnt lgkmcnt(11)
 v_mfma_f32_32x32x16_bf16 v[112:127], v[32:35], a[132:135], v[112:127]
 s_lshl_b32 s86, s71, 1
 s_add_u32 s86, s86, s68
 s_add_u32 s86, s86, 0
 s_sub_u32 s74, s86, 20
 s_cmp_ge_u32 s86, 20
 s_cselect_b32 s86, s74, s86
 s_mul_i32 s86, s86, 122880
 s_add_u32 s86, s86, s75
 s_add_u32 m0, s84, 40960
 v_mfma_f32_32x32x16_bf16 v[128:143], v[36:39], a[132:135], v[128:143]
 buffer_load_dwordx4 v21, s[44:47], s86 offen  lds
 s_add_u32 m0, s84, 41984
 v_mfma_f32_32x32x16_bf16 v[144:159], v[40:43], a[132:135], v[144:159]
 buffer_load_dwordx4 v29, s[44:47], s86 offen  lds
 s_add_u32 m0, s84, 43008
 v_mfma_f32_32x32x16_bf16 v[160:175], v[44:47], a[132:135], v[160:175]
 buffer_load_dwordx4 v30, s[44:47], s86 offen  lds
 s_add_u32 m0, s84, 44032
 v_mfma_f32_32x32x16_bf16 v[176:191], v[48:51], a[132:135], v[176:191]
 buffer_load_dwordx4 v31, s[44:47], s86 offen  lds
 s_add_u32 m0, s84, 45056
 ds_read_b128 a[140:143], v4 offset:0
 ds_read_b64_tr_b16 v[72:73], v14 offset:15360
 ds_read_b64_tr_b16 v[74:75], v14 offset:16640
 ds_read_b64_tr_b16 v[76:77], v14 offset:15424
 ds_read_b64_tr_b16 v[78:79], v14 offset:16704
 ds_read_b64_tr_b16 v[80:81], v14 offset:15488
 ds_read_b64_tr_b16 v[82:83], v14 offset:16768
 buffer_load_dwordx4 v252, s[44:47], s86 offen  lds
 ds_read_b64_tr_b16 v[84:85], v14 offset:15552
 ds_read_b64_tr_b16 v[86:87], v14 offset:16832
 ds_read_b64_tr_b16 v[88:89], v14 offset:15616
 ds_read_b64_tr_b16 v[90:91], v14 offset:16896
 s_waitcnt vmcnt(6)
 s_barrier
 s_waitcnt lgkmcnt(11)
 v_mfma_f32_32x32x16_bf16 v[112:127], v[52:55], a[136:139], v[112:127]
 ds_read_b128 a[144:147], v1 offset:4096
 ds_read_b64_tr_b16 v[32:33], v14 offset:20480
 v_mfma_f32_32x32x16_bf16 v[128:143], v[56:59], a[136:139], v[128:143]
 ds_read_b64_tr_b16 v[34:35], v14 offset:21760
 ds_read_b64_tr_b16 v[36:37], v14 offset:20544
 v_mfma_f32_32x32x16_bf16 v[144:159], v[60:63], a[136:139], v[144:159]
 ds_read_b64_tr_b16 v[38:39], v14 offset:21824
 ds_read_b64_tr_b16 v[40:41], v14 offset:20608
 ds_read_b64_tr_b16 v[42:43], v14 offset:21888
 v_mfma_f32_32x32x16_bf16 v[160:175], v[64:67], a[136:139], v[160:175]
 ds_read_b64_tr_b16 v[44:45], v14 offset:20672
 ds_read_b64_tr_b16 v[46:47], v14 offset:21952
 v_mfma_f32_32x32x16_bf16 v[176:191], v[68:71], a[136:139], v[176:191]
 ds_read_b64_tr_b16 v[48:49], v14 offset:20736
 ds_read_b64_tr_b16 v[50:51], v14 offset:22016
 s_waitcnt lgkmcnt(11)
 v_mfma_f32_32x32x16_bf16 v[112:127], v[72:75], a[140:143], v[112:127]
 ds_read_b128 a[148:151], v2 offset:4096
 ds_read_b64_tr_b16 v[52:53], v14 offset:25600
 v_mfma_f32_32x32x16_bf16 v[128:143], v[76:79], a[140:143], v[128:143]
 ds_read_b64_tr_b16 v[54:55], v14 offset:26880
 ds_read_b64_tr_b16 v[56:57], v14 offset:25664
 v_mfma_f32_32x32x16_bf16 v[144:159], v[80:83], a[140:143], v[144:159]
 ds_read_b64_tr_b16 v[58:59], v14 offset:26944
 ds_read_b64_tr_b16 v[60:61], v14 offset:25728
 ds_read_b64_tr_b16 v[62:63], v14 offset:27008
 v_mfma_f32_32x32x16_bf16 v[160:175], v[84:87], a[140:143], v[160:175]
 ds_read_b64_tr_b16 v[64:65], v14 offset:25792
 ds_read_b64_tr_b16 v[66:67], v14 offset:27072
 v_mfma_f32_32x32x16_bf16 v[176:191], v[88:91], a[140:143], v[176:191]
 ds_read_b64_tr_b16 v[68:69], v14 offset:25856
 ds_read_b64_tr_b16 v[70:71], v14 offset:27136
 s_waitcnt lgkmcnt(11)
 v_mfma_f32_32x32x16_bf16 v[112:127], v[32:35], a[144:147], v[112:127]
 ds_read_b128 a[152:155], v3 offset:4096
 ds_read_b64_tr_b16 v[72:73], v14 offset:30720
 v_mfma_f32_32x32x16_bf16 v[128:143], v[36:39], a[144:147], v[128:143]
 ds_read_b64_tr_b16 v[74:75], v14 offset:32000
 ds_read_b64_tr_b16 v[76:77], v14 offset:30784
 v_mfma_f32_32x32x16_bf16 v[144:159], v[40:43], a[144:147], v[144:159]
 ds_read_b64_tr_b16 v[78:79], v14 offset:32064
 ds_read_b64_tr_b16 v[80:81], v14 offset:30848
 ds_read_b64_tr_b16 v[82:83], v14 offset:32128
 v_mfma_f32_32x32x16_bf16 v[160:175], v[44:47], a[144:147], v[160:175]
 ds_read_b64_tr_b16 v[84:85], v14 offset:30912
 ds_read_b64_tr_b16 v[86:87], v14 offset:32192
 v_mfma_f32_32x32x16_bf16 v[176:191], v[48:51], a[144:147], v[176:191]
 ds_read_b64_tr_b16 v[88:89], v14 offset:30976
 ds_read_b64_tr_b16 v[90:91], v14 offset:32256
 s_waitcnt lgkmcnt(11)
 v_mfma_f32_32x32x16_bf16 v[112:127], v[52:55], a[148:151], v[112:127]
 s_lshl_b32 s86, s71, 1
 s_add_u32 s86, s86, s68
 s_add_u32 s86, s86, 4
 s_sub_u32 s74, s86, 20
 s_cmp_ge_u32 s86, 20
 s_cselect_b32 s86, s74, s86
 s_mul_i32 s86, s86, 122880
 s_add_u32 s86, s86, s75
 s_add_u32 m0, s84, 61440
 v_mfma_f32_32x32x16_bf16 v[128:143], v[56:59], a[148:151], v[128:143]
 buffer_load_dwordx4 v21, s[44:47], s86 offen  lds
 s_add_u32 m0, s84, 62464
 v_mfma_f32_32x32x16_bf16 v[144:159], v[60:63], a[148:151], v[144:159]
 buffer_load_dwordx4 v29, s[44:47], s86 offen  lds
 s_add_u32 m0, s84, 63488
 v_mfma_f32_32x32x16_bf16 v[160:175], v[64:67], a[148:151], v[160:175]
 buffer_load_dwordx4 v30, s[44:47], s86 offen  lds
 s_add_u32 m0, s84, 64512
 v_mfma_f32_32x32x16_bf16 v[176:191], v[68:71], a[148:151], v[176:191]
 buffer_load_dwordx4 v31, s[44:47], s86 offen  lds
 s_add_u32 m0, s84, 65536
 ds_read_b128 a[156:159], v4 offset:4096
 ds_read_b64_tr_b16 v[32:33], v14 offset:35840
 ds_read_b64_tr_b16 v[34:35], v14 offset:37120
 ds_read_b64_tr_b16 v[36:37], v14 offset:35904
 ds_read_b64_tr_b16 v[38:39], v14 offset:37184
 ds_read_b64_tr_b16 v[40:41], v14 offset:35968
 ds_read_b64_tr_b16 v[42:43], v14 offset:37248
 buffer_load_dwordx4 v252, s[44:47], s86 offen  lds
 ds_read_b64_tr_b16 v[44:45], v14 offset:36032
 ds_read_b64_tr_b16 v[46:47], v14 offset:37312
 ds_read_b64_tr_b16 v[48:49], v14 offset:36096
 ds_read_b64_tr_b16 v[50:51], v14 offset:37376
 s_waitcnt lgkmcnt(0)
 s_waitcnt vmcnt(5)
 s_barrier
 v_mfma_f32_32x32x16_bf16 v[112:127], v[72:75], a[152:155], v[112:127]
 ds_read_b64_tr_b16 a[160:161], v18 offset:0
 v_accvgpr_read_b32 v25, a207
 ds_read_b64_tr_b16 a[162:163], v18 offset:1280
 v_mfma_f32_32x32x16_bf16 v[128:143], v[76:79], a[152:155], v[128:143]
 s_lshl_b32 s86, s71, 1
 s_add_u32 s86, s86, s68
 s_add_u32 s86, s86, 8
 s_sub_u32 s74, s86, 20
 s_cmp_ge_u32 s86, 20
 s_cselect_b32 s86, s74, s86
 s_mul_i32 s86, s86, 122880
 s_add_u32 s86, s86, s75
 s_add_u32 m0, s84, 0
 v_accvgpr_read_b32 v27, a208
 v_mfma_f32_32x32x16_bf16 v[144:159], v[80:83], a[152:155], v[144:159]
 ds_read_b64_tr_b16 a[164:165], v18 offset:2560
 ds_read_b64_tr_b16 a[166:167], v18 offset:3840
 v_accvgpr_read_b32 v26, a205
 ds_read_b64_tr_b16 a[168:169], v18 offset:5120
 v_accvgpr_read_b32 v251, a206
 v_mfma_f32_32x32x16_bf16 v[160:175], v[84:87], a[152:155], v[160:175]
 buffer_load_dwordx4 v21, s[44:47], s86 offen  lds
 s_add_u32 m0, s84, 1024
 ds_read_b64_tr_b16 a[170:171], v18 offset:6400
 s_branch pg2_skip
.p2align 12
pg2:
 s_setpc_b64 s[4:5]
 s_nop 0
pg2_skip:
 ds_read_b64_tr_b16 a[172:173], v19 offset:0
 v_mfma_f32_32x32x16_bf16 v[176:191], v[88:91], a[152:155], v[176:191]
 v_accvgpr_read_b32 v16, a204
 ds_read_b64_tr_b16 a[174:175], v19 offset:1280
 v_add_u32 v17, 40960, v16
 ds_read_b64_tr_b16 a[176:177], v19 offset:2560
 v_mfma_f32_32x32x16_bf16 v[112:127], v[32:35], a[156:159], v[112:127]
 buffer_load_dwordx4 v29, s[44:47], s86 offen  lds
 s_add_u32 m0, s84, 2048
 ds_read_b64_tr_b16 a[178:179], v19 offset:3840
 v_accvgpr_read_b32 v1, a225
 v_mfma_f32_32x32x16_bf16 v[128:143], v[36:39], a[156:159], v[128:143]
 ds_read_b64_tr_b16 a[180:181], v19 offset:5120
 v_accvgpr_read_b32 v2, a226
 ds_read_b64_tr_b16 a[182:183], v19 offset:6400
 v_accvgpr_read_b32 v3, a227
 ds_read_b64_tr_b16 a[184:185], v19 offset:7680
 v_mfma_f32_32x32x16_bf16 v[144:159], v[40:43], a[156:159], v[144:159]
 buffer_load_dwordx4 v30, s[44:47], s86 offen  lds
 s_add_u32 m0, s84, 3072
 ds_read_b64_tr_b16 a[186:187], v19 offset:8960
 v_accvgpr_read_b32 v4, a228
 v_mfma_f32_32x32x16_bf16 v[160:175], v[44:47], a[156:159], v[160:175]
 ds_read_b64_tr_b16 a[188:189], v19 offset:10240
 v_accvgpr_read_b32 v5, a229
 ds_read_b64_tr_b16 a[190:191], v19 offset:11520
 v_mfma_f32_32x32x16_bf16 v[176:191], v[48:51], a[156:159], v[176:191]
 buffer_load_dwordx4 v31, s[44:47], s86 offen  lds
 s_add_u32 m0, s84, 4096
 ds_read_b64_tr_b16 a[192:193], v20 offset:5120
 v_lshlrev_b32_e64 v24, 4, v23
 ds_read_b64_tr_b16 a[194:195], v20 offset:6400
 s_mul_i32 s77, s70, 5120
 ds_read_b64_tr_b16 a[196:197], v20 offset:7680
 ds_read_b64_tr_b16 a[198:199], v20 offset:8960
 s_add_u32 s77, s77, s92
 buffer_load_dwordx4 v252, s[44:47], s86 offen  lds
 ds_read_b64_tr_b16 a[200:201], v20 offset:10240
 s_add_u32 s78, s77, 4096
 ds_read_b64_tr_b16 a[202:203], v20 offset:11520
 s_nop 0
 v_cvt_pk_bf16_f32 v32, v112, v113
 v_cvt_pk_bf16_f32 v33, v114, v115
 v_cvt_pk_bf16_f32 v34, v116, v117
 v_cvt_pk_bf16_f32 v35, v118, v119
 v_cvt_pk_bf16_f32 v36, v120, v121
 v_cvt_pk_bf16_f32 v37, v122, v123
 v_cvt_pk_bf16_f32 v38, v124, v125
 v_cvt_pk_bf16_f32 v39, v126, v127
 s_waitcnt lgkmcnt(14)
 v_mfma_f32_32x32x16_bf16 v[192:207], a[160:163], v[32:35], 0
 s_nop 0
 v_cvt_pk_bf16_f32 v40, v128, v129
 v_cvt_pk_bf16_f32 v41, v130, v131
 v_cvt_pk_bf16_f32 v42, v132, v133
 v_cvt_pk_bf16_f32 v43, v134, v135
 v_cvt_pk_bf16_f32 v44, v136, v137
 v_cvt_pk_bf16_f32 v45, v138, v139
 s_waitcnt lgkmcnt(14)
 v_mfma_f32_32x32x16_bf16 v[192:207], a[164:167], v[36:39], v[192:207]
 s_nop 0
 v_cvt_pk_bf16_f32 v46, v140, v141
 v_cvt_pk_bf16_f32 v47, v142, v143
 v_cvt_pk_bf16_f32 v48, v144, v145
 v_cvt_pk_bf16_f32 v49, v146, v147
 v_cvt_pk_bf16_f32 v50, v148, v149
 v_cvt_pk_bf16_f32 v51, v150, v151
 s_waitcnt lgkmcnt(14)
 v_mfma_f32_32x32x16_bf16 v[192:207], a[168:171], v[40:43], v[192:207]
 v_cvt_pk_bf16_f32 v240, v152, v153
 v_cvt_pk_bf16_f32 v241, v154, v155
 ds_write_b64 v25, v[240:241] offset:0
 s_waitcnt lgkmcnt(14)
 v_mfma_f32_32x32x16_bf16 v[208:223], a[172:175], v[32:35], 0
 v_cvt_pk_bf16_f32 v242, v156, v157
 v_cvt_pk_bf16_f32 v243, v158, v159
 ds_write_b64 v27, v[242:243] offset:0
 s_waitcnt lgkmcnt(14)
 v_mfma_f32_32x32x16_bf16 v[208:223], a[176:179], v[36:39], v[208:223]
 v_cvt_pk_bf16_f32 v244, v160, v161
 v_cvt_pk_bf16_f32 v245, v162, v163
 ds_write_b64 v25, v[244:245] offset:32
 s_waitcnt lgkmcnt(13)
 v_mfma_f32_32x32x16_bf16 v[208:223], a[180:183], v[40:43], v[208:223]
 v_cvt_pk_bf16_f32 v246, v164, v165
 v_cvt_pk_bf16_f32 v247, v166, v167
 ds_write_b64 v27, v[246:247] offset:32
 s_waitcnt lgkmcnt(12)
 v_mfma_f32_32x32x16_bf16 v[208:223], a[184:187], v[44:47], v[208:223]
 v_cvt_pk_bf16_f32 v240, v168, v169
 v_cvt_pk_bf16_f32 v241, v170, v171
 ds_write_b64 v25, v[240:241] offset:64
 s_waitcnt lgkmcnt(11)
 v_mfma_f32_32x32x16_bf16 v[208:223], a[188:191], v[48:51], v[208:223]
 v_cvt_pk_bf16_f32 v242, v172, v173
 v_cvt_pk_bf16_f32 v243, v174, v175
 ds_write_b64 v27, v[242:243] offset:64
 s_waitcnt lgkmcnt(10)
 v_mfma_f32_32x32x16_bf16 v[224:239], a[192:195], v[40:43], 0
 v_cvt_pk_bf16_f32 v244, v176, v177
 v_cvt_pk_bf16_f32 v245, v178, v179
 ds_write_b64 v25, v[244:245] offset:96
 s_waitcnt lgkmcnt(9)
 v_mfma_f32_32x32x16_bf16 v[224:239], a[196:199], v[44:47], v[224:239]
 v_cvt_pk_bf16_f32 v246, v180, v181
 v_cvt_pk_bf16_f32 v247, v182, v183
 ds_write_b64 v27, v[246:247] offset:96
 s_waitcnt lgkmcnt(8)
 v_mfma_f32_32x32x16_bf16 v[224:239], a[200:203], v[48:51], v[224:239]
 v_cvt_pk_bf16_f32 v240, v184, v185
 v_cvt_pk_bf16_f32 v241, v186, v187
 ds_write_b64 v25, v[240:241] offset:128
 v_cvt_pk_bf16_f32 v242, v188, v189
 v_cvt_pk_bf16_f32 v243, v190, v191
 ds_write_b64 v27, v[242:243] offset:128
 s_nop 0
 v_max3_f32 v96, v192, v193, v194
 v_min3_f32 v98, v192, v193, v194
 v_max3_f32 v96, v96, v195, v196
 v_min3_f32 v98, v98, v195, v196
 v_max3_f32 v96, v96, v197, v198
 v_min3_f32 v98, v98, v197, v198
 v_max3_f32 v96, v96, v199, v200
 v_min3_f32 v98, v98, v199, v200
 v_max3_f32 v96, v96, v201, v202
 v_min3_f32 v98, v98, v201, v202
 v_max3_f32 v96, v96, v203, v204
 v_min3_f32 v98, v98, v203, v204
 v_max3_f32 v96, v96, v205, v206
 v_min3_f32 v98, v98, v205, v206
 v_max3_f32 v96, v96, v207, v208
 v_min3_f32 v98, v98, v207, v208
 v_max3_f32 v96, v96, v209, v210
 v_min3_f32 v98, v98, v209, v210
 v_max_f32 v96, v96, v211
 v_min_f32 v98, v98, v211
 v_mul_f32 v96, s88, v96
 v_mul_f32 v98, s88, v98
 v_pk_fma_f32 v[56:57], v[192:193], s[88:89], v[96:97] op_sel_hi:[1,1,0] neg_lo:[0,0,1] neg_hi:[0,0,1]
 v_pk_fma_f32 v[76:77], v[192:193], s[88:89], v[98:99] op_sel_hi:[1,1,0] neg_lo:[1,0,0] neg_hi:[1,0,0]
 v_pk_fma_f32 v[58:59], v[194:195], s[88:89], v[96:97] op_sel_hi:[1,1,0] neg_lo:[0,0,1] neg_hi:[0,0,1]
 v_pk_fma_f32 v[78:79], v[194:195], s[88:89], v[98:99] op_sel_hi:[1,1,0] neg_lo:[1,0,0] neg_hi:[1,0,0]
 v_pk_fma_f32 v[60:61], v[196:197], s[88:89], v[96:97] op_sel_hi:[1,1,0] neg_lo:[0,0,1] neg_hi:[0,0,1]
 v_pk_fma_f32 v[80:81], v[196:197], s[88:89], v[98:99] op_sel_hi:[1,1,0] neg_lo:[1,0,0] neg_hi:[1,0,0]
 v_pk_fma_f32 v[62:63], v[198:199], s[88:89], v[96:97] op_sel_hi:[1,1,0] neg_lo:[0,0,1] neg_hi:[0,0,1]
 v_pk_fma_f32 v[82:83], v[198:199], s[88:89], v[98:99] op_sel_hi:[1,1,0] neg_lo:[1,0,0] neg_hi:[1,0,0]
 v_pk_fma_f32 v[64:65], v[200:201], s[88:89], v[96:97] op_sel_hi:[1,1,0] neg_lo:[0,0,1] neg_hi:[0,0,1]
 v_pk_fma_f32 v[84:85], v[200:201], s[88:89], v[98:99] op_sel_hi:[1,1,0] neg_lo:[1,0,0] neg_hi:[1,0,0]
 v_pk_fma_f32 v[66:67], v[202:203], s[88:89], v[96:97] op_sel_hi:[1,1,0] neg_lo:[0,0,1] neg_hi:[0,0,1]
 v_pk_fma_f32 v[86:87], v[202:203], s[88:89], v[98:99] op_sel_hi:[1,1,0] neg_lo:[1,0,0] neg_hi:[1,0,0]
 v_pk_fma_f32 v[68:69], v[204:205], s[88:89], v[96:97] op_sel_hi:[1,1,0] neg_lo:[0,0,1] neg_hi:[0,0,1]
 v_pk_fma_f32 v[88:89], v[204:205], s[88:89], v[98:99] op_sel_hi:[1,1,0] neg_lo:[1,0,0] neg_hi:[1,0,0]
 v_pk_fma_f32 v[70:71], v[206:207], s[88:89], v[96:97] op_sel_hi:[1,1,0] neg_lo:[0,0,1] neg_hi:[0,0,1]
 v_pk_fma_f32 v[90:91], v[206:207], s[88:89], v[98:99] op_sel_hi:[1,1,0] neg_lo:[1,0,0] neg_hi:[1,0,0]
 v_pk_fma_f32 v[72:73], v[208:209], s[88:89], v[96:97] op_sel_hi:[1,1,0] neg_lo:[0,0,1] neg_hi:[0,0,1]
 v_pk_fma_f32 v[92:93], v[208:209], s[88:89], v[98:99] op_sel_hi:[1,1,0] neg_lo:[1,0,0] neg_hi:[1,0,0]
 v_pk_fma_f32 v[74:75], v[210:211], s[88:89], v[96:97] op_sel_hi:[1,1,0] neg_lo:[0,0,1] neg_hi:[0,0,1]
 v_pk_fma_f32 v[94:95], v[210:211], s[88:89], v[98:99] op_sel_hi:[1,1,0] neg_lo:[1,0,0] neg_hi:[1,0,0]
 v_exp_f32 v56, v56
 v_exp_f32 v57, v57
 v_exp_f32 v58, v58
 v_exp_f32 v59, v59
 v_exp_f32 v60, v60
 v_exp_f32 v61, v61
 v_mov_b32 v244, -1
 v_mov_b32 v245, -1
 v_mov_b32 v246, -1
 v_mov_b32 v247, -1
 v_exp_f32 v62, v62
 v_exp_f32 v63, v63
 v_exp_f32 v64, v64
 v_exp_f32 v65, v65
 v_exp_f32 v66, v66
 v_exp_f32 v67, v67
 buffer_store_dwordx4 v[244:247], v24, s[52:55], s77 offen offset:0 sc1
 v_exp_f32 v68, v68
 v_exp_f32 v69, v69
 v_exp_f32 v70, v70
 v_exp_f32 v71, v71
 v_exp_f32 v72, v72
 v_exp_f32 v73, v73
 buffer_store_dwordx4 v[244:247], v24, s[52:55], s77 offen offset:1024 sc1
 v_exp_f32 v74, v74
 v_exp_f32 v75, v75
 v_exp_f32 v76, v76
 v_exp_f32 v77, v77
 v_exp_f32 v78, v78
 v_exp_f32 v79, v79
 buffer_store_dwordx4 v[244:247], v24, s[52:55], s77 offen offset:2048 sc1
 v_exp_f32 v80, v80
 v_exp_f32 v81, v81
 v_exp_f32 v82, v82
 v_exp_f32 v83, v83
 v_exp_f32 v84, v84
 v_exp_f32 v85, v85
 buffer_store_dwordx4 v[244:247], v24, s[52:55], s77 offen offset:3072 sc1
 v_exp_f32 v86, v86
 v_exp_f32 v87, v87
 v_exp_f32 v88, v88
 v_exp_f32 v89, v89
 v_exp_f32 v90, v90
 v_exp_f32 v91, v91
 buffer_store_dwordx4 v[244:247], v24, s[52:55], s78 offen offset:0 sc1
 v_exp_f32 v92, v92
 v_exp_f32 v93, v93
 v_exp_f32 v94, v94
 v_exp_f32 v95, v95
 v_pk_add_f32 v[100:101], v[56:57], v[58:59]
 v_pk_add_f32 v[102:103], v[76:77], v[78:79]
 v_pk_add_f32 v[100:101], v[100:101], v[60:61]
 v_pk_add_f32 v[102:103], v[102:103], v[80:81]
 v_pk_add_f32 v[100:101], v[100:101], v[62:63]
 v_pk_add_f32 v[102:103], v[102:103], v[82:83]
 v_pk_add_f32 v[100:101], v[100:101], v[64:65]
 v_pk_add_f32 v[102:103], v[102:103], v[84:85]
 v_pk_add_f32 v[100:101], v[100:101], v[66:67]
 v_pk_add_f32 v[102:103], v[102:103], v[86:87]
 v_pk_add_f32 v[100:101], v[100:101], v[68:69]
 v_pk_add_f32 v[102:103], v[102:103], v[88:89]
 v_pk_add_f32 v[100:101], v[100:101], v[70:71]
 v_pk_add_f32 v[102:103], v[102:103], v[90:91]
 v_pk_add_f32 v[100:101], v[100:101], v[72:73]
 v_pk_add_f32 v[102:103], v[102:103], v[92:93]
 v_pk_add_f32 v[100:101], v[100:101], v[74:75]
 v_pk_add_f32 v[102:103], v[102:103], v[94:95]
 v_add_f32 v100, v100, v101
 v_add_f32 v102, v102, v103
 v_rcp_f32 v100, v100
 v_rcp_f32 v102, v102
 v_pk_mul_f32 v[56:57], v[56:57], v[100:101] op_sel_hi:[1,0]
 v_pk_mul_f32 v[58:59], v[58:59], v[100:101] op_sel_hi:[1,0]
 v_pk_mul_f32 v[60:61], v[60:61], v[100:101] op_sel_hi:[1,0]
 v_pk_mul_f32 v[62:63], v[62:63], v[100:101] op_sel_hi:[1,0]
 v_pk_mul_f32 v[64:65], v[64:65], v[100:101] op_sel_hi:[1,0]
 v_pk_mul_f32 v[66:67], v[66:67], v[100:101] op_sel_hi:[1,0]
 v_pk_mul_f32 v[68:69], v[68:69], v[100:101] op_sel_hi:[1,0]
 v_pk_mul_f32 v[70:71], v[70:71], v[100:101] op_sel_hi:[1,0]
 v_pk_mul_f32 v[72:73], v[72:73], v[100:101] op_sel_hi:[1,0]
 v_pk_mul_f32 v[74:75], v[74:75], v[100:101] op_sel_hi:[1,0]
 v_pk_mul_f32 v[76:77], v[76:77], v[102:103] op_sel_hi:[1,0]
 v_pk_mul_f32 v[78:79], v[78:79], v[102:103] op_sel_hi:[1,0]
 v_pk_mul_f32 v[80:81], v[80:81], v[102:103] op_sel_hi:[1,0]
 v_pk_mul_f32 v[82:83], v[82:83], v[102:103] op_sel_hi:[1,0]
 v_pk_mul_f32 v[84:85], v[84:85], v[102:103] op_sel_hi:[1,0]
 v_pk_mul_f32 v[86:87], v[86:87], v[102:103] op_sel_hi:[1,0]
 v_pk_mul_f32 v[88:89], v[88:89], v[102:103] op_sel_hi:[1,0]
 v_pk_mul_f32 v[90:91], v[90:91], v[102:103] op_sel_hi:[1,0]
 v_pk_mul_f32 v[92:93], v[92:93], v[102:103] op_sel_hi:[1,0]
 v_pk_mul_f32 v[94:95], v[94:95], v[102:103] op_sel_hi:[1,0]
 v_cvt_pk_bf16_f32 v160, v56, v57
 v_cvt_pk_bf16_f32 v161, v58, v59
 v_cvt_pk_bf16_f32 v162, v60, v61
 v_cvt_pk_bf16_f32 v163, v62, v63
 v_cvt_pk_bf16_f32 v164, v64, v65
 v_cvt_pk_bf16_f32 v165, v66, v67
 v_cvt_pk_bf16_f32 v166, v68, v69
 v_cvt_pk_bf16_f32 v167, v70, v71
 v_cvt_pk_bf16_f32 v168, v72, v73
 v_cvt_pk_bf16_f32 v169, v74, v75
 v_cvt_pk_bf16_f32 v170, v76, v77
 v_cvt_pk_bf16_f32 v171, v78, v79
 v_cvt_pk_bf16_f32 v172, v80, v81
 v_cvt_pk_bf16_f32 v173, v82, v83
 v_cvt_pk_bf16_f32 v174, v84, v85
 v_cvt_pk_bf16_f32 v175, v86, v87
 v_cvt_pk_bf16_f32 v176, v88, v89
 v_cvt_pk_bf16_f32 v177, v90, v91
 v_cvt_pk_bf16_f32 v178, v92, v93
 v_cvt_pk_bf16_f32 v179, v94, v95
 v_max3_f32 v104, v212, v213, v214
 v_min3_f32 v106, v212, v213, v214
 v_max3_f32 v104, v104, v215, v216
 v_min3_f32 v106, v106, v215, v216
 v_max3_f32 v104, v104, v217, v218
 v_min3_f32 v106, v106, v217, v218
 v_max3_f32 v104, v104, v219, v220
 v_min3_f32 v106, v106, v219, v220
 v_max3_f32 v104, v104, v221, v222
 v_min3_f32 v106, v106, v221, v222
 v_max3_f32 v104, v104, v223, v224
 v_min3_f32 v106, v106, v223, v224
 v_max3_f32 v104, v104, v225, v226
 v_min3_f32 v106, v106, v225, v226
 v_max3_f32 v104, v104, v227, v228
 v_min3_f32 v106, v106, v227, v228
 v_max3_f32 v104, v104, v229, v230
 v_min3_f32 v106, v106, v229, v230
 v_max_f32 v104, v104, v231
 v_min_f32 v106, v106, v231
 v_mul_f32 v104, s88, v104
 v_mul_f32 v106, s88, v106
 v_pk_fma_f32 v[56:57], v[212:213], s[88:89], v[104:105] op_sel_hi:[1,1,0] neg_lo:[0,0,1] neg_hi:[0,0,1]
 v_pk_fma_f32 v[76:77], v[212:213], s[88:89], v[106:107] op_sel_hi:[1,1,0] neg_lo:[1,0,0] neg_hi:[1,0,0]
 v_pk_fma_f32 v[58:59], v[214:215], s[88:89], v[104:105] op_sel_hi:[1,1,0] neg_lo:[0,0,1] neg_hi:[0,0,1]
 v_pk_fma_f32 v[78:79], v[214:215], s[88:89], v[106:107] op_sel_hi:[1,1,0] neg_lo:[1,0,0] neg_hi:[1,0,0]
 v_pk_fma_f32 v[60:61], v[216:217], s[88:89], v[104:105] op_sel_hi:[1,1,0] neg_lo:[0,0,1] neg_hi:[0,0,1]
 v_pk_fma_f32 v[80:81], v[216:217], s[88:89], v[106:107] op_sel_hi:[1,1,0] neg_lo:[1,0,0] neg_hi:[1,0,0]
 v_pk_fma_f32 v[62:63], v[218:219], s[88:89], v[104:105] op_sel_hi:[1,1,0] neg_lo:[0,0,1] neg_hi:[0,0,1]
 v_pk_fma_f32 v[82:83], v[218:219], s[88:89], v[106:107] op_sel_hi:[1,1,0] neg_lo:[1,0,0] neg_hi:[1,0,0]
 v_pk_fma_f32 v[64:65], v[220:221], s[88:89], v[104:105] op_sel_hi:[1,1,0] neg_lo:[0,0,1] neg_hi:[0,0,1]
 v_pk_fma_f32 v[84:85], v[220:221], s[88:89], v[106:107] op_sel_hi:[1,1,0] neg_lo:[1,0,0] neg_hi:[1,0,0]
 v_pk_fma_f32 v[66:67], v[222:223], s[88:89], v[104:105] op_sel_hi:[1,1,0] neg_lo:[0,0,1] neg_hi:[0,0,1]
 v_pk_fma_f32 v[86:87], v[222:223], s[88:89], v[106:107] op_sel_hi:[1,1,0] neg_lo:[1,0,0] neg_hi:[1,0,0]
 v_pk_fma_f32 v[68:69], v[224:225], s[88:89], v[104:105] op_sel_hi:[1,1,0] neg_lo:[0,0,1] neg_hi:[0,0,1]
 v_pk_fma_f32 v[88:89], v[224:225], s[88:89], v[106:107] op_sel_hi:[1,1,0] neg_lo:[1,0,0] neg_hi:[1,0,0]
 v_pk_fma_f32 v[70:71], v[226:227], s[88:89], v[104:105] op_sel_hi:[1,1,0] neg_lo:[0,0,1] neg_hi:[0,0,1]
 v_pk_fma_f32 v[90:91], v[226:227], s[88:89], v[106:107] op_sel_hi:[1,1,0] neg_lo:[1,0,0] neg_hi:[1,0,0]
 v_pk_fma_f32 v[72:73], v[228:229], s[88:89], v[104:105] op_sel_hi:[1,1,0] neg_lo:[0,0,1] neg_hi:[0,0,1]
 v_pk_fma_f32 v[92:93], v[228:229], s[88:89], v[106:107] op_sel_hi:[1,1,0] neg_lo:[1,0,0] neg_hi:[1,0,0]
 v_pk_fma_f32 v[74:75], v[230:231], s[88:89], v[104:105] op_sel_hi:[1,1,0] neg_lo:[0,0,1] neg_hi:[0,0,1]
 v_pk_fma_f32 v[94:95], v[230:231], s[88:89], v[106:107] op_sel_hi:[1,1,0] neg_lo:[1,0,0] neg_hi:[1,0,0]
 v_exp_f32 v56, v56
 v_exp_f32 v57, v57
 v_exp_f32 v58, v58
 v_exp_f32 v59, v59
 v_exp_f32 v60, v60
 v_exp_f32 v61, v61
 v_exp_f32 v62, v62
 v_exp_f32 v63, v63
 v_exp_f32 v64, v64
 v_exp_f32 v65, v65
 v_exp_f32 v66, v66
 v_exp_f32 v67, v67
 v_exp_f32 v68, v68
 v_exp_f32 v69, v69
 v_exp_f32 v70, v70
 v_exp_f32 v71, v71
 v_exp_f32 v72, v72
 v_exp_f32 v73, v73
 v_exp_f32 v74, v74
 v_exp_f32 v75, v75
 v_exp_f32 v76, v76
 v_exp_f32 v77, v77
 v_exp_f32 v78, v78
 v_exp_f32 v79, v79
 v_exp_f32 v80, v80
 v_exp_f32 v81, v81
 v_exp_f32 v82, v82
 v_exp_f32 v83, v83
 v_exp_f32 v84, v84
 v_exp_f32 v85, v85
 v_exp_f32 v86, v86
 v_exp_f32 v87, v87
 v_exp_f32 v88, v88
 v_exp_f32 v89, v89
 v_exp_f32 v90, v90
 v_exp_f32 v91, v91
 v_exp_f32 v92, v92
 v_exp_f32 v93, v93
 v_exp_f32 v94, v94
 v_exp_f32 v95, v95
 v_pk_add_f32 v[108:109], v[56:57], v[58:59]
 v_pk_add_f32 v[110:111], v[76:77], v[78:79]
 v_pk_add_f32 v[108:109], v[108:109], v[60:61]
 v_pk_add_f32 v[110:111], v[110:111], v[80:81]
 v_pk_add_f32 v[108:109], v[108:109], v[62:63]
 v_pk_add_f32 v[110:111], v[110:111], v[82:83]
 v_pk_add_f32 v[108:109], v[108:109], v[64:65]
 v_pk_add_f32 v[110:111], v[110:111], v[84:85]
 v_pk_add_f32 v[108:109], v[108:109], v[66:67]
 v_pk_add_f32 v[110:111], v[110:111], v[86:87]
 v_pk_add_f32 v[108:109], v[108:109], v[68:69]
 v_pk_add_f32 v[110:111], v[110:111], v[88:89]
 v_pk_add_f32 v[108:109], v[108:109], v[70:71]
 v_pk_add_f32 v[110:111], v[110:111], v[90:91]
 v_pk_add_f32 v[108:109], v[108:109], v[72:73]
 v_pk_add_f32 v[110:111], v[110:111], v[92:93]
 v_pk_add_f32 v[108:109], v[108:109], v[74:75]
 v_pk_add_f32 v[110:111], v[110:111], v[94:95]
 v_add_f32 v108, v108, v109
 v_add_f32 v110, v110, v111
 v_rcp_f32 v108, v108
 v_rcp_f32 v110, v110
 v_pk_mul_f32 v[56:57], v[56:57], v[108:109] op_sel_hi:[1,0]
 v_pk_mul_f32 v[58:59], v[58:59], v[108:109] op_sel_hi:[1,0]
 v_pk_mul_f32 v[60:61], v[60:61], v[108:109] op_sel_hi:[1,0]
 v_pk_mul_f32 v[62:63], v[62:63], v[108:109] op_sel_hi:[1,0]
 v_pk_mul_f32 v[64:65], v[64:65], v[108:109] op_sel_hi:[1,0]
 v_pk_mul_f32 v[66:67], v[66:67], v[108:109] op_sel_hi:[1,0]
 v_pk_mul_f32 v[68:69], v[68:69], v[108:109] op_sel_hi:[1,0]
 v_pk_mul_f32 v[70:71], v[70:71], v[108:109] op_sel_hi:[1,0]
 v_pk_mul_f32 v[72:73], v[72:73], v[108:109] op_sel_hi:[1,0]
 v_pk_mul_f32 v[74:75], v[74:75], v[108:109] op_sel_hi:[1,0]
 v_pk_mul_f32 v[76:77], v[76:77], v[110:111] op_sel_hi:[1,0]
 v_pk_mul_f32 v[78:79], v[78:79], v[110:111] op_sel_hi:[1,0]
 v_pk_mul_f32 v[80:81], v[80:81], v[110:111] op_sel_hi:[1,0]
 v_pk_mul_f32 v[82:83], v[82:83], v[110:111] op_sel_hi:[1,0]
 v_pk_mul_f32 v[84:85], v[84:85], v[110:111] op_sel_hi:[1,0]
 v_pk_mul_f32 v[86:87], v[86:87], v[110:111] op_sel_hi:[1,0]
 v_pk_mul_f32 v[88:89], v[88:89], v[110:111] op_sel_hi:[1,0]
 v_pk_mul_f32 v[90:91], v[90:91], v[110:111] op_sel_hi:[1,0]
 v_pk_mul_f32 v[92:93], v[92:93], v[110:111] op_sel_hi:[1,0]
 v_pk_mul_f32 v[94:95], v[94:95], v[110:111] op_sel_hi:[1,0]
 ds_read_b64_tr_b16 v[32:33], v17 offset:0
 ds_read_b64_tr_b16 v[34:35], v17 offset:160
 ds_read_b64_tr_b16 v[36:37], v17 offset:64
 ds_read_b64_tr_b16 v[38:39], v17 offset:224
 ds_read_b64_tr_b16 v[40:41], v17 offset:128
 ds_read_b64_tr_b16 v[42:43], v17 offset:288
 v_cvt_pk_bf16_f32 v180, v56, v57
 v_cvt_pk_bf16_f32 v181, v58, v59
 v_cvt_pk_bf16_f32 v182, v60, v61
 v_cvt_pk_bf16_f32 v183, v62, v63
 v_cvt_pk_bf16_f32 v184, v64, v65
 v_cvt_pk_bf16_f32 v185, v66, v67
 v_cvt_pk_bf16_f32 v186, v68, v69
 v_cvt_pk_bf16_f32 v187, v70, v71
 v_cvt_pk_bf16_f32 v188, v72, v73
 v_cvt_pk_bf16_f32 v189, v74, v75
 v_cvt_pk_bf16_f32 v190, v76, v77
 v_cvt_pk_bf16_f32 v191, v78, v79
 v_cvt_pk_bf16_f32 v192, v80, v81
 v_cvt_pk_bf16_f32 v193, v82, v83
 v_cvt_pk_bf16_f32 v194, v84, v85
 v_cvt_pk_bf16_f32 v195, v86, v87
 v_cvt_pk_bf16_f32 v196, v88, v89
 v_cvt_pk_bf16_f32 v197, v90, v91
 v_cvt_pk_bf16_f32 v198, v92, v93
 v_cvt_pk_bf16_f32 v199, v94, v95
 ds_read_b64_tr_b16 v[44:45], v17 offset:2560
 ds_read_b64_tr_b16 v[46:47], v17 offset:2720
 ds_read_b64_tr_b16 v[48:49], v17 offset:2624
 ds_read_b64_tr_b16 v[50:51], v17 offset:2784
 ds_read_b64_tr_b16 v[52:53], v17 offset:2688
 ds_read_b64_tr_b16 v[54:55], v17 offset:2848
 v_readfirstlane_b32 s95, v250
 s_mov_b32 s94, 400000
 s_cmp_ge_u32 s95, 32
 s_cbranch_scc1 a_pz_x
a_pz:
 buffer_load_dword v250, v22, s[60:63], 0 offen sc1
 s_sub_u32 s94, s94, 1
 s_waitcnt vmcnt(0)
 v_readfirstlane_b32 s95, v250
 s_cmp_eq_u32 s94, 0
 s_cbranch_scc1 a_pz_x
 s_cmp_ge_u32 s95, 32
 s_cbranch_scc0 a_pz
a_pz_x:
 s_waitcnt lgkmcnt(6)
 v_mfma_f32_32x32x16_bf16 v[112:127], v[32:35], a[0:3], 0
 ds_read_b64_tr_b16 v[56:57], v17 offset:5120
 ds_read_b64_tr_b16 v[58:59], v17 offset:5280
 ds_write_b128 v26, v[160:163] offset:0
 v_mfma_f32_32x32x16_bf16 v[128:143], v[36:39], a[0:3], 0
 ds_read_b64_tr_b16 v[60:61], v17 offset:5184
 ds_read_b64_tr_b16 v[62:63], v17 offset:5344
 ds_write_b128 v251, v[164:167] offset:0
 v_mfma_f32_32x32x16_bf16 v[144:159], v[40:43], a[0:3], 0
 ds_read_b64_tr_b16 v[64:65], v17 offset:5248
 ds_read_b64_tr_b16 v[66:67], v17 offset:5408
 v_accvgpr_read_b32 v24, a209
 s_waitcnt lgkmcnt(8)
 v_mfma_f32_32x32x16_bf16 v[112:127], v[44:47], a[4:7], v[112:127]
 ds_write_b128 v26, v[168:171] offset:32
 v_accvgpr_read_b32 v25, a210
 v_accvgpr_read_b32 v27, a211
 v_mfma_f32_32x32x16_bf16 v[128:143], v[48:51], a[4:7], v[128:143]
 ds_write_b128 v251, v[172:175] offset:32
 v_mov_b32 v28, 0x3f803f80
 v_mfma_f32_32x32x16_bf16 v[144:159], v[52:55], a[4:7], v[144:159]
 ds_write_b128 v26, v[176:179] offset:64
 v_accvgpr_read_b32 v240, a212
 v_accvgpr_read_b32 v241, a213
 ds_read_b64_tr_b16 v[32:33], v17 offset:7680
 ds_write_b128 v26, v[180:183] offset:160
 v_accvgpr_read_b32 v242, a214
 ds_read_b64_tr_b16 v[34:35], v17 offset:7840
 v_accvgpr_read_b32 v243, a215
 ds_write_b128 v251, v[184:187] offset:160
 ds_read_b64_tr_b16 v[36:37], v17 offset:7744
 v_accvgpr_read_b32 v244, a216
 ds_write_b128 v26, v[188:191] offset:192
 s_lshl_b32 s78, s70, 2
 ds_read_b64_tr_b16 v[38:39], v17 offset:7904
 s_add_u32 s78, s78, s68
 ds_write_b128 v251, v[192:195] offset:192
 ds_read_b64_tr_b16 v[40:41], v17 offset:7808
 s_lshl_b32 s78, s78, 12
 ds_write_b128 v26, v[196:199] offset:224
 ds_read_b64_tr_b16 v[42:43], v17 offset:7968
 s_add_u32 s78, s78, 0
 s_waitcnt lgkmcnt(0)
 s_barrier
 ds_read_b64_tr_b16 v[76:77], v27 offset:0
 ds_read_b64_tr_b16 v[78:79], v27 offset:2560
 ds_read_b64_tr_b16 v[72:73], v25 offset:0
 ds_read_b64_tr_b16 v[74:75], v25 offset:2560
 ds_read_b64_tr_b16 v[80:81], v24 offset:0
 ds_read_b64_tr_b16 v[82:83], v24 offset:5632
 ds_read_b64_tr_b16 v[84:85], v24 offset:32
 ds_read_b64_tr_b16 v[86:87], v24 offset:5664
 ds_read_b64_tr_b16 v[88:89], v24 offset:64
 ds_read_b64_tr_b16 v[90:91], v24 offset:5696
 ds_read_b64_tr_b16 v[96:97], v27 offset:5120
 ds_read_b64_tr_b16 v[98:99], v27 offset:7680
 ds_read_b64_tr_b16 v[92:93], v25 offset:5120
 ds_read_b64_tr_b16 v[94:95], v25 offset:7680
 ds_read_b64_tr_b16 v[100:101], v24 offset:11264
 ds_read_b64_tr_b16 v[102:103], v24 offset:16896
 ds_read_b64_tr_b16 v[104:105], v24 offset:11296
 ds_read_b64_tr_b16 v[106:107], v24 offset:16928
 ds_read_b64_tr_b16 v[108:109], v24 offset:11328
 ds_read_b64_tr_b16 v[110:111], v24 offset:16960
 v_mfma_f32_32x32x16_bf16 v[112:127], v[56:59], a[8:11], v[112:127]
 ds_read_b64_tr_b16 v[44:45], v17 offset:10240
 ds_read_b64_tr_b16 v[46:47], v17 offset:10400
 v_mfma_f32_32x32x16_bf16 v[128:143], v[60:63], a[8:11], v[128:143]
 ds_read_b64_tr_b16 v[48:49], v17 offset:10304
 ds_read_b64_tr_b16 v[50:51], v17 offset:10464
 v_mfma_f32_32x32x16_bf16 v[144:159], v[64:67], a[8:11], v[144:159]
 ds_read_b64_tr_b16 v[52:53], v17 offset:10368
 ds_read_b64_tr_b16 v[54:55], v17 offset:10528
 s_waitcnt lgkmcnt(14)
 v_cndmask_b32 v76, v28, v76, s[90:91]
 v_cndmask_b32 v77, v28, v77, s[90:91]
 v_cndmask_b32 v78, v28, v78, s[90:91]
 v_cndmask_b32 v79, v28, v79, s[90:91]
 v_mfma_f32_16x16x32_bf16 v[200:203], v[72:75], v[80:83], 0
 ds_read_b64_tr_b16 v[164:165], v27 offset:10240
 ds_read_b64_tr_b16 v[166:167], v27 offset:12800
 v_mfma_f32_16x16x32_bf16 v[204:207], v[72:75], v[84:87], 0
 ds_read_b64_tr_b16 v[160:161], v25 offset:10240
 ds_read_b64_tr_b16 v[162:163], v25 offset:12800
 v_mfma_f32_16x16x32_bf16 v[208:211], v[72:75], v[88:91], 0
 ds_read_b64_tr_b16 v[168:169], v24 offset:22528
 v_mfma_f32_16x16x32_bf16 v[212:215], v[76:79], v[80:83], 0
 ds_read_b64_tr_b16 v[170:171], v24 offset:28160
 ds_read_b64_tr_b16 v[172:173], v24 offset:22560
 v_mfma_f32_16x16x32_bf16 v[216:219], v[76:79], v[84:87], 0
 ds_read_b64_tr_b16 v[174:175], v24 offset:28192
 ds_read_b64_tr_b16 v[176:177], v24 offset:22592
 v_mfma_f32_16x16x32_bf16 v[220:223], v[76:79], v[88:91], 0
 ds_read_b64_tr_b16 v[178:179], v24 offset:28224
 ds_read_b64_tr_b16 v[184:185], v27 offset:15360
 s_waitcnt lgkmcnt(14)
 v_cndmask_b32 v96, v28, v96, s[90:91]
 v_cndmask_b32 v97, v28, v97, s[90:91]
 v_cndmask_b32 v98, v28, v98, s[90:91]
 v_cndmask_b32 v99, v28, v99, s[90:91]
 v_mfma_f32_16x16x32_bf16 v[200:203], v[92:95], v[100:103], v[200:203]
 ds_read_b64_tr_b16 v[186:187], v27 offset:17920
 ds_read_b64_tr_b16 v[180:181], v25 offset:15360
 v_mfma_f32_16x16x32_bf16 v[204:207], v[92:95], v[104:107], v[204:207]
 ds_read_b64_tr_b16 v[182:183], v25 offset:17920
 ds_read_b64_tr_b16 v[188:189], v24 offset:33792
 v_mfma_f32_16x16x32_bf16 v[208:211], v[92:95], v[108:111], v[208:211]
 ds_read_b64_tr_b16 v[190:191], v24 offset:39424
 v_mfma_f32_16x16x32_bf16 v[212:215], v[96:99], v[100:103], v[212:215]
 ds_read_b64_tr_b16 v[192:193], v24 offset:33824
 ds_read_b64_tr_b16 v[194:195], v24 offset:39456
 v_mfma_f32_16x16x32_bf16 v[216:219], v[96:99], v[104:107], v[216:219]
 ds_read_b64_tr_b16 v[196:197], v24 offset:33856
 ds_read_b64_tr_b16 v[198:199], v24 offset:39488
 v_mfma_f32_16x16x32_bf16 v[220:223], v[96:99], v[108:111], v[220:223]
 s_waitcnt lgkmcnt(10)
 v_cndmask_b32 v164, v28, v164, s[90:91]
 v_cndmask_b32 v165, v28, v165, s[90:91]
 v_cndmask_b32 v166, v28, v166, s[90:91]
 v_cndmask_b32 v167, v28, v167, s[90:91]
 v_mfma_f32_16x16x32_bf16 v[200:203], v[160:163], v[168:171], v[200:203]
 s_lshl_b32 s86, s71, 1
 s_add_u32 s86, s86, s68
 s_add_u32 s86, s86, 12
 s_sub_u32 s74, s86, 20
 s_cmp_ge_u32 s86, 20
 s_cselect_b32 s86, s74, s86
 s_mul_i32 s86, s86, 122880
 s_add_u32 s86, s86, s75
 s_add_u32 m0, s84, 20480
 v_mfma_f32_16x16x32_bf16 v[204:207], v[160:163], v[172:175], v[204:207]
 v_mfma_f32_16x16x32_bf16 v[208:211], v[160:163], v[176:179], v[208:211]
 buffer_load_dwordx4 v21, s[44:47], s86 offen  lds
 s_branch pg3_skip
.p2align 12
pg3:
 s_setpc_b64 s[4:5]
 s_nop 0
pg3_skip:
 s_add_u32 m0, s84, 21504
 v_mfma_f32_16x16x32_bf16 v[212:215], v[164:167], v[168:171], v[212:215]
 v_mfma_f32_16x16x32_bf16 v[216:219], v[164:167], v[172:175], v[216:219]
 buffer_load_dwordx4 v29, s[44:47], s86 offen  lds
 s_add_u32 m0, s84, 22528
 v_mfma_f32_16x16x32_bf16 v[220:223], v[164:167], v[176:179], v[220:223]
 s_waitcnt lgkmcnt(0)
 v_cndmask_b32 v184, v28, v184, s[90:91]
 v_cndmask_b32 v185, v28, v185, s[90:91]
 v_cndmask_b32 v186, v28, v186, s[90:91]
 v_cndmask_b32 v187, v28, v187, s[90:91]
 v_mfma_f32_16x16x32_bf16 v[200:203], v[180:183], v[188:191], v[200:203]
 buffer_load_dwordx4 v30, s[44:47], s86 offen  lds
 s_add_u32 m0, s84, 23552
 v_mfma_f32_16x16x32_bf16 v[204:207], v[180:183], v[192:195], v[204:207]
 v_mfma_f32_16x16x32_bf16 v[208:211], v[180:183], v[196:199], v[208:211]
 buffer_load_dwordx4 v31, s[44:47], s86 offen  lds
 s_add_u32 m0, s84, 24576
 v_mfma_f32_16x16x32_bf16 v[212:215], v[184:187], v[188:191], v[212:215]
 v_mfma_f32_16x16x32_bf16 v[216:219], v[184:187], v[192:195], v[216:219]
 buffer_load_dwordx4 v252, s[44:47], s86 offen  lds
 v_mfma_f32_16x16x32_bf16 v[220:223], v[184:187], v[196:199], v[220:223]
 v_mfma_f32_32x32x16_bf16 v[112:127], v[32:35], a[12:15], v[112:127]
 ds_read_b64_tr_b16 v[56:57], v17 offset:12800
 ds_read_b64_tr_b16 v[58:59], v17 offset:12960
 buffer_atomic_add_f32 v200, v240, s[52:55], s78 offen offset:0
 v_mfma_f32_32x32x16_bf16 v[128:143], v[36:39], a[12:15], v[128:143]
 ds_read_b64_tr_b16 v[60:61], v17 offset:12864
 ds_read_b64_tr_b16 v[62:63], v17 offset:13024
 buffer_atomic_add_f32 v201, v240, s[52:55], s78 offen offset:192
 v_mfma_f32_32x32x16_bf16 v[144:159], v[40:43], a[12:15], v[144:159]
 ds_read_b64_tr_b16 v[64:65], v17 offset:12928
 ds_read_b64_tr_b16 v[66:67], v17 offset:13088
 buffer_atomic_add_f32 v202, v240, s[52:55], s78 offen offset:384
 v_mfma_f32_32x32x16_bf16 v[112:127], v[44:47], a[16:19], v[112:127]
 ds_read_b64_tr_b16 v[32:33], v17 offset:15360
 ds_read_b64_tr_b16 v[34:35], v17 offset:15520
 buffer_atomic_add_f32 v203, v240, s[52:55], s78 offen offset:576
 v_mfma_f32_32x32x16_bf16 v[128:143], v[48:51], a[16:19], v[128:143]
 ds_read_b64_tr_b16 v[36:37], v17 offset:15424
 ds_read_b64_tr_b16 v[38:39], v17 offset:15584
 buffer_atomic_add_f32 v204, v240, s[52:55], s78 offen offset:64
 v_mfma_f32_32x32x16_bf16 v[144:159], v[52:55], a[16:19], v[144:159]
 ds_read_b64_tr_b16 v[40:41], v17 offset:15488
 ds_read_b64_tr_b16 v[42:43], v17 offset:15648
 buffer_atomic_add_f32 v205, v240, s[52:55], s78 offen offset:256
 s_waitcnt lgkmcnt(6)
 v_mfma_f32_32x32x16_bf16 v[112:127], v[56:59], a[20:23], v[112:127]
 buffer_atomic_add_f32 v206, v240, s[52:55], s78 offen offset:448
 buffer_atomic_add_f32 v207, v240, s[52:55], s78 offen offset:640
 v_mfma_f32_32x32x16_bf16 v[128:143], v[60:63], a[20:23], v[128:143]
 ds_read_b64_tr_b16 v[44:45], v17 offset:17920
 ds_read_b64_tr_b16 v[46:47], v17 offset:18080
 v_mov_b32_dpp v208, v209 row_shr:8 row_mask:0xf bank_mask:0xc
 ds_read_b64_tr_b16 v[48:49], v17 offset:17984
 ds_read_b64_tr_b16 v[50:51], v17 offset:18144
 v_mov_b32_dpp v210, v211 row_shr:8 row_mask:0xf bank_mask:0xc
 v_mfma_f32_32x32x16_bf16 v[144:159], v[64:67], a[20:23], v[144:159]
 ds_read_b64_tr_b16 v[52:53], v17 offset:18048
 v_permlane16_swap_b32 v212, v213
 ds_read_b64_tr_b16 v[54:55], v17 offset:18208
 s_waitcnt vmcnt(23)
 s_barrier
 s_waitcnt lgkmcnt(6)
 v_mfma_f32_32x32x16_bf16 v[112:127], v[32:35], a[24:27], v[112:127]
 ds_read_b64_tr_b16 v[56:57], v17 offset:20480
 ds_read_b64_tr_b16 v[58:59], v17 offset:20640
 v_permlane16_swap_b32 v214, v215
 v_permlane16_swap_b32 v216, v217
 v_mfma_f32_32x32x16_bf16 v[128:143], v[36:39], a[24:27], v[128:143]
 ds_read_b64_tr_b16 v[60:61], v17 offset:20544
 ds_read_b64_tr_b16 v[62:63], v17 offset:20704
 v_permlane16_swap_b32 v218, v219
 v_permlane16_swap_b32 v220, v221
 v_mfma_f32_32x32x16_bf16 v[144:159], v[40:43], a[24:27], v[144:159]
 ds_read_b64_tr_b16 v[64:65], v17 offset:20608
 ds_read_b64_tr_b16 v[66:67], v17 offset:20768
 v_permlane16_swap_b32 v222, v223
 buffer_atomic_add_f32 v208, v241, s[52:55], s78 offen offset:128
 s_waitcnt lgkmcnt(6)
 v_mfma_f32_32x32x16_bf16 v[112:127], v[44:47], a[28:31], v[112:127]
 ds_read_b64_tr_b16 v[32:33], v17 offset:23040
 ds_read_b64_tr_b16 v[34:35], v17 offset:23200
 buffer_atomic_add_f32 v210, v241, s[52:55], s78 offen offset:512
 v_permlane32_swap_b32 v212, v214
 v_mfma_f32_32x32x16_bf16 v[128:143], v[48:51], a[28:31], v[128:143]
 ds_read_b64_tr_b16 v[36:37], v17 offset:23104
 ds_read_b64_tr_b16 v[38:39], v17 offset:23264
 v_permlane32_swap_b32 v216, v218
 v_permlane32_swap_b32 v220, v222
 v_mfma_f32_32x32x16_bf16 v[144:159], v[52:55], a[28:31], v[144:159]
 ds_read_b64_tr_b16 v[40:41], v17 offset:23168
 ds_read_b64_tr_b16 v[42:43], v17 offset:23328
 v_permlane16_swap_b32 v213, v217
 buffer_atomic_add_f32 v212, v242, s[52:55], s78 offen offset:0
 s_waitcnt lgkmcnt(6)
 v_mfma_f32_32x32x16_bf16 v[112:127], v[56:59], a[32:35], v[112:127]
 buffer_atomic_add_f32 v216, v242, s[52:55], s78 offen offset:64
 buffer_atomic_add_f32 v220, v243, s[52:55], s78 offen offset:128
 v_mfma_f32_32x32x16_bf16 v[128:143], v[60:63], a[32:35], v[128:143]
 v_permlane32_swap_b32 v213, v221
 buffer_atomic_add_f32 v213, v244, s[52:55], s78 offen offset:0
 ds_read_b64_tr_b16 v[44:45], v17 offset:25600
 ds_read_b64_tr_b16 v[46:47], v17 offset:25760
 v_mfma_f32_32x32x16_bf16 v[144:159], v[64:67], a[32:35], v[144:159]
 ds_read_b64_tr_b16 v[48:49], v17 offset:25664
 ds_read_b64_tr_b16 v[50:51], v17 offset:25824
 ds_read_b64_tr_b16 v[52:53], v17 offset:25728
 ds_read_b64_tr_b16 v[54:55], v17 offset:25888
 s_waitcnt lgkmcnt(6)
 v_mfma_f32_32x32x16_bf16 v[112:127], v[32:35], a[36:39], v[112:127]
 ds_read_b64_tr_b16 v[56:57], v17 offset:28160
 ds_read_b64_tr_b16 v[58:59], v17 offset:28320
 v_mfma_f32_32x32x16_bf16 v[128:143], v[36:39], a[36:39], v[128:143]
 ds_read_b64_tr_b16 v[60:61], v17 offset:28224
 ds_read_b64_tr_b16 v[62:63], v17 offset:28384
 v_mfma_f32_32x32x16_bf16 v[144:159], v[40:43], a[36:39], v[144:159]
 ds_read_b64_tr_b16 v[64:65], v17 offset:28288
 ds_read_b64_tr_b16 v[66:67], v17 offset:28448
 s_waitcnt lgkmcnt(6)
 v_mfma_f32_32x32x16_bf16 v[112:127], v[44:47], a[40:43], v[112:127]
 ds_read_b64_tr_b16 v[32:33], v17 offset:30720
 ds_read_b64_tr_b16 v[34:35], v17 offset:30880
 v_mfma_f32_32x32x16_bf16 v[128:143], v[48:51], a[40:43], v[128:143]
 ds_read_b64_tr_b16 v[36:37], v17 offset:30784
 ds_read_b64_tr_b16 v[38:39], v17 offset:30944
 v_mfma_f32_32x32x16_bf16 v[144:159], v[52:55], a[40:43], v[144:159]
 ds_read_b64_tr_b16 v[40:41], v17 offset:30848
 ds_read_b64_tr_b16 v[42:43], v17 offset:31008
 s_waitcnt lgkmcnt(6)
 v_mfma_f32_32x32x16_bf16 v[112:127], v[56:59], a[44:47], v[112:127]
 ds_read_b64_tr_b16 v[44:45], v17 offset:33280
 ds_read_b64_tr_b16 v[46:47], v17 offset:33440
 v_mfma_f32_32x32x16_bf16 v[128:143], v[60:63], a[44:47], v[128:143]
 ds_read_b64_tr_b16 v[48:49], v17 offset:33344
 ds_read_b64_tr_b16 v[50:51], v17 offset:33504
 v_mfma_f32_32x32x16_bf16 v[144:159], v[64:67], a[44:47], v[144:159]
 ds_read_b64_tr_b16 v[52:53], v17 offset:33408
 ds_read_b64_tr_b16 v[54:55], v17 offset:33568
 s_waitcnt lgkmcnt(6)
 v_mfma_f32_32x32x16_bf16 v[112:127], v[32:35], a[48:51], v[112:127]
 ds_read_b64_tr_b16 v[56:57], v17 offset:35840
 ds_read_b64_tr_b16 v[58:59], v17 offset:36000
 v_mfma_f32_32x32x16_bf16 v[128:143], v[36:39], a[48:51], v[128:143]
 ds_read_b64_tr_b16 v[60:61], v17 offset:35904
 ds_read_b64_tr_b16 v[62:63], v17 offset:36064
 v_mfma_f32_32x32x16_bf16 v[144:159], v[40:43], a[48:51], v[144:159]
 ds_read_b64_tr_b16 v[64:65], v17 offset:35968
 ds_read_b64_tr_b16 v[66:67], v17 offset:36128
 s_waitcnt lgkmcnt(6)
 v_mfma_f32_32x32x16_bf16 v[112:127], v[44:47], a[52:55], v[112:127]
 ds_read_b64_tr_b16 v[32:33], v17 offset:38400
 ds_read_b64_tr_b16 v[34:35], v17 offset:38560
 v_mfma_f32_32x32x16_bf16 v[128:143], v[48:51], a[52:55], v[128:143]
 ds_read_b64_tr_b16 v[36:37], v17 offset:38464
 ds_read_b64_tr_b16 v[38:39], v17 offset:38624
 v_mfma_f32_32x32x16_bf16 v[144:159], v[52:55], a[52:55], v[144:159]
 ds_read_b64_tr_b16 v[40:41], v17 offset:38528
 ds_read_b64_tr_b16 v[42:43], v17 offset:38688
 s_waitcnt vmcnt(24)
 s_barrier
 s_waitcnt lgkmcnt(6)
 v_mfma_f32_32x32x16_bf16 v[112:127], v[56:59], a[56:59], v[112:127]
 ds_read_b64_tr_b16 v[44:45], v16 offset:0
 ds_read_b64_tr_b16 v[46:47], v16 offset:160
 v_mfma_f32_32x32x16_bf16 v[128:143], v[60:63], a[56:59], v[128:143]
 ds_read_b64_tr_b16 v[48:49], v16 offset:64
 ds_read_b64_tr_b16 v[50:51], v16 offset:224
 v_mfma_f32_32x32x16_bf16 v[144:159], v[64:67], a[56:59], v[144:159]
 ds_read_b64_tr_b16 v[52:53], v16 offset:128
 ds_read_b64_tr_b16 v[54:55], v16 offset:288
 s_lshl_b32 s86, s71, 1
 s_add_u32 s86, s86, s68
 s_add_u32 s86, s86, 16
 s_sub_u32 s74, s86, 20
 s_cmp_ge_u32 s86, 20
 s_cselect_b32 s86, s74, s86
 s_mul_i32 s86, s86, 122880
 s_add_u32 s86, s86, s75
 s_add_u32 m0, s84, 40960
 s_waitcnt lgkmcnt(6)
 v_mfma_f32_32x32x16_bf16 v[112:127], v[32:35], a[60:63], v[112:127]
 ds_read_b64_tr_b16 v[56:57], v16 offset:2560
 ds_read_b64_tr_b16 v[58:59], v16 offset:2720
 v_mfma_f32_32x32x16_bf16 v[128:143], v[36:39], a[60:63], v[128:143]
 ds_read_b64_tr_b16 v[60:61], v16 offset:2624
 ds_read_b64_tr_b16 v[62:63], v16 offset:2784
 v_mfma_f32_32x32x16_bf16 v[144:159], v[40:43], a[60:63], v[144:159]
 ds_read_b64_tr_b16 v[64:65], v16 offset:2688
 ds_read_b64_tr_b16 v[66:67], v16 offset:2848
 s_waitcnt lgkmcnt(6)
 v_mfma_f32_32x32x16_bf16 v[112:127], v[44:47], a[64:67], v[112:127]
 ds_read_b64_tr_b16 v[32:33], v16 offset:5120
 ds_read_b64_tr_b16 v[34:35], v16 offset:5280
 buffer_load_dwordx4 v21, s[44:47], s86 offen  lds
 s_add_u32 m0, s84, 41984
 v_mfma_f32_32x32x16_bf16 v[128:143], v[48:51], a[64:67], v[128:143]
 ds_read_b64_tr_b16 v[36:37], v16 offset:5184
 ds_read_b64_tr_b16 v[38:39], v16 offset:5344
 v_mfma_f32_32x32x16_bf16 v[144:159], v[52:55], a[64:67], v[144:159]
 ds_read_b64_tr_b16 v[40:41], v16 offset:5248
 ds_read_b64_tr_b16 v[42:43], v16 offset:5408
 s_waitcnt lgkmcnt(6)
 v_mfma_f32_32x32x16_bf16 v[112:127], v[56:59], a[68:71], v[112:127]
 ds_read_b64_tr_b16 v[44:45], v16 offset:7680
 ds_read_b64_tr_b16 v[46:47], v16 offset:7840
 v_mfma_f32_32x32x16_bf16 v[128:143], v[60:63], a[68:71], v[128:143]
 ds_read_b64_tr_b16 v[48:49], v16 offset:7744
 ds_read_b64_tr_b16 v[50:51], v16 offset:7904
 buffer_load_dwordx4 v29, s[44:47], s86 offen  lds
 s_add_u32 m0, s84, 43008
 v_mfma_f32_32x32x16_bf16 v[144:159], v[64:67], a[68:71], v[144:159]
 ds_read_b64_tr_b16 v[52:53], v16 offset:7808
 ds_read_b64_tr_b16 v[54:55], v16 offset:7968
 s_waitcnt lgkmcnt(6)
 v_mfma_f32_32x32x16_bf16 v[112:127], v[32:35], a[72:75], v[112:127]
 ds_read_b64_tr_b16 v[56:57], v16 offset:10240
 ds_read_b64_tr_b16 v[58:59], v16 offset:10400
 v_mfma_f32_32x32x16_bf16 v[128:143], v[36:39], a[72:75], v[128:143]
 ds_read_b64_tr_b16 v[60:61], v16 offset:10304
 ds_read_b64_tr_b16 v[62:63], v16 offset:10464
 v_mfma_f32_32x32x16_bf16 v[144:159], v[40:43], a[72:75], v[144:159]
 ds_read_b64_tr_b16 v[64:65], v16 offset:10368
 ds_read_b64_tr_b16 v[66:67], v16 offset:10528
 buffer_load_dwordx4 v30, s[44:47], s86 offen  lds
 s_add_u32 m0, s84, 44032
 s_waitcnt lgkmcnt(6)
 v_mfma_f32_32x32x16_bf16 v[112:127], v[44:47], a[76:79], v[112:127]
 ds_read_b64_tr_b16 v[32:33], v16 offset:12800
 ds_read_b64_tr_b16 v[34:35], v16 offset:12960
 v_mfma_f32_32x32x16_bf16 v[128:143], v[48:51], a[76:79], v[128:143]
 ds_read_b64_tr_b16 v[36:37], v16 offset:12864
 ds_read_b64_tr_b16 v[38:39], v16 offset:13024
 v_mfma_f32_32x32x16_bf16 v[144:159], v[52:55], a[76:79], v[144:159]
 ds_read_b64_tr_b16 v[40:41], v16 offset:12928
 ds_read_b64_tr_b16 v[42:43], v16 offset:13088
 s_waitcnt lgkmcnt(6)
 v_mfma_f32_32x32x16_bf16 v[112:127], v[56:59], a[80:83], v[112:127]
 ds_read_b64_tr_b16 v[44:45], v16 offset:15360
 ds_read_b64_tr_b16 v[46:47], v16 offset:15520
 buffer_load_dwordx4 v31, s[44:47], s86 offen  lds
 s_add_u32 m0, s84, 45056
 v_mfma_f32_32x32x16_bf16 v[128:143], v[60:63], a[80:83], v[128:143]
 ds_read_b64_tr_b16 v[48:49], v16 offset:15424
 ds_read_b64_tr_b16 v[50:51], v16 offset:15584
 v_mfma_f32_32x32x16_bf16 v[144:159], v[64:67], a[80:83], v[144:159]
 ds_read_b64_tr_b16 v[52:53], v16 offset:15488
 ds_read_b64_tr_b16 v[54:55], v16 offset:15648
 s_waitcnt lgkmcnt(6)
 v_mfma_f32_32x32x16_bf16 v[112:127], v[32:35], a[84:87], v[112:127]
 ds_read_b64_tr_b16 v[56:57], v16 offset:17920
 ds_read_b64_tr_b16 v[58:59], v16 offset:18080
 v_mfma_f32_32x32x16_bf16 v[128:143], v[36:39], a[84:87], v[128:143]
 buffer_load_dwordx4 v252, s[44:47], s86 offen  lds
 ds_read_b64_tr_b16 v[60:61], v16 offset:17984
 ds_read_b64_tr_b16 v[62:63], v16 offset:18144
 v_mfma_f32_32x32x16_bf16 v[144:159], v[40:43], a[84:87], v[144:159]
 ds_read_b64_tr_b16 v[64:65], v16 offset:18048
 ds_read_b64_tr_b16 v[66:67], v16 offset:18208
 s_waitcnt vmcnt(19)
 s_barrier
 s_waitcnt lgkmcnt(6)
 v_mfma_f32_32x32x16_bf16 v[112:127], v[44:47], a[88:91], v[112:127]
 ds_read_b64_tr_b16 v[32:33], v16 offset:20480
 ds_read_b64_tr_b16 v[34:35], v16 offset:20640
 v_mfma_f32_32x32x16_bf16 v[128:143], v[48:51], a[88:91], v[128:143]
 ds_read_b64_tr_b16 v[36:37], v16 offset:20544
 ds_read_b64_tr_b16 v[38:39], v16 offset:20704
 v_mfma_f32_32x32x16_bf16 v[144:159], v[52:55], a[88:91], v[144:159]
 ds_read_b64_tr_b16 v[40:41], v16 offset:20608
 ds_read_b64_tr_b16 v[42:43], v16 offset:20768
 s_add_u32 s86, s79, 6
 s_and_b32 s86, s86, 7
 s_mul_i32 s86, s86, 102400
 s_add_u32 s86, s86, s83
 s_add_u32 m0, s84, 61440
 s_waitcnt lgkmcnt(6)
 v_mfma_f32_32x32x16_bf16 v[112:127], v[56:59], a[92:95], v[112:127]
 ds_read_b64_tr_b16 v[44:45], v16 offset:23040
 ds_read_b64_tr_b16 v[46:47], v16 offset:23200
 v_mfma_f32_32x32x16_bf16 v[128:143], v[60:63], a[92:95], v[128:143]
 ds_read_b64_tr_b16 v[48:49], v16 offset:23104
 ds_read_b64_tr_b16 v[50:51], v16 offset:23264
 v_mfma_f32_32x32x16_bf16 v[144:159], v[64:67], a[92:95], v[144:159]
 ds_read_b64_tr_b16 v[52:53], v16 offset:23168
 ds_read_b64_tr_b16 v[54:55], v16 offset:23328
 s_waitcnt lgkmcnt(6)
 v_mfma_f32_32x32x16_bf16 v[112:127], v[32:35], a[96:99], v[112:127]
 ds_read_b64_tr_b16 v[56:57], v16 offset:25600
 ds_read_b64_tr_b16 v[58:59], v16 offset:25760
 buffer_load_dwordx4 v1, s[48:51], s86 offen  lds
 s_add_u32 m0, s84, 62464
 v_mfma_f32_32x32x16_bf16 v[128:143], v[36:39], a[96:99], v[128:143]
 ds_read_b64_tr_b16 v[60:61], v16 offset:25664
 ds_read_b64_tr_b16 v[62:63], v16 offset:25824
 v_mfma_f32_32x32x16_bf16 v[144:159], v[40:43], a[96:99], v[144:159]
 ds_read_b64_tr_b16 v[64:65], v16 offset:25728
 ds_read_b64_tr_b16 v[66:67], v16 offset:25888
 s_waitcnt lgkmcnt(6)
 v_mfma_f32_32x32x16_bf16 v[112:127], v[44:47], a[100:103], v[112:127]
 ds_read_b64_tr_b16 v[32:33], v16 offset:28160
 ds_read_b64_tr_b16 v[34:35], v16 offset:28320
 v_mfma_f32_32x32x16_bf16 v[128:143], v[48:51], a[100:103], v[128:143]
 ds_read_b64_tr_b16 v[36:37], v16 offset:28224
 ds_read_b64_tr_b16 v[38:39], v16 offset:28384
 buffer_load_dwordx4 v2, s[48:51], s86 offen  lds
 s_add_u32 m0, s84, 63488
 v_mfma_f32_32x32x16_bf16 v[144:159], v[52:55], a[100:103], v[144:159]
 ds_read_b64_tr_b16 v[40:41], v16 offset:28288
 ds_read_b64_tr_b16 v[42:43], v16 offset:28448
 s_waitcnt lgkmcnt(6)
 v_mfma_f32_32x32x16_bf16 v[112:127], v[56:59], a[104:107], v[112:127]
 ds_read_b64_tr_b16 v[44:45], v16 offset:30720
 ds_read_b64_tr_b16 v[46:47], v16 offset:30880
 v_mfma_f32_32x32x16_bf16 v[128:143], v[60:63], a[104:107], v[128:143]
 ds_read_b64_tr_b16 v[48:49], v16 offset:30784
 ds_read_b64_tr_b16 v[50:51], v16 offset:30944
 v_mfma_f32_32x32x16_bf16 v[144:159], v[64:67], a[104:107], v[144:159]
 ds_read_b64_tr_b16 v[52:53], v16 offset:30848
 ds_read_b64_tr_b16 v[54:55], v16 offset:31008
 buffer_load_dwordx4 v3, s[48:51], s86 offen  lds
 s_add_u32 m0, s84, 64512
 s_waitcnt lgkmcnt(6)
 v_mfma_f32_32x32x16_bf16 v[112:127], v[32:35], a[108:111], v[112:127]
 ds_read_b64_tr_b16 v[56:57], v16 offset:33280
 ds_read_b64_tr_b16 v[58:59], v16 offset:33440
 v_mfma_f32_32x32x16_bf16 v[128:143], v[36:39], a[108:111], v[128:143]
 ds_read_b64_tr_b16 v[60:61], v16 offset:33344
 ds_read_b64_tr_b16 v[62:63], v16 offset:33504
 v_mfma_f32_32x32x16_bf16 v[144:159], v[40:43], a[108:111], v[144:159]
 ds_read_b64_tr_b16 v[64:65], v16 offset:33408
 ds_read_b64_tr_b16 v[66:67], v16 offset:33568
 s_waitcnt lgkmcnt(6)
 v_mfma_f32_32x32x16_bf16 v[112:127], v[44:47], a[112:115], v[112:127]
 ds_read_b64_tr_b16 v[32:33], v16 offset:35840
 ds_read_b64_tr_b16 v[34:35], v16 offset:36000
 buffer_load_dwordx4 v4, s[48:51], s86 offen  lds
 s_add_u32 m0, s84, 65536
 v_mfma_f32_32x32x16_bf16 v[128:143], v[48:51], a[112:115], v[128:143]
 ds_read_b64_tr_b16 v[36:37], v16 offset:35904
 ds_read_b64_tr_b16 v[38:39], v16 offset:36064
 v_mfma_f32_32x32x16_bf16 v[144:159], v[52:55], a[112:115], v[144:159]
 ds_read_b64_tr_b16 v[40:41], v16 offset:35968
 ds_read_b64_tr_b16 v[42:43], v16 offset:36128
 s_waitcnt lgkmcnt(6)
 v_mfma_f32_32x32x16_bf16 v[112:127], v[56:59], a[116:119], v[112:127]
 ds_read_b64_tr_b16 v[44:45], v16 offset:38400
 ds_read_b64_tr_b16 v[46:47], v16 offset:38560
 v_mfma_f32_32x32x16_bf16 v[128:143], v[60:63], a[116:119], v[128:143]
 buffer_load_dwordx4 v5, s[48:51], s86 offen  lds
 ds_read_b64_tr_b16 v[48:49], v16 offset:38464
 ds_read_b64_tr_b16 v[50:51], v16 offset:38624
 v_mfma_f32_32x32x16_bf16 v[144:159], v[64:67], a[116:119], v[144:159]
 ds_read_b64_tr_b16 v[52:53], v16 offset:38528
 ds_read_b64_tr_b16 v[54:55], v16 offset:38688
 v_accvgpr_read_b32 v247, a217
 s_lshl_b32 s78, s70, 13
 s_lshl_b32 s85, s69, 9
 s_add_u32 s78, s78, s85
 s_lshl_b32 s85, s68, 7
 s_add_u32 s78, s78, s85
 s_add_u32 s78, s78, 131072
 s_waitcnt vmcnt(10)
 buffer_store_dword v253, v247, s[52:55], s78 offen sc1
 s_waitcnt vmcnt(6)
 s_barrier
 s_waitcnt lgkmcnt(6)
 v_mfma_f32_32x32x16_bf16 v[112:127], v[32:35], a[120:123], v[112:127]
 ds_read_b64_tr_b16 v[56:57], v17 offset:0
 ds_read_b64_tr_b16 v[58:59], v17 offset:160
 v_mfma_f32_32x32x16_bf16 v[128:143], v[36:39], a[120:123], v[128:143]
 ds_read_b64_tr_b16 v[60:61], v17 offset:64
 ds_read_b64_tr_b16 v[62:63], v17 offset:224
 v_mfma_f32_32x32x16_bf16 v[144:159], v[40:43], a[120:123], v[144:159]
 ds_read_b64_tr_b16 v[64:65], v17 offset:128
 ds_read_b64_tr_b16 v[66:67], v17 offset:288
 s_add_u32 s86, s79, 0
 s_and_b32 s86, s86, 7
 s_mul_i32 s86, s86, 102400
 s_add_u32 s86, s86, s83
 s_add_u32 m0, s84, 0
 s_waitcnt lgkmcnt(6)
 v_mfma_f32_32x32x16_bf16 v[112:127], v[44:47], a[124:127], v[112:127]
 ds_read_b64_tr_b16 v[32:33], v17 offset:2560
 ds_read_b64_tr_b16 v[34:35], v17 offset:2720
 v_mfma_f32_32x32x16_bf16 v[128:143], v[48:51], a[124:127], v[128:143]
 ds_read_b64_tr_b16 v[36:37], v17 offset:2624
 ds_read_b64_tr_b16 v[38:39], v17 offset:2784
 v_mfma_f32_32x32x16_bf16 v[144:159], v[52:55], a[124:127], v[144:159]
 ds_read_b64_tr_b16 v[40:41], v17 offset:2688
 ds_read_b64_tr_b16 v[42:43], v17 offset:2848
 s_waitcnt lgkmcnt(6)
 v_mfma_f32_32x32x16_bf16 v[112:127], v[56:59], a[128:131], v[112:127]
 ds_read_b64_tr_b16 v[44:45], v17 offset:5120
 ds_read_b64_tr_b16 v[46:47], v17 offset:5280
 buffer_load_dwordx4 v1, s[48:51], s86 offen  lds
 s_add_u32 m0, s84, 1024
 v_mfma_f32_32x32x16_bf16 v[128:143], v[60:63], a[128:131], v[128:143]
 ds_read_b64_tr_b16 v[48:49], v17 offset:5184
 ds_read_b64_tr_b16 v[50:51], v17 offset:5344
 v_mfma_f32_32x32x16_bf16 v[144:159], v[64:67], a[128:131], v[144:159]
 ds_read_b64_tr_b16 v[52:53], v17 offset:5248
 ds_read_b64_tr_b16 v[54:55], v17 offset:5408
 s_waitcnt lgkmcnt(6)
 v_mfma_f32_32x32x16_bf16 v[112:127], v[32:35], a[132:135], v[112:127]
 ds_read_b64_tr_b16 v[56:57], v17 offset:7680
 ds_read_b64_tr_b16 v[58:59], v17 offset:7840
 v_mfma_f32_32x32x16_bf16 v[128:143], v[36:39], a[132:135], v[128:143]
 ds_read_b64_tr_b16 v[60:61], v17 offset:7744
 ds_read_b64_tr_b16 v[62:63], v17 offset:7904
 buffer_load_dwordx4 v2, s[48:51], s86 offen  lds
 s_add_u32 m0, s84, 2048
 v_mfma_f32_32x32x16_bf16 v[144:159], v[40:43], a[132:135], v[144:159]
 ds_read_b64_tr_b16 v[64:65], v17 offset:7808
 ds_read_b64_tr_b16 v[66:67], v17 offset:7968
 s_waitcnt lgkmcnt(6)
 v_mfma_f32_32x32x16_bf16 v[112:127], v[44:47], a[136:139], v[112:127]
 ds_read_b64_tr_b16 v[32:33], v17 offset:10240
 ds_read_b64_tr_b16 v[34:35], v17 offset:10400
 v_mfma_f32_32x32x16_bf16 v[128:143], v[48:51], a[136:139], v[128:143]
 ds_read_b64_tr_b16 v[36:37], v17 offset:10304
 ds_read_b64_tr_b16 v[38:39], v17 offset:10464
 v_mfma_f32_32x32x16_bf16 v[144:159], v[52:55], a[136:139], v[144:159]
 ds_read_b64_tr_b16 v[40:41], v17 offset:10368
 ds_read_b64_tr_b16 v[42:43], v17 offset:10528
 buffer_load_dwordx4 v3, s[48:51], s86 offen  lds
 s_add_u32 m0, s84, 3072
 s_waitcnt lgkmcnt(6)
 v_mfma_f32_32x32x16_bf16 v[112:127], v[56:59], a[140:143], v[112:127]
 ds_read_b64_tr_b16 v[44:45], v17 offset:12800
 ds_read_b64_tr_b16 v[46:47], v17 offset:12960
 v_mfma_f32_32x32x16_bf16 v[128:143], v[60:63], a[140:143], v[128:143]
 ds_read_b64_tr_b16 v[48:49], v17 offset:12864
 ds_read_b64_tr_b16 v[50:51], v17 offset:13024
 v_mfma_f32_32x32x16_bf16 v[144:159], v[64:67], a[140:143], v[144:159]
 ds_read_b64_tr_b16 v[52:53], v17 offset:12928
 ds_read_b64_tr_b16 v[54:55], v17 offset:13088
 s_waitcnt lgkmcnt(6)
 v_mfma_f32_32x32x16_bf16 v[112:127], v[32:35], a[144:147], v[112:127]
 ds_read_b64_tr_b16 v[56:57], v17 offset:15360
 ds_read_b64_tr_b16 v[58:59], v17 offset:15520
 buffer_load_dwordx4 v4, s[48:51], s86 offen  lds
 s_add_u32 m0, s84, 4096
 v_mfma_f32_32x32x16_bf16 v[128:143], v[36:39], a[144:147], v[128:143]
 ds_read_b64_tr_b16 v[60:61], v17 offset:15424
 ds_read_b64_tr_b16 v[62:63], v17 offset:15584
 v_mfma_f32_32x32x16_bf16 v[144:159], v[40:43], a[144:147], v[144:159]
 ds_read_b64_tr_b16 v[64:65], v17 offset:15488
 ds_read_b64_tr_b16 v[66:67], v17 offset:15648
 s_waitcnt lgkmcnt(6)
 v_mfma_f32_32x32x16_bf16 v[112:127], v[44:47], a[148:151], v[112:127]
 ds_read_b64_tr_b16 v[32:33], v17 offset:17920
 ds_read_b64_tr_b16 v[34:35], v17 offset:18080
 v_mfma_f32_32x32x16_bf16 v[128:143], v[48:51], a[148:151], v[128:143]
 buffer_load_dwordx4 v5, s[48:51], s86 offen  lds
 ds_read_b64_tr_b16 v[36:37], v17 offset:17984
 ds_read_b64_tr_b16 v[38:39], v17 offset:18144
 v_mfma_f32_32x32x16_bf16 v[144:159], v[52:55], a[148:151], v[144:159]
 ds_read_b64_tr_b16 v[40:41], v17 offset:18048
 ds_read_b64_tr_b16 v[42:43], v17 offset:18208
 s_waitcnt lgkmcnt(6)
 v_mfma_f32_32x32x16_bf16 v[112:127], v[56:59], a[152:155], v[112:127]
 v_mfma_f32_32x32x16_bf16 v[128:143], v[60:63], a[152:155], v[128:143]
 v_mfma_f32_32x32x16_bf16 v[144:159], v[64:67], a[152:155], v[144:159]
 s_waitcnt lgkmcnt(0)
 v_mfma_f32_32x32x16_bf16 v[112:127], v[32:35], a[156:159], v[112:127]
 v_mfma_f32_32x32x16_bf16 v[128:143], v[36:39], a[156:159], v[128:143]
 v_mfma_f32_32x32x16_bf16 v[144:159], v[40:43], a[156:159], v[144:159]
 s_nop 9
 v_cvt_pk_bf16_f32 v32, v112, v113
 v_cvt_pk_bf16_f32 v33, v114, v115
 v_cvt_pk_bf16_f32 v34, v116, v117
 v_cvt_pk_bf16_f32 v35, v118, v119
 v_cvt_pk_bf16_f32 v36, v120, v121
 v_cvt_pk_bf16_f32 v37, v122, v123
 v_cvt_pk_bf16_f32 v38, v124, v125
 v_cvt_pk_bf16_f32 v39, v126, v127
 v_mfma_f32_32x32x16_bf16 v[192:207], a[160:163], v[32:35], 0
 v_cvt_pk_bf16_f32 v40, v128, v129
 v_cvt_pk_bf16_f32 v41, v130, v131
 v_cvt_pk_bf16_f32 v42, v132, v133
 v_cvt_pk_bf16_f32 v43, v134, v135
 v_cvt_pk_bf16_f32 v44, v136, v137
 v_cvt_pk_bf16_f32 v45, v138, v139
 v_mfma_f32_32x32x16_bf16 v[192:207], a[164:167], v[36:39], v[192:207]
 v_cvt_pk_bf16_f32 v46, v140, v141
 v_cvt_pk_bf16_f32 v47, v142, v143
 v_cvt_pk_bf16_f32 v48, v144, v145
 v_cvt_pk_bf16_f32 v49, v146, v147
 v_cvt_pk_bf16_f32 v50, v148, v149
 v_cvt_pk_bf16_f32 v51, v150, v151
 v_mfma_f32_32x32x16_bf16 v[192:207], a[168:171], v[40:43], v[192:207]
 v_accvgpr_read_b32 v24, a222
 v_mov_b32 v240, 0
 v_mov_b32 v241, 0
 v_mfma_f32_32x32x16_bf16 v[208:223], a[172:175], v[32:35], 0
 v_mov_b32 v242, 0
 v_mov_b32 v243, 0
 ds_write_b128 v24, v[240:243]
 v_mfma_f32_32x32x16_bf16 v[208:223], a[176:179], v[36:39], v[208:223]
 v_lshlrev_b32 v25, 7, v23
 v_lshlrev_b32 v26, 4, v23
 v_mfma_f32_32x32x16_bf16 v[208:223], a[180:183], v[40:43], v[208:223]
 s_lshl_b32 s78, s70, 13
 s_add_u32 s78, s78, 131072
 s_lshl_b32 s77, s70, 2
 v_mfma_f32_32x32x16_bf16 v[208:223], a[184:187], v[44:47], v[208:223]
 s_add_u32 s77, s77, s68
 v_max3_f32 v96, v192, v193, v194
 s_lshl_b32 s77, s77, 12
 v_min3_f32 v98, v192, v193, v194
 s_add_u32 s77, s77, 0
 v_max3_f32 v96, v96, v195, v196
 v_mfma_f32_32x32x16_bf16 v[208:223], a[188:191], v[48:51], v[208:223]
 s_nop 0
 v_accvgpr_read_b32 v244, a218
 v_min3_f32 v98, v98, v195, v196
 v_accvgpr_read_b32 v245, a219
 v_max3_f32 v96, v96, v197, v198
 v_accvgpr_read_b32 v246, a220
 v_min3_f32 v98, v98, v197, v198
 v_mfma_f32_32x32x16_bf16 v[224:239], a[192:195], v[40:43], 0
 v_accvgpr_read_b32 v247, a221
 v_max3_f32 v96, v96, v199, v200
 buffer_load_dword v248, v25, s[52:55], s78 offen sc1
 v_min3_f32 v98, v98, v199, v200
 v_mfma_f32_32x32x16_bf16 v[224:239], a[196:199], v[44:47], v[224:239]
 v_and_b32_e64 v27, 7, v0
 v_max3_f32 v96, v96, v201, v202
 v_lshlrev_b32_e64 v27, 13, v27
 v_min3_f32 v98, v98, v201, v202
 s_lshl_b32 s93, s69, 9
 v_max3_f32 v96, v96, v203, v204
 v_mfma_f32_32x32x16_bf16 v[224:239], a[200:203], v[48:51], v[224:239]
 s_lshl_b32 s81, s68, 7
 v_min3_f32 v98, v98, v203, v204
 s_add_u32 s93, s93, s81
 v_max3_f32 v96, v96, v205, v206
 s_add_u32 s93, s93, 131072
 v_min3_f32 v98, v98, v205, v206
 v_max3_f32 v96, v96, v207, v208
 v_min3_f32 v98, v98, v207, v208
 v_max3_f32 v96, v96, v209, v210
 v_min3_f32 v98, v98, v209, v210
 v_max_f32 v96, v96, v211
 s_branch pg4_skip
.p2align 12
pg4:
 s_setpc_b64 s[4:5]
 s_nop 0
pg4_skip:
 v_min_f32 v98, v98, v211
 v_mul_f32 v96, s88, v96
 v_mul_f32_e64 v98, s88, v98
 v_pk_fma_f32 v[56:57], v[192:193], s[88:89], v[96:97] op_sel_hi:[1,1,0] neg_lo:[0,0,1] neg_hi:[0,0,1]
 v_pk_fma_f32 v[76:77], v[192:193], s[88:89], v[98:99] op_sel_hi:[1,1,0] neg_lo:[1,0,0] neg_hi:[1,0,0]
 v_pk_fma_f32 v[58:59], v[194:195], s[88:89], v[96:97] op_sel_hi:[1,1,0] neg_lo:[0,0,1] neg_hi:[0,0,1]
 v_pk_fma_f32 v[78:79], v[194:195], s[88:89], v[98:99] op_sel_hi:[1,1,0] neg_lo:[1,0,0] neg_hi:[1,0,0]
 v_pk_fma_f32 v[60:61], v[196:197], s[88:89], v[96:97] op_sel_hi:[1,1,0] neg_lo:[0,0,1] neg_hi:[0,0,1]
 v_pk_fma_f32 v[80:81], v[196:197], s[88:89], v[98:99] op_sel_hi:[1,1,0] neg_lo:[1,0,0] neg_hi:[1,0,0]
 v_pk_fma_f32 v[62:63], v[198:199], s[88:89], v[96:97] op_sel_hi:[1,1,0] neg_lo:[0,0,1] neg_hi:[0,0,1]
 v_pk_fma_f32 v[82:83], v[198:199], s[88:89], v[98:99] op_sel_hi:[1,1,0] neg_lo:[1,0,0] neg_hi:[1,0,0]
 v_pk_fma_f32 v[64:65], v[200:201], s[88:89], v[96:97] op_sel_hi:[1,1,0] neg_lo:[0,0,1] neg_hi:[0,0,1]
 v_pk_fma_f32 v[84:85], v[200:201], s[88:89], v[98:99] op_sel_hi:[1,1,0] neg_lo:[1,0,0] neg_hi:[1,0,0]
 v_pk_fma_f32 v[66:67], v[202:203], s[88:89], v[96:97] op_sel_hi:[1,1,0] neg_lo:[0,0,1] neg_hi:[0,0,1]
 v_pk_fma_f32 v[86:87], v[202:203], s[88:89], v[98:99] op_sel_hi:[1,1,0] neg_lo:[1,0,0] neg_hi:[1,0,0]
 v_pk_fma_f32 v[68:69], v[204:205], s[88:89], v[96:97] op_sel_hi:[1,1,0] neg_lo:[0,0,1] neg_hi:[0,0,1]
 v_pk_fma_f32 v[88:89], v[204:205], s[88:89], v[98:99] op_sel_hi:[1,1,0] neg_lo:[1,0,0] neg_hi:[1,0,0]
 v_pk_fma_f32 v[70:71], v[206:207], s[88:89], v[96:97] op_sel_hi:[1,1,0] neg_lo:[0,0,1] neg_hi:[0,0,1]
 v_pk_fma_f32 v[90:91], v[206:207], s[88:89], v[98:99] op_sel_hi:[1,1,0] neg_lo:[1,0,0] neg_hi:[1,0,0]
 v_pk_fma_f32 v[72:73], v[208:209], s[88:89], v[96:97] op_sel_hi:[1,1,0] neg_lo:[0,0,1] neg_hi:[0,0,1]
 v_pk_fma_f32 v[92:93], v[208:209], s[88:89], v[98:99] op_sel_hi:[1,1,0] neg_lo:[1,0,0] neg_hi:[1,0,0]
 v_pk_fma_f32 v[74:75], v[210:211], s[88:89], v[96:97] op_sel_hi:[1,1,0] neg_lo:[0,0,1] neg_hi:[0,0,1]
 v_pk_fma_f32 v[94:95], v[210:211], s[88:89], v[98:99] op_sel_hi:[1,1,0] neg_lo:[1,0,0] neg_hi:[1,0,0]
 v_exp_f32 v56, v56
 v_exp_f32 v57, v57
 v_exp_f32 v58, v58
 v_exp_f32 v59, v59
 v_exp_f32 v60, v60
 v_exp_f32 v61, v61
 v_exp_f32 v62, v62
 v_exp_f32 v63, v63
 v_exp_f32 v64, v64
 v_exp_f32 v65, v65
 v_exp_f32 v66, v66
 v_exp_f32 v67, v67
 v_exp_f32 v68, v68
 v_exp_f32 v69, v69
 v_exp_f32 v70, v70
 v_exp_f32 v71, v71
 v_exp_f32 v72, v72
 v_exp_f32 v73, v73
 v_exp_f32 v74, v74
 v_exp_f32 v75, v75
 v_exp_f32 v76, v76
 v_exp_f32 v77, v77
 v_exp_f32 v78, v78
 v_exp_f32 v79, v79
 v_exp_f32 v80, v80
 v_exp_f32 v81, v81
 v_exp_f32 v82, v82
 v_exp_f32 v83, v83
 v_exp_f32 v84, v84
 v_exp_f32 v85, v85
 v_exp_f32 v86, v86
 v_exp_f32 v87, v87
 v_exp_f32 v88, v88
 v_exp_f32 v89, v89
 v_exp_f32 v90, v90
 v_exp_f32 v91, v91
 v_exp_f32 v92, v92
 v_exp_f32 v93, v93
 v_exp_f32 v94, v94
 v_exp_f32 v95, v95
 v_pk_add_f32 v[100:101], v[56:57], v[58:59]
 v_pk_add_f32 v[102:103], v[76:77], v[78:79]
 v_pk_add_f32 v[100:101], v[100:101], v[60:61]
 v_pk_add_f32 v[102:103], v[102:103], v[80:81]
 v_pk_add_f32 v[100:101], v[100:101], v[62:63]
 v_pk_add_f32 v[102:103], v[102:103], v[82:83]
 v_pk_add_f32 v[100:101], v[100:101], v[64:65]
 v_pk_add_f32 v[102:103], v[102:103], v[84:85]
 v_pk_add_f32 v[100:101], v[100:101], v[66:67]
 v_pk_add_f32 v[102:103], v[102:103], v[86:87]
 v_pk_add_f32 v[100:101], v[100:101], v[68:69]
 v_pk_add_f32 v[102:103], v[102:103], v[88:89]
 v_pk_add_f32 v[100:101], v[100:101], v[70:71]
 v_pk_add_f32 v[102:103], v[102:103], v[90:91]
 v_pk_add_f32 v[100:101], v[100:101], v[72:73]
 v_pk_add_f32 v[102:103], v[102:103], v[92:93]
 v_pk_add_f32 v[100:101], v[100:101], v[74:75]
 v_pk_add_f32 v[102:103], v[102:103], v[94:95]
 v_add_f32 v100, v100, v101
 v_add_f32 v102, v102, v103
 v_rcp_f32 v100, v100
 v_rcp_f32 v102, v102
 v_pk_mul_f32 v[56:57], v[56:57], v[100:101] op_sel_hi:[1,0]
 v_pk_mul_f32 v[58:59], v[58:59], v[100:101] op_sel_hi:[1,0]
 v_pk_mul_f32 v[60:61], v[60:61], v[100:101] op_sel_hi:[1,0]
 v_pk_mul_f32 v[62:63], v[62:63], v[100:101] op_sel_hi:[1,0]
 v_pk_mul_f32 v[64:65], v[64:65], v[100:101] op_sel_hi:[1,0]
 v_pk_mul_f32 v[66:67], v[66:67], v[100:101] op_sel_hi:[1,0]
 v_pk_mul_f32 v[68:69], v[68:69], v[100:101] op_sel_hi:[1,0]
 v_pk_mul_f32 v[70:71], v[70:71], v[100:101] op_sel_hi:[1,0]
 v_pk_mul_f32 v[72:73], v[72:73], v[100:101] op_sel_hi:[1,0]
 v_pk_mul_f32 v[74:75], v[74:75], v[100:101] op_sel_hi:[1,0]
 v_pk_mul_f32 v[76:77], v[76:77], v[102:103] op_sel_hi:[1,0]
 v_pk_mul_f32 v[78:79], v[78:79], v[102:103] op_sel_hi:[1,0]
 v_pk_mul_f32 v[80:81], v[80:81], v[102:103] op_sel_hi:[1,0]
 v_pk_mul_f32 v[82:83], v[82:83], v[102:103] op_sel_hi:[1,0]
 v_pk_mul_f32 v[84:85], v[84:85], v[102:103] op_sel_hi:[1,0]
 v_pk_mul_f32 v[86:87], v[86:87], v[102:103] op_sel_hi:[1,0]
 v_pk_mul_f32 v[88:89], v[88:89], v[102:103] op_sel_hi:[1,0]
 v_pk_mul_f32 v[90:91], v[90:91], v[102:103] op_sel_hi:[1,0]
 v_pk_mul_f32 v[92:93], v[92:93], v[102:103] op_sel_hi:[1,0]
 v_pk_mul_f32 v[94:95], v[94:95], v[102:103] op_sel_hi:[1,0]
 s_waitcnt vmcnt(0)
 v_cmp_eq_u32 vcc, v253, v248
 s_mov_b32 s95, 0
 s_nop 0
 s_cmp_eq_u64 vcc, -1
 s_cbranch_scc0 a_noearly
 buffer_load_dwordx4 v[144:147], v26, s[52:55], s77 offen offset:0 sc1
 buffer_load_dwordx4 v[148:151], v26, s[52:55], s77 offen offset:1024 sc1
 buffer_load_dwordx4 v[152:155], v26, s[52:55], s77 offen offset:2048 sc1
 buffer_load_dwordx4 v[156:159], v26, s[52:55], s77 offen offset:3072 sc1
 s_mov_b32 s95, 1
a_noearly:
 buffer_load_dword v249, v27, s[52:55], s93 offen sc1
 s_nop 0
 v_cvt_pk_bf16_f32 v160, v56, v57
 v_cvt_pk_bf16_f32 v161, v58, v59
 v_cvt_pk_bf16_f32 v162, v60, v61
 v_cvt_pk_bf16_f32 v163, v62, v63
 v_cvt_pk_bf16_f32 v164, v64, v65
 v_cvt_pk_bf16_f32 v165, v66, v67
 v_cvt_pk_bf16_f32 v166, v68, v69
 v_cvt_pk_bf16_f32 v167, v70, v71
 v_cvt_pk_bf16_f32 v168, v72, v73
 v_cvt_pk_bf16_f32 v169, v74, v75
 v_cvt_pk_bf16_f32 v170, v76, v77
 v_cvt_pk_bf16_f32 v171, v78, v79
 v_cvt_pk_bf16_f32 v172, v80, v81
 v_cvt_pk_bf16_f32 v173, v82, v83
 v_cvt_pk_bf16_f32 v174, v84, v85
 v_cvt_pk_bf16_f32 v175, v86, v87
 v_cvt_pk_bf16_f32 v176, v88, v89
 v_cvt_pk_bf16_f32 v177, v90, v91
 v_cvt_pk_bf16_f32 v178, v92, v93
 v_cvt_pk_bf16_f32 v179, v94, v95
 v_max3_f32 v104, v212, v213, v214
 v_min3_f32 v106, v212, v213, v214
 v_max3_f32 v104, v104, v215, v216
 v_min3_f32 v106, v106, v215, v216
 v_max3_f32 v104, v104, v217, v218
 v_min3_f32 v106, v106, v217, v218
 v_max3_f32 v104, v104, v219, v220
 v_min3_f32 v106, v106, v219, v220
 v_max3_f32 v104, v104, v221, v222
 v_min3_f32 v106, v106, v221, v222
 v_max3_f32 v104, v104, v223, v224
 v_min3_f32 v106, v106, v223, v224
 v_max3_f32 v104, v104, v225, v226
 v_min3_f32 v106, v106, v225, v226
 v_max3_f32 v104, v104, v227, v228
 v_min3_f32 v106, v106, v227, v228
 v_max3_f32 v104, v104, v229, v230
 v_min3_f32 v106, v106, v229, v230
 v_max_f32 v104, v104, v231
 v_min_f32 v106, v106, v231
 v_mul_f32 v104, s88, v104
 v_mul_f32 v106, s88, v106
 v_pk_fma_f32 v[56:57], v[212:213], s[88:89], v[104:105] op_sel_hi:[1,1,0] neg_lo:[0,0,1] neg_hi:[0,0,1]
 v_pk_fma_f32 v[76:77], v[212:213], s[88:89], v[106:107] op_sel_hi:[1,1,0] neg_lo:[1,0,0] neg_hi:[1,0,0]
 v_pk_fma_f32 v[58:59], v[214:215], s[88:89], v[104:105] op_sel_hi:[1,1,0] neg_lo:[0,0,1] neg_hi:[0,0,1]
 v_pk_fma_f32 v[78:79], v[214:215], s[88:89], v[106:107] op_sel_hi:[1,1,0] neg_lo:[1,0,0] neg_hi:[1,0,0]
 v_pk_fma_f32 v[60:61], v[216:217], s[88:89], v[104:105] op_sel_hi:[1,1,0] neg_lo:[0,0,1] neg_hi:[0,0,1]
 v_pk_fma_f32 v[80:81], v[216:217], s[88:89], v[106:107] op_sel_hi:[1,1,0] neg_lo:[1,0,0] neg_hi:[1,0,0]
 v_pk_fma_f32 v[62:63], v[218:219], s[88:89], v[104:105] op_sel_hi:[1,1,0] neg_lo:[0,0,1] neg_hi:[0,0,1]
 v_pk_fma_f32 v[82:83], v[218:219], s[88:89], v[106:107] op_sel_hi:[1,1,0] neg_lo:[1,0,0] neg_hi:[1,0,0]
 v_pk_fma_f32 v[64:65], v[220:221], s[88:89], v[104:105] op_sel_hi:[1,1,0] neg_lo:[0,0,1] neg_hi:[0,0,1]
 v_pk_fma_f32 v[84:85], v[220:221], s[88:89], v[106:107] op_sel_hi:[1,1,0] neg_lo:[1,0,0] neg_hi:[1,0,0]
 v_pk_fma_f32 v[66:67], v[222:223], s[88:89], v[104:105] op_sel_hi:[1,1,0] neg_lo:[0,0,1] neg_hi:[0,0,1]
 v_pk_fma_f32 v[86:87], v[222:223], s[88:89], v[106:107] op_sel_hi:[1,1,0] neg_lo:[1,0,0] neg_hi:[1,0,0]
 v_pk_fma_f32 v[68:69], v[224:225], s[88:89], v[104:105] op_sel_hi:[1,1,0] neg_lo:[0,0,1] neg_hi:[0,0,1]
 v_pk_fma_f32 v[88:89], v[224:225], s[88:89], v[106:107] op_sel_hi:[1,1,0] neg_lo:[1,0,0] neg_hi:[1,0,0]
 v_pk_fma_f32 v[70:71], v[226:227], s[88:89], v[104:105] op_sel_hi:[1,1,0] neg_lo:[0,0,1] neg_hi:[0,0,1]
 v_pk_fma_f32 v[90:91], v[226:227], s[88:89], v[106:107] op_sel_hi:[1,1,0] neg_lo:[1,0,0] neg_hi:[1,0,0]
 v_pk_fma_f32 v[72:73], v[228:229], s[88:89], v[104:105] op_sel_hi:[1,1,0] neg_lo:[0,0,1] neg_hi:[0,0,1]
 v_pk_fma_f32 v[92:93], v[228:229], s[88:89], v[106:107] op_sel_hi:[1,1,0] neg_lo:[1,0,0] neg_hi:[1,0,0]
 v_pk_fma_f32 v[74:75], v[230:231], s[88:89], v[104:105] op_sel_hi:[1,1,0] neg_lo:[0,0,1] neg_hi:[0,0,1]
 v_pk_fma_f32 v[94:95], v[230:231], s[88:89], v[106:107] op_sel_hi:[1,1,0] neg_lo:[1,0,0] neg_hi:[1,0,0]
 v_exp_f32 v56, v56
 v_exp_f32 v57, v57
 v_exp_f32 v58, v58
 v_exp_f32 v59, v59
 v_exp_f32 v60, v60
 v_exp_f32 v61, v61
 v_exp_f32 v62, v62
 v_exp_f32 v63, v63
 v_exp_f32 v64, v64
 v_exp_f32 v65, v65
 v_exp_f32 v66, v66
 v_exp_f32 v67, v67
 v_exp_f32 v68, v68
 v_exp_f32 v69, v69
 v_exp_f32 v70, v70
 v_exp_f32 v71, v71
 v_exp_f32 v72, v72
 v_exp_f32 v73, v73
 v_exp_f32 v74, v74
 v_exp_f32 v75, v75
 v_exp_f32 v76, v76
 v_exp_f32 v77, v77
 v_exp_f32 v78, v78
 v_exp_f32 v79, v79
 v_exp_f32 v80, v80
 v_exp_f32 v81, v81
 v_exp_f32 v82, v82
 v_exp_f32 v83, v83
 v_exp_f32 v84, v84
 v_exp_f32 v85, v85
 v_exp_f32 v86, v86
 v_exp_f32 v87, v87
 v_exp_f32 v88, v88
 v_exp_f32 v89, v89
 v_exp_f32 v90, v90
 v_exp_f32 v91, v91
 v_exp_f32 v92, v92
 v_exp_f32 v93, v93
 v_exp_f32 v94, v94
 v_exp_f32 v95, v95
 v_pk_add_f32 v[108:109], v[56:57], v[58:59]
 v_pk_add_f32 v[110:111], v[76:77], v[78:79]
 v_pk_add_f32 v[108:109], v[108:109], v[60:61]
 v_pk_add_f32 v[110:111], v[110:111], v[80:81]
 v_pk_add_f32 v[108:109], v[108:109], v[62:63]
 v_pk_add_f32 v[110:111], v[110:111], v[82:83]
 v_pk_add_f32 v[108:109], v[108:109], v[64:65]
 v_pk_add_f32 v[110:111], v[110:111], v[84:85]
 v_pk_add_f32 v[108:109], v[108:109], v[66:67]
 v_pk_add_f32 v[110:111], v[110:111], v[86:87]
 v_pk_add_f32 v[108:109], v[108:109], v[68:69]
 v_pk_add_f32 v[110:111], v[110:111], v[88:89]
 v_pk_add_f32 v[108:109], v[108:109], v[70:71]
 v_pk_add_f32 v[110:111], v[110:111], v[90:91]
 v_pk_add_f32 v[108:109], v[108:109], v[72:73]
 v_pk_add_f32 v[110:111], v[110:111], v[92:93]
 v_pk_add_f32 v[108:109], v[108:109], v[74:75]
 v_pk_add_f32 v[110:111], v[110:111], v[94:95]
 v_add_f32 v108, v108, v109
 v_add_f32 v110, v110, v111
 v_rcp_f32 v108, v108
 v_rcp_f32 v110, v110
 v_pk_mul_f32 v[56:57], v[56:57], v[108:109] op_sel_hi:[1,0]
 v_pk_mul_f32 v[58:59], v[58:59], v[108:109] op_sel_hi:[1,0]
 v_pk_mul_f32 v[60:61], v[60:61], v[108:109] op_sel_hi:[1,0]
 v_pk_mul_f32 v[62:63], v[62:63], v[108:109] op_sel_hi:[1,0]
 v_pk_mul_f32 v[64:65], v[64:65], v[108:109] op_sel_hi:[1,0]
 v_pk_mul_f32 v[66:67], v[66:67], v[108:109] op_sel_hi:[1,0]
 v_pk_mul_f32 v[68:69], v[68:69], v[108:109] op_sel_hi:[1,0]
 v_pk_mul_f32 v[70:71], v[70:71], v[108:109] op_sel_hi:[1,0]
 v_pk_mul_f32 v[72:73], v[72:73], v[108:109] op_sel_hi:[1,0]
 v_pk_mul_f32 v[74:75], v[74:75], v[108:109] op_sel_hi:[1,0]
 v_pk_mul_f32 v[76:77], v[76:77], v[110:111] op_sel_hi:[1,0]
 v_pk_mul_f32 v[78:79], v[78:79], v[110:111] op_sel_hi:[1,0]
 v_pk_mul_f32 v[80:81], v[80:81], v[110:111] op_sel_hi:[1,0]
 v_pk_mul_f32 v[82:83], v[82:83], v[110:111] op_sel_hi:[1,0]
 v_pk_mul_f32 v[84:85], v[84:85], v[110:111] op_sel_hi:[1,0]
 v_pk_mul_f32 v[86:87], v[86:87], v[110:111] op_sel_hi:[1,0]
 v_pk_mul_f32 v[88:89], v[88:89], v[110:111] op_sel_hi:[1,0]
 v_pk_mul_f32 v[90:91], v[90:91], v[110:111] op_sel_hi:[1,0]
 v_pk_mul_f32 v[92:93], v[92:93], v[110:111] op_sel_hi:[1,0]
 v_pk_mul_f32 v[94:95], v[94:95], v[110:111] op_sel_hi:[1,0]
 s_cmp_eq_u32 s95, 1
 s_cbranch_scc1 a_have
 s_mov_b32 s94, 400000
a_pk:
 buffer_load_dword v248, v25, s[52:55], s78 offen sc1
 s_sub_u32 s94, s94, 1
 s_waitcnt vmcnt(0)
 v_cmp_eq_u32 vcc, v253, v248
 s_cmp_eq_u32 s94, 0
 s_cbranch_scc1 a_pk_x
 s_cmp_eq_u64 vcc, -1
 s_cbranch_scc0 a_pk
a_pk_x:
 buffer_load_dwordx4 v[144:147], v26, s[52:55], s77 offen offset:0 sc1
 buffer_load_dwordx4 v[148:151], v26, s[52:55], s77 offen offset:1024 sc1
 buffer_load_dwordx4 v[152:155], v26, s[52:55], s77 offen offset:2048 sc1
 buffer_load_dwordx4 v[156:159], v26, s[52:55], s77 offen offset:3072 sc1
a_have:
 s_waitcnt vmcnt(0)
 v_cvt_pk_bf16_f32 v32, v144, v145
 v_cvt_pk_bf16_f32 v33, v146, v147
 ds_write_b64 v244, v[32:33]
 v_cvt_pk_bf16_f32 v34, v148, v149
 v_cvt_pk_bf16_f32 v35, v150, v151
 ds_write_b64 v245, v[34:35]
 v_cvt_pk_bf16_f32 v36, v152, v153
 v_cvt_pk_bf16_f32 v37, v154, v155
 ds_write_b64 v246, v[36:37]
 v_cvt_pk_bf16_f32 v38, v156, v157
 v_cvt_pk_bf16_f32 v39, v158, v159
 ds_write_b64 v247, v[38:39]
 v_cmp_eq_u32_e64 vcc, v253, v249
 v_accvgpr_read_b32 v24, a223
 v_accvgpr_read_b32 v25, a224
 s_cmp_eq_u64 vcc, -1
 s_cbranch_scc1 a_pf_x
 s_mov_b32 s94, 400000
a_pf:
 buffer_load_dword v249, v27, s[52:55], s93 offen sc1
 s_sub_u32 s94, s94, 1
 s_waitcnt vmcnt(0)
 v_cmp_eq_u32 vcc, v253, v249
 s_cmp_eq_u32 s94, 0
 s_cbranch_scc1 a_pf_x
 s_cmp_eq_u64 vcc, -1
 s_cbranch_scc0 a_pf
a_pf_x:
 s_mul_i32 s76, s70, 5120
 s_add_u32 s78, s92, s76
 s_add_u32 s81, s78, 4096
 s_mov_b32 s85, 0x358637bd
 v_cvt_pk_bf16_f32 v180, v56, v57
 v_cvt_pk_bf16_f32 v181, v58, v59
 v_cvt_pk_bf16_f32 v182, v60, v61
 v_cvt_pk_bf16_f32 v183, v62, v63
 v_cvt_pk_bf16_f32 v184, v64, v65
 v_cvt_pk_bf16_f32 v185, v66, v67
 v_cvt_pk_bf16_f32 v186, v68, v69
 v_cvt_pk_bf16_f32 v187, v70, v71
 v_cvt_pk_bf16_f32 v188, v72, v73
 v_cvt_pk_bf16_f32 v189, v74, v75
 v_cvt_pk_bf16_f32 v190, v76, v77
 v_cvt_pk_bf16_f32 v191, v78, v79
 v_cvt_pk_bf16_f32 v192, v80, v81
 v_cvt_pk_bf16_f32 v193, v82, v83
 v_cvt_pk_bf16_f32 v194, v84, v85
 v_cvt_pk_bf16_f32 v195, v86, v87
 v_cvt_pk_bf16_f32 v196, v88, v89
 v_cvt_pk_bf16_f32 v197, v90, v91
 v_cvt_pk_bf16_f32 v198, v92, v93
 v_cvt_pk_bf16_f32 v199, v94, v95
 s_waitcnt lgkmcnt(0)
 s_barrier
 ds_read_b128 v[32:35], v24 offset:1280
 ds_read_b128 v[36:39], v24 offset:1296
 ds_read_b128 v[40:43], v24 offset:1312
 ds_read_b128 v[44:47], v24 offset:1328
 ds_read_b128 v[48:51], v24 offset:1344
 ds_read_b128 v[52:55], v25 offset:1280
 ds_read_b128 v[56:59], v25 offset:1296
 ds_read_b128 v[60:63], v25 offset:1312
 ds_read_b128 v[64:67], v25 offset:1328
 ds_read_b128 v[68:71], v25 offset:1344
 s_waitcnt lgkmcnt(8)
 v_mfma_f32_32x32x16_bf16 v[112:127], v[32:35], v[160:163], 0
 s_add_u32 s86, s79, 2
 s_and_b32 s86, s86, 7
 s_mul_i32 s86, s86, 102400
 s_add_u32 s86, s86, s83
 s_add_u32 m0, s84, 20480
 ds_read_b128 v[32:35], v24 offset:0
 v_mfma_f32_32x32x16_bf16 v[112:127], v[36:39], v[164:167], v[112:127]
 buffer_load_dwordx4 v1, s[48:51], s86 offen  lds
 s_add_u32 m0, s84, 21504
 ds_read_b128 v[36:39], v24 offset:16
 s_waitcnt lgkmcnt(7)
 v_mfma_f32_32x32x16_bf16 v[112:127], v[40:43], v[168:171], v[112:127]
 buffer_load_dwordx4 v2, s[48:51], s86 offen  lds
 s_add_u32 m0, s84, 22528
 ds_read_b128 v[40:43], v24 offset:32
 v_mfma_f32_32x32x16_bf16 v[112:127], v[44:47], v[172:175], v[112:127]
 buffer_load_dwordx4 v3, s[48:51], s86 offen  lds
 s_add_u32 m0, s84, 23552
 ds_read_b128 v[44:47], v24 offset:48
 v_mfma_f32_32x32x16_bf16 v[112:127], v[48:51], v[176:179], v[112:127]
 buffer_load_dwordx4 v4, s[48:51], s86 offen  lds
 s_add_u32 m0, s84, 24576
 ds_read_b128 v[48:51], v24 offset:64
 s_waitcnt lgkmcnt(5)
 v_mfma_f32_32x32x16_bf16 v[128:143], v[52:55], v[180:183], 0
 buffer_load_dwordx4 v5, s[48:51], s86 offen  lds
 ds_read_b128 v[52:55], v25 offset:0
 v_mfma_f32_32x32x16_bf16 v[128:143], v[56:59], v[184:187], v[128:143]
 s_add_u32 s86, s79, 4
 s_and_b32 s86, s86, 7
 s_mul_i32 s86, s86, 102400
 s_add_u32 s86, s86, s83
 s_add_u32 m0, s84, 40960
 ds_read_b128 v[56:59], v25 offset:16
 v_mfma_f32_32x32x16_bf16 v[128:143], v[60:63], v[188:191], v[128:143]
 buffer_load_dwordx4 v1, s[48:51], s86 offen  lds
 s_add_u32 m0, s84, 41984
 ds_read_b128 v[60:63], v25 offset:32
 v_mfma_f32_32x32x16_bf16 v[128:143], v[64:67], v[192:195], v[128:143]
 v_add_f32 v116, s85, v116
 v_rcp_f32 v116, v116
 s_nop 0
 v_mul_f32_e64 v112, v116, v112
 ds_read_b128 v[64:67], v25 offset:48
 v_mfma_f32_32x32x16_bf16 v[128:143], v[68:71], v[196:199], v[128:143]
 v_mul_f32_e64 v113, v116, v113
 v_cvt_pk_bf16_f32 v88, v112, v113
 buffer_load_dwordx4 v2, s[48:51], s86 offen  lds
 s_add_u32 m0, s84, 43008
 ds_read_b128 v[68:71], v25 offset:64
 s_waitcnt lgkmcnt(5)
 v_mfma_f32_32x32x16_bf16 v[200:215], v[32:35], v[160:163], 0
 v_mul_f32 v114, v116, v114
 v_mul_f32_e64 v115, v116, v115
 v_cvt_pk_bf16_f32 v89, v114, v115
 buffer_load_dwordx4 v3, s[48:51], s86 offen  lds
 s_add_u32 m0, s84, 44032
 v_mfma_f32_32x32x16_bf16 v[200:215], v[36:39], v[164:167], v[200:215]
 buffer_load_dwordx4 v4, s[48:51], s86 offen  lds
 s_add_u32 m0, s84, 45056
 s_nop 0
 buffer_load_dwordx4 v5, s[48:51], s86 offen  lds
 v_mfma_f32_32x32x16_bf16 v[200:215], v[40:43], v[168:171], v[200:215]
 v_add_f32 v132, s85, v132
 v_rcp_f32 v132, v132
 s_nop 0
 v_mul_f32_e64 v128, v132, v128
 v_mfma_f32_32x32x16_bf16 v[200:215], v[44:47], v[172:175], v[200:215]
 v_mul_f32_e64 v129, v132, v129
 v_cvt_pk_bf16_f32 v98, v128, v129
 v_mfma_f32_32x32x16_bf16 v[200:215], v[48:51], v[176:179], v[200:215]
 v_mul_f32 v130, v132, v130
 v_mul_f32 v131, v132, v131
 v_cvt_pk_bf16_f32 v99, v130, v131
 s_waitcnt lgkmcnt(0)
 v_mfma_f32_32x32x16_bf16 v[216:231], v[52:55], v[180:183], 0
 v_mfma_f32_32x32x16_bf16 v[216:231], v[56:59], v[184:187], v[216:231]
 s_nop 5
 v_mul_f32 v200, v116, v200
 v_mul_f32 v201, v116, v201
 v_cvt_pk_bf16_f32 v80, v200, v201
 v_mul_f32 v202, v116, v202
 v_mul_f32 v203, v116, v203
 v_cvt_pk_bf16_f32 v81, v202, v203
 v_mfma_f32_32x32x16_bf16 v[216:231], v[60:63], v[188:191], v[216:231]
 v_mul_f32 v204, v116, v204
 v_mul_f32 v205, v116, v205
 v_cvt_pk_bf16_f32 v82, v204, v205
 v_mul_f32 v206, v116, v206
 v_mul_f32 v207, v116, v207
 v_cvt_pk_bf16_f32 v83, v206, v207
 v_mfma_f32_32x32x16_bf16 v[216:231], v[64:67], v[192:195], v[216:231]
 buffer_store_dwordx4 v[80:83], v26, s[52:55], s78 offen offset:0 sc1
 v_mul_f32 v208, v116, v208
 v_mul_f32 v209, v116, v209
 v_cvt_pk_bf16_f32 v84, v208, v209
 v_mfma_f32_32x32x16_bf16 v[216:231], v[68:71], v[196:199], v[216:231]
 v_mul_f32 v210, v116, v210
 v_mul_f32 v211, v116, v211
 v_cvt_pk_bf16_f32 v85, v210, v211
 v_mul_f32 v212, v116, v212
 v_mul_f32 v213, v116, v213
 v_cvt_pk_bf16_f32 v86, v212, v213
 v_mul_f32 v214, v116, v214
 v_mul_f32 v215, v116, v215
 v_cvt_pk_bf16_f32 v87, v214, v215
 buffer_store_dwordx4 v[84:87], v26, s[52:55], s78 offen offset:1024 sc1
 s_nop 1
 s_nop 0
 v_pk_mul_f32 v[216:217], v[216:217], v[132:133] op_sel_hi:[1,0]
 v_pk_mul_f32 v[218:219], v[218:219], v[132:133] op_sel_hi:[1,0]
 v_pk_mul_f32 v[220:221], v[220:221], v[132:133] op_sel_hi:[1,0]
 v_pk_mul_f32 v[222:223], v[222:223], v[132:133] op_sel_hi:[1,0]
 v_pk_mul_f32 v[224:225], v[224:225], v[132:133] op_sel_hi:[1,0]
 v_pk_mul_f32 v[226:227], v[226:227], v[132:133] op_sel_hi:[1,0]
 v_pk_mul_f32 v[228:229], v[228:229], v[132:133] op_sel_hi:[1,0]
 v_pk_mul_f32 v[230:231], v[230:231], v[132:133] op_sel_hi:[1,0]
 v_cvt_pk_bf16_f32 v90, v216, v217
 v_cvt_pk_bf16_f32 v91, v218, v219
 buffer_store_dwordx4 v[88:91], v26, s[52:55], s78 offen offset:2048 sc1
 v_cvt_pk_bf16_f32 v92, v220, v221
 v_cvt_pk_bf16_f32 v93, v222, v223
 v_cvt_pk_bf16_f32 v94, v224, v225
 v_cvt_pk_bf16_f32 v95, v226, v227
 buffer_store_dwordx4 v[92:95], v26, s[52:55], s78 offen offset:3072 sc1
 v_cvt_pk_bf16_f32 v96, v228, v229
 v_cvt_pk_bf16_f32 v97, v230, v231
 buffer_store_dwordx4 v[96:99], v26, s[52:55], s81 offen offset:0 sc1
 s_waitcnt vmcnt(5)
g2_tail:
 v_accvgpr_read_b32 v14, a230
 v_xor_b32 v15, 64, v14
 v_add_u32 v16, 40960, v14
 v_add_u32 v17, 40960, v15
 v_lshlrev_b32 v26, 4, v23
 v_lshrrev_b32 v28, 3, v23
 v_mul_u32_u24 v28, 5120, v28
 v_and_b32_e64 v24, 7, v0
 v_lshl_add_u32 v28, v24, 7, v28
 s_mov_b32 s94, 400000
 s_add_u32 s93, s92, 4096
 s_barrier
 v_accvgpr_read_b32 v24, a231
 v_accvgpr_read_b32 v25, a232
 v_accvgpr_read_b32 v27, a233
g2_retry:
 ds_read_b64_tr_b16 v[32:33], v14 offset:0
 ds_read_b64_tr_b16 v[34:35], v14 offset:512
 ds_read_b64_tr_b16 v[36:37], v15 offset:0
 ds_read_b64_tr_b16 v[38:39], v15 offset:512
 ds_read_b64_tr_b16 v[40:41], v14 offset:2048
 ds_read_b64_tr_b16 v[42:43], v14 offset:2560
 ds_read_b64_tr_b16 v[44:45], v15 offset:2048
 ds_read_b64_tr_b16 v[46:47], v15 offset:2560
 s_mul_i32 s76, s100, 5120
 s_add_u32 s76, s76, s92
 s_add_u32 s77, s92, 40960
 s_mov_b32 s81, s76
 v_mov_b32_e64 v248, 0
 s_waitcnt vmcnt(0)
 buffer_load_dword v249, v28, s[52:55], s93 offen sc1
 s_waitcnt vmcnt(0)
 v_cmp_ne_u32 vcc, -1, v249
 s_nop 1
 s_cmp_eq_u64 vcc, -1
 s_cbranch_scc1 g2_now
g2_poll:
 s_sleep 6
 buffer_load_dword v249, v28, s[52:55], s93 offen sc1
 s_mov_b32 s81, s76
 s_sub_u32 s94, s94, 1
 s_waitcnt vmcnt(0)
 v_cmp_ne_u32 vcc, -1, v249
 s_cmp_lt_i32 s94, 1
 s_cbranch_scc1 g2_now
 s_cmp_eq_u64 vcc, -1
 s_cbranch_scc0 g2_poll
g2_now:
 buffer_load_dwordx4 v[88:91], v26, s[52:55], s81 offen offset:0 sc1
 buffer_load_dwordx4 v[92:95], v26, s[52:55], s81 offen offset:1024 sc1
 buffer_load_dwordx4 v[96:99], v26, s[52:55], s81 offen offset:2048 sc1
 buffer_load_dwordx4 v[100:103], v26, s[52:55], s81 offen offset:3072 sc1
 s_add_u32 s85, s81, 4096
 buffer_load_dwordx4 v[104:107], v26, s[52:55], s85 offen offset:0 sc1
 s_add_u32 s81, s81, 5120
 s_cmp_eq_u32 s81, s77
 s_cselect_b32 s81, s92, s81
 buffer_load_dwordx4 v[108:111], v26, s[52:55], s81 offen offset:0 sc1
 buffer_load_dwordx4 v[112:115], v26, s[52:55], s81 offen offset:1024 sc1
 buffer_load_dwordx4 v[116:119], v26, s[52:55], s81 offen offset:2048 sc1
 buffer_load_dwordx4 v[120:123], v26, s[52:55], s81 offen offset:3072 sc1
 s_add_u32 s85, s81, 4096
 buffer_load_dwordx4 v[124:127], v26, s[52:55], s85 offen offset:0 sc1
 s_add_u32 s81, s81, 5120
 s_cmp_eq_u32 s81, s77
 s_cselect_b32 s81, s92, s81
 buffer_load_dwordx4 v[128:131], v26, s[52:55], s81 offen offset:0 sc1
 buffer_load_dwordx4 v[132:135], v26, s[52:55], s81 offen offset:1024 sc1
 buffer_load_dwordx4 v[136:139], v26, s[52:55], s81 offen offset:2048 sc1
 buffer_load_dwordx4 v[140:143], v26, s[52:55], s81 offen offset:3072 sc1
g2_go:
 s_waitcnt vmcnt(13) lgkmcnt(4)
 v_mfma_f32_32x32x16_bf16 v[56:71], v[32:35], v[88:91], 0
 s_add_u32 s85, s81, 4096
 buffer_load_dwordx4 v[144:147], v26, s[52:55], s85 offen offset:0 sc1
 s_add_u32 s81, s81, 5120
 s_cmp_eq_u32 s81, s77
 s_cselect_b32 s81, s92, s81
 ds_read_b64_tr_b16 v[48:49], v14 offset:4096
 ds_read_b64_tr_b16 v[50:51], v14 offset:4608
 v_mfma_f32_32x32x16_bf16 v[72:87], v[36:39], v[88:91], 0
 ds_read_b64_tr_b16 v[52:53], v15 offset:4096
 v_max3_u32 v248, v248, v88, v89
 ds_read_b64_tr_b16 v[54:55], v15 offset:4608
 v_max3_u32 v248, v248, v90, v91
 s_waitcnt vmcnt(13) lgkmcnt(4)
 v_mfma_f32_32x32x16_bf16 v[56:71], v[40:43], v[92:95], v[56:71]
 buffer_load_dwordx4 v[148:151], v26, s[52:55], s81 offen offset:0 sc1
 ds_read_b64_tr_b16 v[32:33], v14 offset:6144
 ds_read_b64_tr_b16 v[34:35], v14 offset:6656
 v_mfma_f32_32x32x16_bf16 v[72:87], v[44:47], v[92:95], v[72:87]
 ds_read_b64_tr_b16 v[36:37], v15 offset:6144
 v_max3_u32 v248, v248, v92, v93
 ds_read_b64_tr_b16 v[38:39], v15 offset:6656
 v_max3_u32 v248, v248, v94, v95
 s_waitcnt vmcnt(13) lgkmcnt(4)
 v_mfma_f32_32x32x16_bf16 v[56:71], v[48:51], v[96:99], v[56:71]
 buffer_load_dwordx4 v[152:155], v26, s[52:55], s81 offen offset:1024 sc1
 ds_read_b64_tr_b16 v[40:41], v14 offset:8192
 ds_read_b64_tr_b16 v[42:43], v14 offset:8704
 v_mfma_f32_32x32x16_bf16 v[72:87], v[52:55], v[96:99], v[72:87]
 ds_read_b64_tr_b16 v[44:45], v15 offset:8192
 v_max3_u32 v248, v248, v96, v97
 ds_read_b64_tr_b16 v[46:47], v15 offset:8704
 v_max3_u32 v248, v248, v98, v99
 s_waitcnt vmcnt(13) lgkmcnt(4)
 v_mfma_f32_32x32x16_bf16 v[56:71], v[32:35], v[100:103], v[56:71]
 buffer_load_dwordx4 v[156:159], v26, s[52:55], s81 offen offset:2048 sc1
 ds_read_b64_tr_b16 v[48:49], v14 offset:10240
 ds_read_b64_tr_b16 v[50:51], v14 offset:10752
 v_mfma_f32_32x32x16_bf16 v[72:87], v[36:39], v[100:103], v[72:87]
 ds_read_b64_tr_b16 v[52:53], v15 offset:10240
 v_max3_u32 v248, v248, v100, v101
 ds_read_b64_tr_b16 v[54:55], v15 offset:10752
 v_max3_u32 v248, v248, v102, v103
 s_waitcnt vmcnt(13) lgkmcnt(4)
 v_mfma_f32_32x32x16_bf16 v[56:71], v[40:43], v[104:107], v[56:71]
 buffer_load_dwordx4 v[160:163], v26, s[52:55], s81 offen offset:3072 sc1
 ds_read_b64_tr_b16 v[32:33], v14 offset:12288
 ds_read_b64_tr_b16 v[34:35], v14 offset:12800
 v_mfma_f32_32x32x16_bf16 v[72:87], v[44:47], v[104:107], v[72:87]
 ds_read_b64_tr_b16 v[36:37], v15 offset:12288
 v_max3_u32 v248, v248, v104, v105
 ds_read_b64_tr_b16 v[38:39], v15 offset:12800
 v_max3_u32 v248, v248, v106, v107
 s_waitcnt vmcnt(13) lgkmcnt(4)
 v_mfma_f32_32x32x16_bf16 v[56:71], v[48:51], v[108:111], v[56:71]
 s_add_u32 s85, s81, 4096
 buffer_load_dwordx4 v[164:167], v26, s[52:55], s85 offen offset:0 sc1
 s_add_u32 s81, s81, 5120
 s_cmp_eq_u32 s81, s77
 s_cselect_b32 s81, s92, s81
 s_branch pg5_skip
.p2align 12
pg5:
 s_setpc_b64 s[4:5]
 s_nop 0
pg5_skip:
 ds_read_b64_tr_b16 v[40:41], v14 offset:14336
 ds_read_b64_tr_b16 v[42:43], v14 offset:14848
 v_mfma_f32_32x32x16_bf16 v[72:87], v[52:55], v[108:111], v[72:87]
 ds_read_b64_tr_b16 v[44:45], v15 offset:14336
 v_max3_u32 v248, v248, v108, v109
 ds_read_b64_tr_b16 v[46:47], v15 offset:14848
 v_max3_u32 v248, v248, v110, v111
 s_waitcnt vmcnt(13) lgkmcnt(4)
 v_mfma_f32_32x32x16_bf16 v[56:71], v[32:35], v[112:115], v[56:71]
 buffer_load_dwordx4 v[168:171], v26, s[52:55], s81 offen offset:0 sc1
 ds_read_b64_tr_b16 v[48:49], v14 offset:16384
 ds_read_b64_tr_b16 v[50:51], v14 offset:16896
 v_mfma_f32_32x32x16_bf16 v[72:87], v[36:39], v[112:115], v[72:87]
 ds_read_b64_tr_b16 v[52:53], v15 offset:16384
 v_max3_u32 v248, v248, v112, v113
 ds_read_b64_tr_b16 v[54:55], v15 offset:16896
 v_max3_u32 v248, v248, v114, v115
 s_waitcnt vmcnt(13) lgkmcnt(4)
 v_mfma_f32_32x32x16_bf16 v[56:71], v[40:43], v[116:119], v[56:71]
 buffer_load_dwordx4 v[172:175], v26, s[52:55], s81 offen offset:1024 sc1
 ds_read_b64_tr_b16 v[32:33], v14 offset:18432
 ds_read_b64_tr_b16 v[34:35], v14 offset:18944
 v_mfma_f32_32x32x16_bf16 v[72:87], v[44:47], v[116:119], v[72:87]
 ds_read_b64_tr_b16 v[36:37], v15 offset:18432
 v_max3_u32 v248, v248, v116, v117
 ds_read_b64_tr_b16 v[38:39], v15 offset:18944
 v_max3_u32 v248, v248, v118, v119
 s_waitcnt vmcnt(13) lgkmcnt(4)
 v_mfma_f32_32x32x16_bf16 v[56:71], v[48:51], v[120:123], v[56:71]
 buffer_load_dwordx4 v[176:179], v26, s[52:55], s81 offen offset:2048 sc1
 ds_read_b64_tr_b16 v[40:41], v14 offset:20480
 ds_read_b64_tr_b16 v[42:43], v14 offset:20992
 v_mfma_f32_32x32x16_bf16 v[72:87], v[52:55], v[120:123], v[72:87]
 ds_read_b64_tr_b16 v[44:45], v15 offset:20480
 v_max3_u32 v248, v248, v120, v121
 ds_read_b64_tr_b16 v[46:47], v15 offset:20992
 v_max3_u32 v248, v248, v122, v123
 s_waitcnt vmcnt(13) lgkmcnt(4)
 v_mfma_f32_32x32x16_bf16 v[56:71], v[32:35], v[124:127], v[56:71]
 buffer_load_dwordx4 v[180:183], v26, s[52:55], s81 offen offset:3072 sc1
 ds_read_b64_tr_b16 v[48:49], v14 offset:22528
 ds_read_b64_tr_b16 v[50:51], v14 offset:23040
 v_mfma_f32_32x32x16_bf16 v[72:87], v[36:39], v[124:127], v[72:87]
 ds_read_b64_tr_b16 v[52:53], v15 offset:22528
 v_max3_u32 v248, v248, v124, v125
 ds_read_b64_tr_b16 v[54:55], v15 offset:23040
 v_max3_u32 v248, v248, v126, v127
 s_waitcnt vmcnt(13) lgkmcnt(4)
 v_mfma_f32_32x32x16_bf16 v[56:71], v[40:43], v[128:131], v[56:71]
 s_add_u32 s85, s81, 4096
 buffer_load_dwordx4 v[184:187], v26, s[52:55], s85 offen offset:0 sc1
 s_add_u32 s81, s81, 5120
 s_cmp_eq_u32 s81, s77
 s_cselect_b32 s81, s92, s81
 ds_read_b64_tr_b16 v[32:33], v14 offset:24576
 ds_read_b64_tr_b16 v[34:35], v14 offset:25088
 v_mfma_f32_32x32x16_bf16 v[72:87], v[44:47], v[128:131], v[72:87]
 ds_read_b64_tr_b16 v[36:37], v15 offset:24576
 v_max3_u32 v248, v248, v128, v129
 ds_read_b64_tr_b16 v[38:39], v15 offset:25088
 v_max3_u32 v248, v248, v130, v131
 s_waitcnt vmcnt(13) lgkmcnt(4)
 v_mfma_f32_32x32x16_bf16 v[56:71], v[48:51], v[132:135], v[56:71]
 buffer_load_dwordx4 v[188:191], v26, s[52:55], s81 offen offset:0 sc1
 ds_read_b64_tr_b16 v[40:41], v14 offset:26624
 ds_read_b64_tr_b16 v[42:43], v14 offset:27136
 v_mfma_f32_32x32x16_bf16 v[72:87], v[52:55], v[132:135], v[72:87]
 ds_read_b64_tr_b16 v[44:45], v15 offset:26624
 v_max3_u32 v248, v248, v132, v133
 ds_read_b64_tr_b16 v[46:47], v15 offset:27136
 v_max3_u32 v248, v248, v134, v135
 s_waitcnt vmcnt(13) lgkmcnt(4)
 v_mfma_f32_32x32x16_bf16 v[56:71], v[32:35], v[136:139], v[56:71]
 buffer_load_dwordx4 v[192:195], v26, s[52:55], s81 offen offset:1024 sc1
 ds_read_b64_tr_b16 v[48:49], v14 offset:28672
 ds_read_b64_tr_b16 v[50:51], v14 offset:29184
 v_mfma_f32_32x32x16_bf16 v[72:87], v[36:39], v[136:139], v[72:87]
 ds_read_b64_tr_b16 v[52:53], v15 offset:28672
 v_max3_u32 v248, v248, v136, v137
 ds_read_b64_tr_b16 v[54:55], v15 offset:29184
 v_max3_u32 v248, v248, v138, v139
 s_waitcnt vmcnt(13) lgkmcnt(4)
 v_mfma_f32_32x32x16_bf16 v[56:71], v[40:43], v[140:143], v[56:71]
 buffer_load_dwordx4 v[196:199], v26, s[52:55], s81 offen offset:2048 sc1
 ds_read_b64_tr_b16 v[32:33], v14 offset:30720
 ds_read_b64_tr_b16 v[34:35], v14 offset:31232
 v_mfma_f32_32x32x16_bf16 v[72:87], v[44:47], v[140:143], v[72:87]
 ds_read_b64_tr_b16 v[36:37], v15 offset:30720
 v_max3_u32 v248, v248, v140, v141
 ds_read_b64_tr_b16 v[38:39], v15 offset:31232
 v_max3_u32 v248, v248, v142, v143
 s_waitcnt vmcnt(13) lgkmcnt(4)
 v_mfma_f32_32x32x16_bf16 v[56:71], v[48:51], v[144:147], v[56:71]
 buffer_load_dwordx4 v[200:203], v26, s[52:55], s81 offen offset:3072 sc1
 ds_read_b64_tr_b16 v[40:41], v14 offset:32768
 ds_read_b64_tr_b16 v[42:43], v14 offset:33280
 v_mfma_f32_32x32x16_bf16 v[72:87], v[52:55], v[144:147], v[72:87]
 ds_read_b64_tr_b16 v[44:45], v15 offset:32768
 v_max3_u32 v248, v248, v144, v145
 ds_read_b64_tr_b16 v[46:47], v15 offset:33280
 v_max3_u32 v248, v248, v146, v147
 s_waitcnt vmcnt(13) lgkmcnt(4)
 v_mfma_f32_32x32x16_bf16 v[56:71], v[32:35], v[148:151], v[56:71]
 s_add_u32 s85, s81, 4096
 buffer_load_dwordx4 v[204:207], v26, s[52:55], s85 offen offset:0 sc1
 s_add_u32 s81, s81, 5120
 s_cmp_eq_u32 s81, s77
 s_cselect_b32 s81, s92, s81
 ds_read_b64_tr_b16 v[48:49], v14 offset:34816
 ds_read_b64_tr_b16 v[50:51], v14 offset:35328
 v_mfma_f32_32x32x16_bf16 v[72:87], v[36:39], v[148:151], v[72:87]
 ds_read_b64_tr_b16 v[52:53], v15 offset:34816
 v_max3_u32 v248, v248, v148, v149
 ds_read_b64_tr_b16 v[54:55], v15 offset:35328
 v_max3_u32 v248, v248, v150, v151
 s_waitcnt vmcnt(13) lgkmcnt(4)
 v_mfma_f32_32x32x16_bf16 v[56:71], v[40:43], v[152:155], v[56:71]
 buffer_load_dwordx4 v[208:211], v26, s[52:55], s81 offen offset:0 sc1
 ds_read_b64_tr_b16 v[32:33], v14 offset:36864
 ds_read_b64_tr_b16 v[34:35], v14 offset:37376
 v_mfma_f32_32x32x16_bf16 v[72:87], v[44:47], v[152:155], v[72:87]
 ds_read_b64_tr_b16 v[36:37], v15 offset:36864
 v_max3_u32 v248, v248, v152, v153
 ds_read_b64_tr_b16 v[38:39], v15 offset:37376
 v_max3_u32 v248, v248, v154, v155
 s_waitcnt vmcnt(13) lgkmcnt(4)
 v_mfma_f32_32x32x16_bf16 v[56:71], v[48:51], v[156:159], v[56:71]
 buffer_load_dwordx4 v[212:215], v26, s[52:55], s81 offen offset:1024 sc1
 ds_read_b64_tr_b16 v[40:41], v14 offset:38912
 ds_read_b64_tr_b16 v[42:43], v14 offset:39424
 v_mfma_f32_32x32x16_bf16 v[72:87], v[52:55], v[156:159], v[72:87]
 ds_read_b64_tr_b16 v[44:45], v15 offset:38912
 v_max3_u32 v248, v248, v156, v157
 ds_read_b64_tr_b16 v[46:47], v15 offset:39424
 v_max3_u32 v248, v248, v158, v159
 s_waitcnt vmcnt(13) lgkmcnt(4)
 v_mfma_f32_32x32x16_bf16 v[56:71], v[32:35], v[160:163], v[56:71]
 buffer_load_dwordx4 v[216:219], v26, s[52:55], s81 offen offset:2048 sc1
 ds_read_b64_tr_b16 v[48:49], v16 offset:0
 ds_read_b64_tr_b16 v[50:51], v16 offset:512
 v_mfma_f32_32x32x16_bf16 v[72:87], v[36:39], v[160:163], v[72:87]
 ds_read_b64_tr_b16 v[52:53], v17 offset:0
 v_max3_u32 v248, v248, v160, v161
 ds_read_b64_tr_b16 v[54:55], v17 offset:512
 v_max3_u32 v248, v248, v162, v163
 s_waitcnt vmcnt(13) lgkmcnt(4)
 v_mfma_f32_32x32x16_bf16 v[56:71], v[40:43], v[164:167], v[56:71]
 buffer_load_dwordx4 v[220:223], v26, s[52:55], s81 offen offset:3072 sc1
 ds_read_b64_tr_b16 v[32:33], v16 offset:2048
 ds_read_b64_tr_b16 v[34:35], v16 offset:2560
 v_mfma_f32_32x32x16_bf16 v[72:87], v[44:47], v[164:167], v[72:87]
 ds_read_b64_tr_b16 v[36:37], v17 offset:2048
 v_max3_u32 v248, v248, v164, v165
 ds_read_b64_tr_b16 v[38:39], v17 offset:2560
 v_max3_u32 v248, v248, v166, v167
 s_waitcnt vmcnt(13) lgkmcnt(4)
 v_mfma_f32_32x32x16_bf16 v[56:71], v[48:51], v[168:171], v[56:71]
 s_add_u32 s85, s81, 4096
 buffer_load_dwordx4 v[224:227], v26, s[52:55], s85 offen offset:0 sc1
 s_add_u32 s81, s81, 5120
 s_cmp_eq_u32 s81, s77
 s_cselect_b32 s81, s92, s81
 ds_read_b64_tr_b16 v[40:41], v16 offset:4096
 ds_read_b64_tr_b16 v[42:43], v16 offset:4608
 v_mfma_f32_32x32x16_bf16 v[72:87], v[52:55], v[168:171], v[72:87]
 ds_read_b64_tr_b16 v[44:45], v17 offset:4096
 v_max3_u32 v248, v248, v168, v169
 ds_read_b64_tr_b16 v[46:47], v17 offset:4608
 v_max3_u32 v248, v248, v170, v171
 s_waitcnt vmcnt(13) lgkmcnt(4)
 v_mfma_f32_32x32x16_bf16 v[56:71], v[32:35], v[172:175], v[56:71]
 buffer_load_dwordx4 v[228:231], v26, s[52:55], s81 offen offset:0 sc1
 ds_read_b64_tr_b16 v[48:49], v16 offset:6144
 ds_read_b64_tr_b16 v[50:51], v16 offset:6656
 v_mfma_f32_32x32x16_bf16 v[72:87], v[36:39], v[172:175], v[72:87]
 ds_read_b64_tr_b16 v[52:53], v17 offset:6144
 v_max3_u32 v248, v248, v172, v173
 ds_read_b64_tr_b16 v[54:55], v17 offset:6656
 v_max3_u32 v248, v248, v174, v175
 s_waitcnt vmcnt(13) lgkmcnt(4)
 v_mfma_f32_32x32x16_bf16 v[56:71], v[40:43], v[176:179], v[56:71]
 buffer_load_dwordx4 v[232:235], v26, s[52:55], s81 offen offset:1024 sc1
 ds_read_b64_tr_b16 v[32:33], v16 offset:8192
 ds_read_b64_tr_b16 v[34:35], v16 offset:8704
 v_mfma_f32_32x32x16_bf16 v[72:87], v[44:47], v[176:179], v[72:87]
 ds_read_b64_tr_b16 v[36:37], v17 offset:8192
 v_max3_u32 v248, v248, v176, v177
 ds_read_b64_tr_b16 v[38:39], v17 offset:8704
 v_max3_u32 v248, v248, v178, v179
 s_waitcnt vmcnt(13) lgkmcnt(4)
 v_mfma_f32_32x32x16_bf16 v[56:71], v[48:51], v[180:183], v[56:71]
 buffer_load_dwordx4 v[236:239], v26, s[52:55], s81 offen offset:2048 sc1
 ds_read_b64_tr_b16 v[40:41], v16 offset:10240
 ds_read_b64_tr_b16 v[42:43], v16 offset:10752
 v_mfma_f32_32x32x16_bf16 v[72:87], v[52:55], v[180:183], v[72:87]
 ds_read_b64_tr_b16 v[44:45], v17 offset:10240
 v_max3_u32 v248, v248, v180, v181
 ds_read_b64_tr_b16 v[46:47], v17 offset:10752
 v_max3_u32 v248, v248, v182, v183
 s_waitcnt vmcnt(13) lgkmcnt(4)
 v_mfma_f32_32x32x16_bf16 v[56:71], v[32:35], v[184:187], v[56:71]
 buffer_load_dwordx4 v[240:243], v26, s[52:55], s81 offen offset:3072 sc1
 ds_read_b64_tr_b16 v[48:49], v16 offset:12288
 ds_read_b64_tr_b16 v[50:51], v16 offset:12800
 v_mfma_f32_32x32x16_bf16 v[72:87], v[36:39], v[184:187], v[72:87]
 ds_read_b64_tr_b16 v[52:53], v17 offset:12288
 v_max3_u32 v248, v248, v184, v185
 ds_read_b64_tr_b16 v[54:55], v17 offset:12800
 v_max3_u32 v248, v248, v186, v187
 s_waitcnt vmcnt(13) lgkmcnt(4)
 v_mfma_f32_32x32x16_bf16 v[56:71], v[40:43], v[188:191], v[56:71]
 s_add_u32 s85, s81, 4096
 buffer_load_dwordx4 v[244:247], v26, s[52:55], s85 offen offset:0 sc1
 s_add_u32 s81, s81, 5120
 s_cmp_eq_u32 s81, s77
 s_cselect_b32 s81, s92, s81
 ds_read_b64_tr_b16 v[32:33], v16 offset:14336
 ds_read_b64_tr_b16 v[34:35], v16 offset:14848
 v_mfma_f32_32x32x16_bf16 v[72:87], v[44:47], v[188:191], v[72:87]
 ds_read_b64_tr_b16 v[36:37], v17 offset:14336
 v_max3_u32 v248, v248, v188, v189
 ds_read_b64_tr_b16 v[38:39], v17 offset:14848
 v_max3_u32 v248, v248, v190, v191
 s_waitcnt vmcnt(13) lgkmcnt(4)
 v_mfma_f32_32x32x16_bf16 v[56:71], v[48:51], v[192:195], v[56:71]
 ds_read_b64_tr_b16 v[40:41], v16 offset:16384
 ds_read_b64_tr_b16 v[42:43], v16 offset:16896
 v_mfma_f32_32x32x16_bf16 v[72:87], v[52:55], v[192:195], v[72:87]
 ds_read_b64_tr_b16 v[44:45], v17 offset:16384
 v_max3_u32 v248, v248, v192, v193
 ds_read_b64_tr_b16 v[46:47], v17 offset:16896
 v_max3_u32 v248, v248, v194, v195
 s_waitcnt vmcnt(12) lgkmcnt(4)
 v_mfma_f32_32x32x16_bf16 v[56:71], v[32:35], v[196:199], v[56:71]
 ds_read_b64_tr_b16 v[48:49], v16 offset:18432
 ds_read_b64_tr_b16 v[50:51], v16 offset:18944
 v_mfma_f32_32x32x16_bf16 v[72:87], v[36:39], v[196:199], v[72:87]
 ds_read_b64_tr_b16 v[52:53], v17 offset:18432
 v_max3_u32 v248, v248, v196, v197
 ds_read_b64_tr_b16 v[54:55], v17 offset:18944
 v_max3_u32 v248, v248, v198, v199
 s_waitcnt vmcnt(11) lgkmcnt(4)
 v_mfma_f32_32x32x16_bf16 v[56:71], v[40:43], v[200:203], v[56:71]
 ds_read_b64_tr_b16 v[32:33], v16 offset:20480
 ds_read_b64_tr_b16 v[34:35], v16 offset:20992
 v_mfma_f32_32x32x16_bf16 v[72:87], v[44:47], v[200:203], v[72:87]
 ds_read_b64_tr_b16 v[36:37], v17 offset:20480
 v_max3_u32 v248, v248, v200, v201
 ds_read_b64_tr_b16 v[38:39], v17 offset:20992
 v_max3_u32 v248, v248, v202, v203
 s_waitcnt vmcnt(10) lgkmcnt(4)
 v_mfma_f32_32x32x16_bf16 v[56:71], v[48:51], v[204:207], v[56:71]
 ds_read_b64_tr_b16 v[40:41], v16 offset:22528
 ds_read_b64_tr_b16 v[42:43], v16 offset:23040
 v_mfma_f32_32x32x16_bf16 v[72:87], v[52:55], v[204:207], v[72:87]
 ds_read_b64_tr_b16 v[44:45], v17 offset:22528
 v_max3_u32 v248, v248, v204, v205
 ds_read_b64_tr_b16 v[46:47], v17 offset:23040
 v_max3_u32 v248, v248, v206, v207
 s_waitcnt vmcnt(9) lgkmcnt(4)
 v_mfma_f32_32x32x16_bf16 v[56:71], v[32:35], v[208:211], v[56:71]
 ds_read_b64_tr_b16 v[48:49], v16 offset:24576
 ds_read_b64_tr_b16 v[50:51], v16 offset:25088
 v_mfma_f32_32x32x16_bf16 v[72:87], v[36:39], v[208:211], v[72:87]
 ds_read_b64_tr_b16 v[52:53], v17 offset:24576
 v_max3_u32 v248, v248, v208, v209
 ds_read_b64_tr_b16 v[54:55], v17 offset:25088
 v_max3_u32 v248, v248, v210, v211
 s_waitcnt vmcnt(8) lgkmcnt(4)
 v_mfma_f32_32x32x16_bf16 v[56:71], v[40:43], v[212:215], v[56:71]
 ds_read_b64_tr_b16 v[32:33], v16 offset:26624
 ds_read_b64_tr_b16 v[34:35], v16 offset:27136
 v_mfma_f32_32x32x16_bf16 v[72:87], v[44:47], v[212:215], v[72:87]
 ds_read_b64_tr_b16 v[36:37], v17 offset:26624
 v_max3_u32 v248, v248, v212, v213
 ds_read_b64_tr_b16 v[38:39], v17 offset:27136
 v_max3_u32 v248, v248, v214, v215
 s_waitcnt vmcnt(7) lgkmcnt(4)
 v_mfma_f32_32x32x16_bf16 v[56:71], v[48:51], v[216:219], v[56:71]
 ds_read_b64_tr_b16 v[40:41], v16 offset:28672
 ds_read_b64_tr_b16 v[42:43], v16 offset:29184
 v_mfma_f32_32x32x16_bf16 v[72:87], v[52:55], v[216:219], v[72:87]
 ds_read_b64_tr_b16 v[44:45], v17 offset:28672
 v_max3_u32 v248, v248, v216, v217
 ds_read_b64_tr_b16 v[46:47], v17 offset:29184
 v_max3_u32 v248, v248, v218, v219
 s_waitcnt vmcnt(6) lgkmcnt(4)
 v_mfma_f32_32x32x16_bf16 v[56:71], v[32:35], v[220:223], v[56:71]
 ds_read_b64_tr_b16 v[48:49], v16 offset:30720
 ds_read_b64_tr_b16 v[50:51], v16 offset:31232
 v_mfma_f32_32x32x16_bf16 v[72:87], v[36:39], v[220:223], v[72:87]
 ds_read_b64_tr_b16 v[52:53], v17 offset:30720
 v_max3_u32 v248, v248, v220, v221
 ds_read_b64_tr_b16 v[54:55], v17 offset:31232
 v_max3_u32 v248, v248, v222, v223
 s_waitcnt vmcnt(5) lgkmcnt(4)
 v_mfma_f32_32x32x16_bf16 v[56:71], v[40:43], v[224:227], v[56:71]
 ds_read_b64_tr_b16 v[32:33], v16 offset:32768
 ds_read_b64_tr_b16 v[34:35], v16 offset:33280
 v_mfma_f32_32x32x16_bf16 v[72:87], v[44:47], v[224:227], v[72:87]
 ds_read_b64_tr_b16 v[36:37], v17 offset:32768
 v_max3_u32 v248, v248, v224, v225
 ds_read_b64_tr_b16 v[38:39], v17 offset:33280
 v_max3_u32 v248, v248, v226, v227
 s_waitcnt vmcnt(4) lgkmcnt(4)
 v_mfma_f32_32x32x16_bf16 v[56:71], v[48:51], v[228:231], v[56:71]
 ds_read_b64_tr_b16 v[40:41], v16 offset:34816
 ds_read_b64_tr_b16 v[42:43], v16 offset:35328
 v_mfma_f32_32x32x16_bf16 v[72:87], v[52:55], v[228:231], v[72:87]
 ds_read_b64_tr_b16 v[44:45], v17 offset:34816
 v_max3_u32 v248, v248, v228, v229
 ds_read_b64_tr_b16 v[46:47], v17 offset:35328
 v_max3_u32 v248, v248, v230, v231
 s_waitcnt vmcnt(3) lgkmcnt(4)
 v_mfma_f32_32x32x16_bf16 v[56:71], v[32:35], v[232:235], v[56:71]
 ds_read_b64_tr_b16 v[48:49], v16 offset:36864
 ds_read_b64_tr_b16 v[50:51], v16 offset:37376
 v_mfma_f32_32x32x16_bf16 v[72:87], v[36:39], v[232:235], v[72:87]
 ds_read_b64_tr_b16 v[52:53], v17 offset:36864
 v_max3_u32 v248, v248, v232, v233
 ds_read_b64_tr_b16 v[54:55], v17 offset:37376
 v_max3_u32 v248, v248, v234, v235
 s_waitcnt vmcnt(2) lgkmcnt(4)
 v_mfma_f32_32x32x16_bf16 v[56:71], v[40:43], v[236:239], v[56:71]
 ds_read_b64_tr_b16 v[32:33], v16 offset:38912
 ds_read_b64_tr_b16 v[34:35], v16 offset:39424
 v_mfma_f32_32x32x16_bf16 v[72:87], v[44:47], v[236:239], v[72:87]
 ds_read_b64_tr_b16 v[36:37], v17 offset:38912
 v_max3_u32 v248, v248, v236, v237
 ds_read_b64_tr_b16 v[38:39], v17 offset:39424
 v_max3_u32 v248, v248, v238, v239
 s_waitcnt vmcnt(1) lgkmcnt(4)
 v_mfma_f32_32x32x16_bf16 v[56:71], v[48:51], v[240:243], v[56:71]
 v_mfma_f32_32x32x16_bf16 v[72:87], v[52:55], v[240:243], v[72:87]
 v_max3_u32 v248, v248, v240, v241
 v_max3_u32 v248, v248, v242, v243
 s_waitcnt vmcnt(0) lgkmcnt(0)
 v_mfma_f32_32x32x16_bf16 v[56:71], v[32:35], v[244:247], v[56:71]
 v_mfma_f32_32x32x16_bf16 v[72:87], v[36:39], v[244:247], v[72:87]
 v_max3_u32 v248, v248, v244, v245
 v_max3_u32 v248, v248, v246, v247
 v_cmp_eq_u32_e64 vcc, -1, v248
 s_mul_i32 s78, s68, 81920
 s_cmp_lt_i32 s94, 1
 s_cbranch_scc1 g2_out
 s_sub_u32 s94, s94, 1
 s_nop 7
 s_nop 7
 s_cbranch_vccnz g2_retry
g2_out:
 v_cvt_pk_bf16_f32 v88, v56, v57
 v_cvt_pk_bf16_f32 v89, v58, v59
 ds_write_b64 v24, v[88:89] offset:0
 v_cvt_pk_bf16_f32 v90, v60, v61
 v_cvt_pk_bf16_f32 v91, v62, v63
 ds_write_b64 v24, v[90:91] offset:16
 v_cvt_pk_bf16_f32 v92, v64, v65
 v_cvt_pk_bf16_f32 v93, v66, v67
 ds_write_b64 v24, v[92:93] offset:32
 v_cvt_pk_bf16_f32 v94, v68, v69
 v_cvt_pk_bf16_f32 v95, v70, v71
 ds_write_b64 v24, v[94:95] offset:48
 v_cvt_pk_bf16_f32 v96, v72, v73
 v_cvt_pk_bf16_f32 v97, v74, v75
 ds_write_b64 v24, v[96:97] offset:64
 v_cvt_pk_bf16_f32 v98, v76, v77
 v_cvt_pk_bf16_f32 v99, v78, v79
 ds_write_b64 v24, v[98:99] offset:80
 v_cvt_pk_bf16_f32 v100, v80, v81
 v_cvt_pk_bf16_f32 v101, v82, v83
 ds_write_b64 v24, v[100:101] offset:96
 v_cvt_pk_bf16_f32 v102, v84, v85
 v_cvt_pk_bf16_f32 v103, v86, v87
 ds_write_b64 v24, v[102:103] offset:112
 ds_read_b128 v[104:107], v25 offset:0
 ds_read_b128 v[108:111], v25 offset:1152
 ds_read_b128 v[112:115], v25 offset:2304
 ds_read_b128 v[116:119], v25 offset:3456
 s_waitcnt lgkmcnt(3)
 buffer_store_dwordx4 v[104:107], v27, s[56:59], s78 offen sc1
 s_add_u32 s78, s78, 20480
 s_waitcnt lgkmcnt(2)
 buffer_store_dwordx4 v[108:111], v27, s[56:59], s78 offen sc1
 s_add_u32 s78, s78, 20480
 s_waitcnt lgkmcnt(1)
 buffer_store_dwordx4 v[112:115], v27, s[56:59], s78 offen sc1
 s_add_u32 s78, s78, 20480
 s_waitcnt lgkmcnt(0)
 buffer_store_dwordx4 v[116:119], v27, s[56:59], s78 offen sc1
 s_endpgm
roleB:
 s_and_b32 s71, s2, 7
 s_lshr_b32 s70, s2, 3
 s_sub_u32 s70, s70, 16
 s_lshl_b32 s69, s71, 3
 s_add_u32 s69, s69, s70
 s_lshl_b32 s71, s71, 1
 s_add_u32 s71, s71, s70
 s_add_u32 s71, s71, 56
 s_cmp_ge_u32 s70, 8
 s_cselect_b32 s69, s71, s69
 v_and_b32 v1, 63, v0
 v_and_b32_e64 v2, 15, v0
 v_bfe_u32 v3, v0, 4, 2
 v_mov_b32 v4, 0
 v_lshlrev_b32_e64 v5, 2, v1
 s_waitcnt lgkmcnt(0)
 s_mov_b32 s44, s18
 s_mov_b32 s45, s19
 s_mov_b32 s46, 163840
 s_mov_b32 s47, 0x20000
 s_mov_b32 s48, s20
 s_mov_b32 s49, s21
 s_mov_b32 s50, 163840
 s_mov_b32 s51, 0x20000
 s_mov_b32 s52, s22
 s_mov_b32 s53, s23
 s_mov_b32 s54, 163840
 s_mov_b32 s55, 0x20000
 s_mov_b32 s56, s24
 s_mov_b32 s57, s25
 s_mov_b32 s58, 163840
 s_mov_b32 s59, 0x20000
 s_mov_b32 s60, s26
 s_mov_b32 s61, s27
 s_mov_b32 s62, 1280
 s_mov_b32 s63, 0x20000
 s_mov_b32 s64, s28
 s_mov_b32 s65, s29
 s_mov_b32 s66, 1280
 s_mov_b32 s67, 0x20000
 s_lshl_b32 s71, s69, 3
 s_add_u32 s71, s71, s68
 s_lshl_b32 s81, s71, 8
 s_lshl_b32 s80, s71, 1
 buffer_load_ushort v12, v4, s[60:63], s80 offen
 buffer_load_dword v8, v5, s[44:47], s81 offen nt
 buffer_load_dword v9, v5, s[48:51], s81 offen nt
 buffer_load_dword v10, v5, s[52:55], s81 offen nt
 buffer_load_dword v11, v5, s[56:59], s81 offen nt
 buffer_load_ushort v13, v4, s[64:67], s80 offen
 s_mov_b32 s76, s34
 s_mov_b32 s77, s35
 s_mov_b32 s78, 13631488
 s_mov_b32 s79, 0x20000
 s_mov_b32 s4, 385024
 buffer_load_dword v253, v4, s[76:79], s4 offen sc1
 s_lshr_b32 s93, s2, 3
 s_sub_u32 s93, s93, 16
 s_and_b32 s94, s2, 6
 s_lshl_b32 s94, s94, 1
 s_and_b32 s92, s2, 1
 s_lshl_b32 s92, s92, 2
 s_and_b32 s4, s93, 3
 s_add_u32 s92, s92, s4
 s_lshr_b32 s93, s93, 2
 s_add_u32 s94, s94, s93
 s_add_u32 s93, s94, s92
 s_mul_i32 s93, s93, 3
 s_mul_i32 s92, s92, 160
 s_lshr_b32 s95, s68, 1
 s_add_u32 s95, s95, 1
 s_mul_i32 s95, s95, 1280
 s_add_u32 s92, s92, s95
 s_andn2_b32 s92, s92, 127
 s_and_b32 s95, s68, 1
 s_lshl_b32 s95, s95, 7
 s_add_u32 s92, s92, s95
 v_mul_u32_u24 v250, 3840, v1
 v_mul_u32_u24 v249, 1280, v1
 s_lshl_b32 s94, s94, 1
 s_and_b32 s95, s68, 1
 s_add_u32 s94, s94, s95
 s_mul_i32 s94, s94, 81920
 s_mov_b32 s96, s10
 s_mov_b32 s97, s11
 s_mov_b32 s98, 2457600
 s_mov_b32 s99, 0x20000
 s_add_u32 s100, s93, 1
 s_mul_i32 s95, s100, 205
 s_lshr_b32 s95, s95, 11
 s_mul_i32 s95, s95, 10
 s_sub_u32 s100, s100, s95
 s_mul_i32 s100, s100, 245760
 s_add_u32 s100, s100, s92
 buffer_load_dword v254, v250, s[96:99], s100 offen
 s_mov_b32 s96, s8
 s_mov_b32 s97, s9
 s_mov_b32 s98, 2621440
 s_mov_b32 s99, 0x20000
 s_lshr_b32 s100, s68, 1
 s_add_u32 s100, s100, s93
 s_add_u32 s100, s100, 1
 s_mul_i32 s95, s100, 205
 s_lshr_b32 s95, s95, 11
 s_mul_i32 s95, s95, 10
 s_sub_u32 s100, s100, s95
 s_lshl_b32 s100, s100, 7
 s_add_u32 s100, s100, s94
 buffer_load_dword v254, v249, s[96:99], s100 offen
 s_mov_b32 s96, s10
 s_mov_b32 s97, s11
 s_mov_b32 s98, 2457600
 s_mov_b32 s99, 0x20000
 s_add_u32 s100, s93, 2
 s_mul_i32 s95, s100, 205
 s_lshr_b32 s95, s95, 11
 s_mul_i32 s95, s95, 10
 s_sub_u32 s100, s100, s95
 s_mul_i32 s100, s100, 245760
 s_add_u32 s100, s100, s92
 buffer_load_dword v254, v250, s[96:99], s100 offen
 s_mov_b32 s96, s10
 s_mov_b32 s97, s11
 s_mov_b32 s98, 2457600
 s_mov_b32 s99, 0x20000
 s_add_u32 s100, s93, 3
 s_mul_i32 s95, s100, 205
 s_lshr_b32 s95, s95, 11
 s_mul_i32 s95, s95, 10
 s_sub_u32 s100, s100, s95
 s_mul_i32 s100, s100, 245760
 s_add_u32 s100, s100, s92
 buffer_load_dword v254, v250, s[96:99], s100 offen
 s_mov_b32 s96, s8
 s_mov_b32 s97, s9
 s_mov_b32 s98, 2621440
 s_mov_b32 s99, 0x20000
 s_lshr_b32 s100, s68, 1
 s_add_u32 s100, s100, s93
 s_add_u32 s100, s100, 3
 s_mul_i32 s95, s100, 205
 s_lshr_b32 s95, s95, 11
 s_mul_i32 s95, s95, 10
 s_sub_u32 s100, s100, s95
 s_lshl_b32 s100, s100, 7
 s_add_u32 s100, s100, s94
 buffer_load_dword v254, v249, s[96:99], s100 offen
 s_lshr_b32 s80, s69, 3
 s_lshl_b32 s39, s80, 12
 s_add_u32 s39, s39, 237568
 s_lshl_b32 s101, s69, 2
 s_add_u32 s101, s101, s68
 s_lshl_b32 s101, s101, 7
 s_add_u32 s101, s101, 278528
 s_lshl_b32 s6, s69, 15
 s_lshl_b32 s7, s68, 13
 s_add_u32 s6, s6, s7
 s_add_u32 s6, s6, 10485760
 s_add_u32 s7, s6, 4096
 v_lshlrev_b32 v39, 4, v1
 v_cmp_eq_u32 vcc, 0, v1
 v_mov_b32 v15, 0x80000000
 s_nop 0
 v_cndmask_b32 v15, v15, v4, vcc
 s_lshl_b32 s80, s69, 4
 s_add_u32 s40, s16, s80
 s_addc_u32 s41, s17, 0
 s_mov_b32 s42, 0
 s_mov_b32 s43, 0x20000
 s_sub_u32 s42, 2621440, s80
 v_mul_u32_u24 v6, 1280, v1
 s_and_b32 s5, s69, 7
 s_lshl_b32 s81, s68, 3
 s_add_u32 s5, s5, s81
 s_mov_b32 s72, s30
 s_mov_b32 s73, s31
 s_mov_b32 s74, 5242880
 s_mov_b32 s75, 0x20000
 s_mul_i32 s83, s68, 4608
 s_add_u32 s83, s83, 99968
 s_mul_i32 s84, s68, 8704
 s_add_u32 s84, s84, 118400
 v_lshl_add_u32 v24, v1, 3, s84
 v_mul_u32_u24 v25, 544, v2
 v_lshl_add_u32 v25, v3, 4, v25
 v_add_u32 v25, s84, v25
 v_cmp_gt_u32 vcc, 2, v3
 v_lshrrev_b32 v40, 1, v3
 v_and_b32 v41, 1, v3
 v_lshlrev_b32 v26, 9, v40
 v_lshl_add_u32 v26, v41, 4, v26
 v_lshl_add_u32 v26, v2, 5, v26
 v_add_u32 v26, s84, v26
 v_lshlrev_b32 v42, 4, v2
 v_lshlrev_b32 v43, 3, v2
 v_cndmask_b32 v42, v43, v42, vcc
 v_lshl_add_u32 v27, v3, 8, v42
 v_add_u32_e64 v27, s84, v27
 s_branch pb0_skip
.p2align 12
pb0:
 s_setpc_b64 s[36:37]
 s_nop 0
pb0_skip:
 v_mov_b32 v42, 128
 v_mov_b32 v43, 8
 v_cndmask_b32 v42, v42, v43, vcc
 v_add_u32 v28, v27, v42
 v_lshlrev_b32 v29, 8, v3
 v_lshl_add_u32 v29, v2, 2, v29
 v_add_u32_e64 v29, s84, v29
 v_lshl_add_u32 v30, v1, 2, s84
 v_lshl_add_u32 v31, v1, 3, s84
 v_and_b32_e64 v40, 31, v0
 v_lshl_add_u32 v32, v40, 4, s84
 v_lshl_add_u32 v33, v40, 5, s84
 v_lshlrev_b32 v41, 4, v1
 v_sub_u32 v34, s83, v41
 v_add_u32 v34, 1008, v34
 v_lshlrev_b32 v41, 4, v40
 v_sub_u32 v35, s83, v41
 v_add_u32 v35, 496, v35
 v_and_b32 v40, 1, v0
 v_cmp_eq_u32 vcc, 1, v40
 v_mov_b32 v41, 0xffff
 v_mov_b32 v42, -1
 v_cndmask_b32 v37, v41, v42, vcc
 s_mov_b32 s85, 0xffff
 s_mov_b32 s86, 0x3fb8aa3b
 s_mov_b32 s87, 0x32a57060
 s_mov_b32 s88, 0x3f317218
 s_mov_b32 s89, 0xffff0000
 v_mov_b32 v20, 0
 v_mov_b32 v21, 0
 v_mov_b32 v22, 0
 v_mov_b32 v23, 0
 v_lshlrev_b32_e64 v40, 4, v2
 ds_write_b128 v40, v[20:23] offset:0
 v_lshrrev_b32_e64 v40, 2, v1
 v_mul_u32_u24 v40, 4168, v40
 v_and_b32_e64 v41, 3, v0
 v_lshl_add_u32 v40, v41, 3, v40
 ds_write_b64 v40, v[20:21] offset:33280
 v_and_b32_e64 v40, 31, v0
 v_lshl_add_u32 v38, v40, 4, s83
 ds_write_b128 v38, v[20:23] offset:4096
 v_lshlrev_b32 v41, 5, v2
 v_sub_u32 v36, s83, v41
 v_lshl_add_u32 v36, v3, 4, v36
 v_add_u32 v36, 480, v36
 s_waitcnt vmcnt(11)
 v_lshlrev_b32 v46, 16, v12
 v_mul_f32_e64 v40, s86, v46
 v_fma_f32 v41, v46, s86, -v40
 v_exp_f32_e64 v40, v40
 v_fma_f32 v41, v46, s87, v41
 v_mul_f32_e64 v41, s88, v41
 v_fma_f32 v40, v40, v41, v40
 v_cvt_pk_bf16_f32 v40, v40, v40
 v_and_b32 v47, s89, v40
 s_waitcnt vmcnt(6)
 v_add_f32 v44, v47, v47
 v_lshlrev_b32 v46, 16, v8
 v_mul_f32_e64 v40, s86, v46
 v_fma_f32 v41, v46, s86, -v40
 v_exp_f32_e64 v40, v40
 v_fma_f32 v41, v46, s87, v41
 v_mul_f32_e64 v41, s88, v41
 v_fma_f32 v40, v40, v41, v40
 v_cvt_pk_bf16_f32 v40, v40, v40
 v_and_b32 v45, s89, v40
 v_mul_f32 v45, v45, v47
 v_mul_f32 v92, s86, v45
 v_lshlrev_b32 v46, 16, v9
 v_mul_f32 v46, v46, v47
 v_mul_f32 v94, 0.15915494, v46
 v_lshlrev_b32 v45, 16, v10
 v_lshlrev_b32 v46, 16, v11
 v_mul_f32 v84, v45, v44
 v_mul_f32 v85, v46, v44
 v_and_b32 v46, s89, v8
 v_mul_f32 v40, s86, v46
 v_fma_f32 v41, v46, s86, -v40
 v_exp_f32_e64 v40, v40
 v_fma_f32 v41, v46, s87, v41
 v_mul_f32_e64 v41, s88, v41
 v_fma_f32 v40, v40, v41, v40
 v_cvt_pk_bf16_f32 v40, v40, v40
 v_and_b32 v45, s89, v40
 v_mul_f32 v45, v45, v47
 v_mul_f32 v93, s86, v45
 v_and_b32 v46, s89, v9
 v_mul_f32 v46, v46, v47
 v_mul_f32 v95, 0.15915494, v46
 v_and_b32 v45, s89, v10
 v_and_b32 v46, s89, v11
 v_mul_f32 v86, v45, v44
 v_mul_f32 v87, v46, v44
 v_mul_f32 v40, 0xc1000000, v92
 v_mul_f32 v41, 0x41000000, v94
 v_mul_f32 v42, 0xc1000000, v93
 v_mul_f32 v43, 0x41000000, v95
 v_exp_f32 v40, v40
 v_fract_f32 v41, v41
 v_exp_f32 v42, v42
 v_fract_f32 v43, v43
 v_cos_f32 v76, v41
 v_sin_f32 v77, v41
 v_cos_f32 v78, v43
 v_sin_f32 v79, v43
 v_pk_mul_f32 v[76:77], v[76:77], v[40:41] op_sel_hi:[1,0]
 v_pk_mul_f32 v[78:79], v[78:79], v[42:43] op_sel_hi:[1,0]
 v_mul_f32 v40, 0xbf800000, v92
 v_mul_f32 v41, 0x3f800000, v94
 v_mul_f32 v42, 0xbf800000, v93
 v_mul_f32 v43, 0x3f800000, v95
 v_exp_f32 v40, v40
 v_fract_f32 v41, v41
 v_exp_f32 v42, v42
 v_fract_f32 v43, v43
 v_cos_f32 v48, v41
 v_sin_f32 v49, v41
 v_cos_f32 v50, v43
 v_sin_f32 v51, v43
 v_pk_mul_f32 v[48:49], v[48:49], v[40:41] op_sel_hi:[1,0]
 v_pk_mul_f32 v[50:51], v[50:51], v[42:43] op_sel_hi:[1,0]
 v_mul_f32 v40, 0xc3000000, v92
 v_mul_f32 v41, 0x43000000, v94
 v_mul_f32 v42, 0xc3000000, v93
 v_mul_f32 v43, 0x43000000, v95
 v_exp_f32 v40, v40
 v_fract_f32 v41, v41
 v_exp_f32 v42, v42
 v_fract_f32 v43, v43
 v_cos_f32 v80, v41
 v_sin_f32 v81, v41
 v_cos_f32 v82, v43
 v_sin_f32 v83, v43
 v_pk_mul_f32 v[80:81], v[80:81], v[40:41] op_sel_hi:[1,0]
 v_pk_mul_f32 v[82:83], v[82:83], v[42:43] op_sel_hi:[1,0]
 v_mov_b32 v106, 0x3f80
 v_mov_b32 v107, 0x3f80
 ds_write_b64 v24, v[106:107]
 v_cvt_pk_bf16_f32 v100, v76, -v77
 v_cvt_pk_bf16_f32 v101, v78, -v79
 ds_write_b64 v24, v[100:101] offset:544
 v_pk_mul_f32 v[92:93], v[76:77], v[76:77] op_sel:[0,0] op_sel_hi:[0,1]
 v_pk_fma_f32 v[92:93], v[76:77], v[76:77], v[92:93] op_sel:[1,1,0] op_sel_hi:[1,0,1] neg_lo:[0,1,0]
 v_pk_mul_f32 v[94:95], v[78:79], v[78:79] op_sel:[0,0] op_sel_hi:[0,1]
 v_pk_fma_f32 v[94:95], v[78:79], v[78:79], v[94:95] op_sel:[1,1,0] op_sel_hi:[1,0,1] neg_lo:[0,1,0]
 v_cvt_pk_bf16_f32 v102, v92, -v93
 v_cvt_pk_bf16_f32 v103, v94, -v95
 ds_write_b64 v24, v[102:103] offset:1088
 v_pk_mul_f32 v[96:97], v[92:93], v[76:77] op_sel:[0,0] op_sel_hi:[0,1]
 v_pk_fma_f32 v[96:97], v[92:93], v[76:77], v[96:97] op_sel:[1,1,0] op_sel_hi:[1,0,1] neg_lo:[0,1,0]
 v_pk_mul_f32 v[98:99], v[94:95], v[78:79] op_sel:[0,0] op_sel_hi:[0,1]
 v_pk_fma_f32 v[98:99], v[94:95], v[78:79], v[98:99] op_sel:[1,1,0] op_sel_hi:[1,0,1] neg_lo:[0,1,0]
 v_cvt_pk_bf16_f32 v104, v96, -v97
 v_cvt_pk_bf16_f32 v105, v98, -v99
 ds_write_b64 v24, v[104:105] offset:1632
 v_pk_mul_f32 v[92:93], v[96:97], v[76:77] op_sel:[0,0] op_sel_hi:[0,1]
 v_pk_fma_f32 v[92:93], v[96:97], v[76:77], v[92:93] op_sel:[1,1,0] op_sel_hi:[1,0,1] neg_lo:[0,1,0]
 v_pk_mul_f32 v[94:95], v[98:99], v[78:79] op_sel:[0,0] op_sel_hi:[0,1]
 v_pk_fma_f32 v[94:95], v[98:99], v[78:79], v[94:95] op_sel:[1,1,0] op_sel_hi:[1,0,1] neg_lo:[0,1,0]
 v_cvt_pk_bf16_f32 v106, v92, -v93
 v_cvt_pk_bf16_f32 v107, v94, -v95
 ds_write_b64 v24, v[106:107] offset:2176
 v_pk_mul_f32 v[96:97], v[92:93], v[76:77] op_sel:[0,0] op_sel_hi:[0,1]
 v_pk_fma_f32 v[96:97], v[92:93], v[76:77], v[96:97] op_sel:[1,1,0] op_sel_hi:[1,0,1] neg_lo:[0,1,0]
 v_pk_mul_f32 v[98:99], v[94:95], v[78:79] op_sel:[0,0] op_sel_hi:[0,1]
 v_pk_fma_f32 v[98:99], v[94:95], v[78:79], v[98:99] op_sel:[1,1,0] op_sel_hi:[1,0,1] neg_lo:[0,1,0]
 v_cvt_pk_bf16_f32 v100, v96, -v97
 v_cvt_pk_bf16_f32 v101, v98, -v99
 ds_write_b64 v24, v[100:101] offset:2720
 v_pk_mul_f32 v[92:93], v[96:97], v[76:77] op_sel:[0,0] op_sel_hi:[0,1]
 v_pk_fma_f32 v[92:93], v[96:97], v[76:77], v[92:93] op_sel:[1,1,0] op_sel_hi:[1,0,1] neg_lo:[0,1,0]
 v_pk_mul_f32 v[94:95], v[98:99], v[78:79] op_sel:[0,0] op_sel_hi:[0,1]
 v_pk_fma_f32 v[94:95], v[98:99], v[78:79], v[94:95] op_sel:[1,1,0] op_sel_hi:[1,0,1] neg_lo:[0,1,0]
 v_cvt_pk_bf16_f32 v102, v92, -v93
 v_cvt_pk_bf16_f32 v103, v94, -v95
 ds_write_b64 v24, v[102:103] offset:3264
 v_pk_mul_f32 v[96:97], v[92:93], v[76:77] op_sel:[0,0] op_sel_hi:[0,1]
 v_pk_fma_f32 v[96:97], v[92:93], v[76:77], v[96:97] op_sel:[1,1,0] op_sel_hi:[1,0,1] neg_lo:[0,1,0]
 v_pk_mul_f32 v[98:99], v[94:95], v[78:79] op_sel:[0,0] op_sel_hi:[0,1]
 v_pk_fma_f32 v[98:99], v[94:95], v[78:79], v[98:99] op_sel:[1,1,0] op_sel_hi:[1,0,1] neg_lo:[0,1,0]
 v_cvt_pk_bf16_f32 v104, v96, -v97
 v_cvt_pk_bf16_f32 v105, v98, -v99
 ds_write_b64 v24, v[104:105] offset:3808
 v_pk_mul_f32 v[92:93], v[96:97], v[76:77] op_sel:[0,0] op_sel_hi:[0,1]
 v_pk_fma_f32 v[92:93], v[96:97], v[76:77], v[92:93] op_sel:[1,1,0] op_sel_hi:[1,0,1] neg_lo:[0,1,0]
 v_pk_mul_f32 v[94:95], v[98:99], v[78:79] op_sel:[0,0] op_sel_hi:[0,1]
 v_pk_fma_f32 v[94:95], v[98:99], v[78:79], v[94:95] op_sel:[1,1,0] op_sel_hi:[1,0,1] neg_lo:[0,1,0]
 v_cvt_pk_bf16_f32 v106, v92, -v93
 v_cvt_pk_bf16_f32 v107, v94, -v95
 ds_write_b64 v24, v[106:107] offset:4352
 v_pk_mul_f32 v[96:97], v[92:93], v[76:77] op_sel:[0,0] op_sel_hi:[0,1]
 v_pk_fma_f32 v[96:97], v[92:93], v[76:77], v[96:97] op_sel:[1,1,0] op_sel_hi:[1,0,1] neg_lo:[0,1,0]
 v_pk_mul_f32 v[98:99], v[94:95], v[78:79] op_sel:[0,0] op_sel_hi:[0,1]
 v_pk_fma_f32 v[98:99], v[94:95], v[78:79], v[98:99] op_sel:[1,1,0] op_sel_hi:[1,0,1] neg_lo:[0,1,0]
 v_cvt_pk_bf16_f32 v100, v96, -v97
 v_cvt_pk_bf16_f32 v101, v98, -v99
 ds_write_b64 v24, v[100:101] offset:4896
 v_pk_mul_f32 v[92:93], v[96:97], v[76:77] op_sel:[0,0] op_sel_hi:[0,1]
 v_pk_fma_f32 v[92:93], v[96:97], v[76:77], v[92:93] op_sel:[1,1,0] op_sel_hi:[1,0,1] neg_lo:[0,1,0]
 v_pk_mul_f32 v[94:95], v[98:99], v[78:79] op_sel:[0,0] op_sel_hi:[0,1]
 v_pk_fma_f32 v[94:95], v[98:99], v[78:79], v[94:95] op_sel:[1,1,0] op_sel_hi:[1,0,1] neg_lo:[0,1,0]
 v_cvt_pk_bf16_f32 v102, v92, -v93
 v_cvt_pk_bf16_f32 v103, v94, -v95
 ds_write_b64 v24, v[102:103] offset:5440
 v_pk_mul_f32 v[96:97], v[92:93], v[76:77] op_sel:[0,0] op_sel_hi:[0,1]
 v_pk_fma_f32 v[96:97], v[92:93], v[76:77], v[96:97] op_sel:[1,1,0] op_sel_hi:[1,0,1] neg_lo:[0,1,0]
 v_pk_mul_f32 v[98:99], v[94:95], v[78:79] op_sel:[0,0] op_sel_hi:[0,1]
 v_pk_fma_f32 v[98:99], v[94:95], v[78:79], v[98:99] op_sel:[1,1,0] op_sel_hi:[1,0,1] neg_lo:[0,1,0]
 v_cvt_pk_bf16_f32 v104, v96, -v97
 v_cvt_pk_bf16_f32 v105, v98, -v99
 ds_write_b64 v24, v[104:105] offset:5984
 s_add_u32 s81, s5, 0
 s_and_b32 s81, s81, 31
 s_mul_i32 s82, s81, 81920
 s_lshl_b32 s81, s81, 10
 s_add_u32 m0, s81, 256
 s_nop 0
 buffer_load_dwordx4 v6, s[40:43], s82 offen lds
 v_pk_mul_f32 v[92:93], v[96:97], v[76:77] op_sel:[0,0] op_sel_hi:[0,1]
 v_pk_fma_f32 v[92:93], v[96:97], v[76:77], v[92:93] op_sel:[1,1,0] op_sel_hi:[1,0,1] neg_lo:[0,1,0]
 v_pk_mul_f32 v[94:95], v[98:99], v[78:79] op_sel:[0,0] op_sel_hi:[0,1]
 v_pk_fma_f32 v[94:95], v[98:99], v[78:79], v[94:95] op_sel:[1,1,0] op_sel_hi:[1,0,1] neg_lo:[0,1,0]
 v_cvt_pk_bf16_f32 v106, v92, -v93
 v_cvt_pk_bf16_f32 v107, v94, -v95
 ds_write_b64 v24, v[106:107] offset:6528
 v_pk_mul_f32 v[96:97], v[92:93], v[76:77] op_sel:[0,0] op_sel_hi:[0,1]
 v_pk_fma_f32 v[96:97], v[92:93], v[76:77], v[96:97] op_sel:[1,1,0] op_sel_hi:[1,0,1] neg_lo:[0,1,0]
 v_pk_mul_f32 v[98:99], v[94:95], v[78:79] op_sel:[0,0] op_sel_hi:[0,1]
 v_pk_fma_f32 v[98:99], v[94:95], v[78:79], v[98:99] op_sel:[1,1,0] op_sel_hi:[1,0,1] neg_lo:[0,1,0]
 v_cvt_pk_bf16_f32 v100, v96, -v97
 v_cvt_pk_bf16_f32 v101, v98, -v99
 ds_write_b64 v24, v[100:101] offset:7072
 v_pk_mul_f32 v[92:93], v[96:97], v[76:77] op_sel:[0,0] op_sel_hi:[0,1]
 v_pk_fma_f32 v[92:93], v[96:97], v[76:77], v[92:93] op_sel:[1,1,0] op_sel_hi:[1,0,1] neg_lo:[0,1,0]
 v_pk_mul_f32 v[94:95], v[98:99], v[78:79] op_sel:[0,0] op_sel_hi:[0,1]
 v_pk_fma_f32 v[94:95], v[98:99], v[78:79], v[94:95] op_sel:[1,1,0] op_sel_hi:[1,0,1] neg_lo:[0,1,0]
 v_cvt_pk_bf16_f32 v102, v92, -v93
 v_cvt_pk_bf16_f32 v103, v94, -v95
 ds_write_b64 v24, v[102:103] offset:7616
 v_pk_mul_f32 v[96:97], v[92:93], v[76:77] op_sel:[0,0] op_sel_hi:[0,1]
 v_pk_fma_f32 v[96:97], v[92:93], v[76:77], v[96:97] op_sel:[1,1,0] op_sel_hi:[1,0,1] neg_lo:[0,1,0]
 v_pk_mul_f32 v[98:99], v[94:95], v[78:79] op_sel:[0,0] op_sel_hi:[0,1]
 v_pk_fma_f32 v[98:99], v[94:95], v[78:79], v[98:99] op_sel:[1,1,0] op_sel_hi:[1,0,1] neg_lo:[0,1,0]
 v_cvt_pk_bf16_f32 v104, v96, -v97
 v_cvt_pk_bf16_f32 v105, v98, -v99
 ds_write_b64 v24, v[104:105] offset:8160
 ds_read_b128 v[108:111], v25 offset:0
 ds_read_b128 v[112:115], v25 offset:64
 ds_read_b128 v[116:119], v25 offset:128
 ds_read_b128 v[120:123], v25 offset:192
 ds_read_b128 v[124:127], v25 offset:256
 ds_read_b128 v[128:131], v25 offset:320
 ds_read_b128 v[132:135], v25 offset:384
 ds_read_b128 v[136:139], v25 offset:448
 v_pk_mul_f32 v[52:53], v[48:49], v[48:49] op_sel:[0,0] op_sel_hi:[0,1]
 v_pk_fma_f32 v[52:53], v[48:49], v[48:49], v[52:53] op_sel:[1,1,0] op_sel_hi:[1,0,1] neg_lo:[0,1,0]
 v_pk_mul_f32 v[54:55], v[50:51], v[50:51] op_sel:[0,0] op_sel_hi:[0,1]
 v_pk_fma_f32 v[54:55], v[50:51], v[50:51], v[54:55] op_sel:[1,1,0] op_sel_hi:[1,0,1] neg_lo:[0,1,0]
 v_pk_mul_f32 v[56:57], v[52:53], v[48:49] op_sel:[0,0] op_sel_hi:[0,1]
 v_pk_fma_f32 v[56:57], v[52:53], v[48:49], v[56:57] op_sel:[1,1,0] op_sel_hi:[1,0,1] neg_lo:[0,1,0]
 v_pk_mul_f32 v[58:59], v[54:55], v[50:51] op_sel:[0,0] op_sel_hi:[0,1]
 v_pk_fma_f32 v[58:59], v[54:55], v[50:51], v[58:59] op_sel:[1,1,0] op_sel_hi:[1,0,1] neg_lo:[0,1,0]
 v_pk_mul_f32 v[60:61], v[56:57], v[48:49] op_sel:[0,0] op_sel_hi:[0,1]
 v_pk_fma_f32 v[60:61], v[56:57], v[48:49], v[60:61] op_sel:[1,1,0] op_sel_hi:[1,0,1] neg_lo:[0,1,0]
 v_pk_mul_f32 v[62:63], v[58:59], v[50:51] op_sel:[0,0] op_sel_hi:[0,1]
 v_pk_fma_f32 v[62:63], v[58:59], v[50:51], v[62:63] op_sel:[1,1,0] op_sel_hi:[1,0,1] neg_lo:[0,1,0]
 v_pk_mul_f32 v[64:65], v[60:61], v[48:49] op_sel:[0,0] op_sel_hi:[0,1]
 v_pk_fma_f32 v[64:65], v[60:61], v[48:49], v[64:65] op_sel:[1,1,0] op_sel_hi:[1,0,1] neg_lo:[0,1,0]
 v_pk_mul_f32 v[66:67], v[62:63], v[50:51] op_sel:[0,0] op_sel_hi:[0,1]
 v_pk_fma_f32 v[66:67], v[62:63], v[50:51], v[66:67] op_sel:[1,1,0] op_sel_hi:[1,0,1] neg_lo:[0,1,0]
 v_pk_mul_f32 v[68:69], v[64:65], v[48:49] op_sel:[0,0] op_sel_hi:[0,1]
 v_pk_fma_f32 v[68:69], v[64:65], v[48:49], v[68:69] op_sel:[1,1,0] op_sel_hi:[1,0,1] neg_lo:[0,1,0]
 v_pk_mul_f32 v[70:71], v[66:67], v[50:51] op_sel:[0,0] op_sel_hi:[0,1]
 v_pk_fma_f32 v[70:71], v[66:67], v[50:51], v[70:71] op_sel:[1,1,0] op_sel_hi:[1,0,1] neg_lo:[0,1,0]
 v_pk_mul_f32 v[72:73], v[68:69], v[48:49] op_sel:[0,0] op_sel_hi:[0,1]
 v_pk_fma_f32 v[72:73], v[68:69], v[48:49], v[72:73] op_sel:[1,1,0] op_sel_hi:[1,0,1] neg_lo:[0,1,0]
 v_pk_mul_f32 v[74:75], v[70:71], v[50:51] op_sel:[0,0] op_sel_hi:[0,1]
 v_pk_fma_f32 v[74:75], v[70:71], v[50:51], v[74:75] op_sel:[1,1,0] op_sel_hi:[1,0,1] neg_lo:[0,1,0]
 v_cvt_pk_bf16_f32 v106, v84, v85
 v_cvt_pk_bf16_f32 v107, v86, v87
 ds_write_b64 v24, v[106:107] offset:0
 v_pk_mul_f32 v[96:97], v[84:85], v[48:49] op_sel:[0,0] op_sel_hi:[0,1]
 v_pk_fma_f32 v[96:97], v[84:85], v[48:49], v[96:97] op_sel:[1,1,0] op_sel_hi:[1,0,1] neg_lo:[0,1,0]
 v_pk_mul_f32 v[98:99], v[86:87], v[50:51] op_sel:[0,0] op_sel_hi:[0,1]
 v_pk_fma_f32 v[98:99], v[86:87], v[50:51], v[98:99] op_sel:[1,1,0] op_sel_hi:[1,0,1] neg_lo:[0,1,0]
 v_cvt_pk_bf16_f32 v100, v96, v97
 v_cvt_pk_bf16_f32 v101, v98, v99
 ds_write_b64 v24, v[100:101] offset:544
 v_pk_mul_f32 v[92:93], v[84:85], v[52:53] op_sel:[0,0] op_sel_hi:[0,1]
 v_pk_fma_f32 v[92:93], v[84:85], v[52:53], v[92:93] op_sel:[1,1,0] op_sel_hi:[1,0,1] neg_lo:[0,1,0]
 v_pk_mul_f32 v[94:95], v[86:87], v[54:55] op_sel:[0,0] op_sel_hi:[0,1]
 v_pk_fma_f32 v[94:95], v[86:87], v[54:55], v[94:95] op_sel:[1,1,0] op_sel_hi:[1,0,1] neg_lo:[0,1,0]
 v_cvt_pk_bf16_f32 v102, v92, v93
 v_cvt_pk_bf16_f32 v103, v94, v95
 ds_write_b64 v24, v[102:103] offset:1088
 v_pk_mul_f32 v[96:97], v[84:85], v[56:57] op_sel:[0,0] op_sel_hi:[0,1]
 v_pk_fma_f32 v[96:97], v[84:85], v[56:57], v[96:97] op_sel:[1,1,0] op_sel_hi:[1,0,1] neg_lo:[0,1,0]
 v_pk_mul_f32 v[98:99], v[86:87], v[58:59] op_sel:[0,0] op_sel_hi:[0,1]
 v_pk_fma_f32 v[98:99], v[86:87], v[58:59], v[98:99] op_sel:[1,1,0] op_sel_hi:[1,0,1] neg_lo:[0,1,0]
 v_cvt_pk_bf16_f32 v104, v96, v97
 v_cvt_pk_bf16_f32 v105, v98, v99
 ds_write_b64 v24, v[104:105] offset:1632
 v_pk_mul_f32 v[92:93], v[84:85], v[60:61] op_sel:[0,0] op_sel_hi:[0,1]
 v_pk_fma_f32 v[92:93], v[84:85], v[60:61], v[92:93] op_sel:[1,1,0] op_sel_hi:[1,0,1] neg_lo:[0,1,0]
 v_pk_mul_f32 v[94:95], v[86:87], v[62:63] op_sel:[0,0] op_sel_hi:[0,1]
 v_pk_fma_f32 v[94:95], v[86:87], v[62:63], v[94:95] op_sel:[1,1,0] op_sel_hi:[1,0,1] neg_lo:[0,1,0]
 v_cvt_pk_bf16_f32 v106, v92, v93
 v_cvt_pk_bf16_f32 v107, v94, v95
 ds_write_b64 v24, v[106:107] offset:2176
 v_pk_mul_f32 v[96:97], v[84:85], v[64:65] op_sel:[0,0] op_sel_hi:[0,1]
 v_pk_fma_f32 v[96:97], v[84:85], v[64:65], v[96:97] op_sel:[1,1,0] op_sel_hi:[1,0,1] neg_lo:[0,1,0]
 v_pk_mul_f32 v[98:99], v[86:87], v[66:67] op_sel:[0,0] op_sel_hi:[0,1]
 v_pk_fma_f32 v[98:99], v[86:87], v[66:67], v[98:99] op_sel:[1,1,0] op_sel_hi:[1,0,1] neg_lo:[0,1,0]
 v_cvt_pk_bf16_f32 v100, v96, v97
 v_cvt_pk_bf16_f32 v101, v98, v99
 ds_write_b64 v24, v[100:101] offset:2720
 v_pk_mul_f32 v[92:93], v[84:85], v[68:69] op_sel:[0,0] op_sel_hi:[0,1]
 v_pk_fma_f32 v[92:93], v[84:85], v[68:69], v[92:93] op_sel:[1,1,0] op_sel_hi:[1,0,1] neg_lo:[0,1,0]
 v_pk_mul_f32 v[94:95], v[86:87], v[70:71] op_sel:[0,0] op_sel_hi:[0,1]
 v_pk_fma_f32 v[94:95], v[86:87], v[70:71], v[94:95] op_sel:[1,1,0] op_sel_hi:[1,0,1] neg_lo:[0,1,0]
 v_cvt_pk_bf16_f32 v102, v92, v93
 v_cvt_pk_bf16_f32 v103, v94, v95
 ds_write_b64 v24, v[102:103] offset:3264
 v_pk_mul_f32 v[96:97], v[84:85], v[72:73] op_sel:[0,0] op_sel_hi:[0,1]
 v_pk_fma_f32 v[96:97], v[84:85], v[72:73], v[96:97] op_sel:[1,1,0] op_sel_hi:[1,0,1] neg_lo:[0,1,0]
 v_pk_mul_f32 v[98:99], v[86:87], v[74:75] op_sel:[0,0] op_sel_hi:[0,1]
 v_pk_fma_f32 v[98:99], v[86:87], v[74:75], v[98:99] op_sel:[1,1,0] op_sel_hi:[1,0,1] neg_lo:[0,1,0]
 v_cvt_pk_bf16_f32 v104, v96, v97
 v_cvt_pk_bf16_f32 v105, v98, v99
 ds_write_b64 v24, v[104:105] offset:3808
 v_pk_mul_f32 v[88:89], v[84:85], v[80:81] op_sel:[0,0] op_sel_hi:[0,1]
 v_pk_fma_f32 v[88:89], v[84:85], v[80:81], v[88:89] op_sel:[1,1,0] op_sel_hi:[1,0,1] neg_lo:[0,1,0]
 v_pk_mul_f32 v[90:91], v[86:87], v[82:83] op_sel:[0,0] op_sel_hi:[0,1]
 v_pk_fma_f32 v[90:91], v[86:87], v[82:83], v[90:91] op_sel:[1,1,0] op_sel_hi:[1,0,1] neg_lo:[0,1,0]
 v_cvt_pk_bf16_f32 v106, v88, v89
 v_cvt_pk_bf16_f32 v107, v90, v91
 ds_write_b64 v24, v[106:107] offset:4352
 v_pk_mul_f32 v[96:97], v[88:89], v[48:49] op_sel:[0,0] op_sel_hi:[0,1]
 v_pk_fma_f32 v[96:97], v[88:89], v[48:49], v[96:97] op_sel:[1,1,0] op_sel_hi:[1,0,1] neg_lo:[0,1,0]
 v_pk_mul_f32 v[98:99], v[90:91], v[50:51] op_sel:[0,0] op_sel_hi:[0,1]
 v_pk_fma_f32 v[98:99], v[90:91], v[50:51], v[98:99] op_sel:[1,1,0] op_sel_hi:[1,0,1] neg_lo:[0,1,0]
 v_cvt_pk_bf16_f32 v100, v96, v97
 v_cvt_pk_bf16_f32 v101, v98, v99
 ds_write_b64 v24, v[100:101] offset:4896
 v_pk_mul_f32 v[92:93], v[88:89], v[52:53] op_sel:[0,0] op_sel_hi:[0,1]
 v_pk_fma_f32 v[92:93], v[88:89], v[52:53], v[92:93] op_sel:[1,1,0] op_sel_hi:[1,0,1] neg_lo:[0,1,0]
 v_pk_mul_f32 v[94:95], v[90:91], v[54:55] op_sel:[0,0] op_sel_hi:[0,1]
 v_pk_fma_f32 v[94:95], v[90:91], v[54:55], v[94:95] op_sel:[1,1,0] op_sel_hi:[1,0,1] neg_lo:[0,1,0]
 v_cvt_pk_bf16_f32 v102, v92, v93
 v_cvt_pk_bf16_f32 v103, v94, v95
 ds_write_b64 v24, v[102:103] offset:5440
 v_pk_mul_f32 v[96:97], v[88:89], v[56:57] op_sel:[0,0] op_sel_hi:[0,1]
 v_pk_fma_f32 v[96:97], v[88:89], v[56:57], v[96:97] op_sel:[1,1,0] op_sel_hi:[1,0,1] neg_lo:[0,1,0]
 v_pk_mul_f32 v[98:99], v[90:91], v[58:59] op_sel:[0,0] op_sel_hi:[0,1]
 v_pk_fma_f32 v[98:99], v[90:91], v[58:59], v[98:99] op_sel:[1,1,0] op_sel_hi:[1,0,1] neg_lo:[0,1,0]
 v_cvt_pk_bf16_f32 v104, v96, v97
 v_cvt_pk_bf16_f32 v105, v98, v99
 ds_write_b64 v24, v[104:105] offset:5984
 v_pk_mul_f32 v[92:93], v[88:89], v[60:61] op_sel:[0,0] op_sel_hi:[0,1]
 v_pk_fma_f32 v[92:93], v[88:89], v[60:61], v[92:93] op_sel:[1,1,0] op_sel_hi:[1,0,1] neg_lo:[0,1,0]
 v_pk_mul_f32 v[94:95], v[90:91], v[62:63] op_sel:[0,0] op_sel_hi:[0,1]
 v_pk_fma_f32 v[94:95], v[90:91], v[62:63], v[94:95] op_sel:[1,1,0] op_sel_hi:[1,0,1] neg_lo:[0,1,0]
 v_cvt_pk_bf16_f32 v106, v92, v93
 v_cvt_pk_bf16_f32 v107, v94, v95
 ds_write_b64 v24, v[106:107] offset:6528
 v_pk_mul_f32 v[96:97], v[88:89], v[64:65] op_sel:[0,0] op_sel_hi:[0,1]
 v_pk_fma_f32 v[96:97], v[88:89], v[64:65], v[96:97] op_sel:[1,1,0] op_sel_hi:[1,0,1] neg_lo:[0,1,0]
 v_pk_mul_f32 v[98:99], v[90:91], v[66:67] op_sel:[0,0] op_sel_hi:[0,1]
 v_pk_fma_f32 v[98:99], v[90:91], v[66:67], v[98:99] op_sel:[1,1,0] op_sel_hi:[1,0,1] neg_lo:[0,1,0]
 v_cvt_pk_bf16_f32 v100, v96, v97
 v_cvt_pk_bf16_f32 v101, v98, v99
 ds_write_b64 v24, v[100:101] offset:7072
 v_pk_mul_f32 v[92:93], v[88:89], v[68:69] op_sel:[0,0] op_sel_hi:[0,1]
 v_pk_fma_f32 v[92:93], v[88:89], v[68:69], v[92:93] op_sel:[1,1,0] op_sel_hi:[1,0,1] neg_lo:[0,1,0]
 v_pk_mul_f32 v[94:95], v[90:91], v[70:71] op_sel:[0,0] op_sel_hi:[0,1]
 v_pk_fma_f32 v[94:95], v[90:91], v[70:71], v[94:95] op_sel:[1,1,0] op_sel_hi:[1,0,1] neg_lo:[0,1,0]
 v_cvt_pk_bf16_f32 v102, v92, v93
 v_cvt_pk_bf16_f32 v103, v94, v95
 ds_write_b64 v24, v[102:103] offset:7616
 v_pk_mul_f32 v[96:97], v[88:89], v[72:73] op_sel:[0,0] op_sel_hi:[0,1]
 v_pk_fma_f32 v[96:97], v[88:89], v[72:73], v[96:97] op_sel:[1,1,0] op_sel_hi:[1,0,1] neg_lo:[0,1,0]
 v_pk_mul_f32 v[98:99], v[90:91], v[74:75] op_sel:[0,0] op_sel_hi:[0,1]
 v_pk_fma_f32 v[98:99], v[90:91], v[74:75], v[98:99] op_sel:[1,1,0] op_sel_hi:[1,0,1] neg_lo:[0,1,0]
 v_cvt_pk_bf16_f32 v104, v96, v97
 v_cvt_pk_bf16_f32 v105, v98, v99
 ds_write_b64 v24, v[104:105] offset:8160
 s_mov_b32 s4, 0x9e3779b1
 s_waitcnt vmcnt(6)
 v_mul_lo_u32 v253, v253, s4
 v_add_u32 v253, 0x7f4a7c15, v253
 s_lshr_b32 s92, s2, 3
 s_sub_u32 s92, s92, 16
 s_lshl_b32 s92, s92, 2
 s_add_u32 s92, s92, s68
 s_lshl_b32 s92, s92, 6
 v_add_u32_e64 v250, s92, v1
 v_mul_u32_u24 v249, 13108, v250
 v_lshrrev_b32 v249, 16, v249
 v_mul_u32_u24 v252, 5, v249
 v_sub_u32_e64 v250, v250, v252
 v_mul_u32_u24 v252, 3840, v249
 v_lshl_add_u32 v252, v250, 7, v252
 s_and_b32 s93, s2, 1
 s_mul_i32 s94, s93, 640
 s_mov_b32 s96, s10
 s_mov_b32 s97, s11
 s_mov_b32 s98, 2457600
 s_mov_b32 s99, 0x20000
 buffer_load_dword v254, v252, s[96:99], s94 offen
 v_pk_mul_f32 v[84:85], v[88:89], v[80:81] op_sel:[0,0] op_sel_hi:[0,1]
 v_pk_fma_f32 v[84:85], v[88:89], v[80:81], v[84:85] op_sel:[1,1,0] op_sel_hi:[1,0,1] neg_lo:[0,1,0]
 v_pk_mul_f32 v[86:87], v[90:91], v[82:83] op_sel:[0,0] op_sel_hi:[0,1]
 v_pk_fma_f32 v[86:87], v[90:91], v[82:83], v[86:87] op_sel:[1,1,0] op_sel_hi:[1,0,1] neg_lo:[0,1,0]
 ds_read_b128 v[140:143], v25 offset:0
 ds_read_b128 v[144:147], v25 offset:64
 ds_read_b128 v[148:151], v25 offset:128
 ds_read_b128 v[152:155], v25 offset:192
 ds_read_b128 v[156:159], v25 offset:256
 ds_read_b128 v[160:163], v25 offset:320
 ds_read_b128 v[164:167], v25 offset:384
 ds_read_b128 v[168:171], v25 offset:448
 v_cvt_pk_bf16_f32 v106, v84, v85
 v_cvt_pk_bf16_f32 v107, v86, v87
 ds_write_b64 v24, v[106:107] offset:0
 s_nop 0
 v_pk_mul_f32 v[96:97], v[84:85], v[52:53] op_sel:[0,0] op_sel_hi:[0,1]
 v_pk_fma_f32 v[96:97], v[84:85], v[52:53], v[96:97] op_sel:[1,1,0] op_sel_hi:[1,0,1] neg_lo:[0,1,0]
 v_pk_mul_f32 v[98:99], v[86:87], v[54:55] op_sel:[0,0] op_sel_hi:[0,1]
 v_pk_fma_f32 v[98:99], v[86:87], v[54:55], v[98:99] op_sel:[1,1,0] op_sel_hi:[1,0,1] neg_lo:[0,1,0]
 v_cvt_pk_bf16_f32 v100, v96, v97
 v_cvt_pk_bf16_f32 v101, v98, v99
 ds_write_b64 v24, v[100:101] offset:544
 v_pk_mul_f32 v[92:93], v[84:85], v[60:61] op_sel:[0,0] op_sel_hi:[0,1]
 v_pk_fma_f32 v[92:93], v[84:85], v[60:61], v[92:93] op_sel:[1,1,0] op_sel_hi:[1,0,1] neg_lo:[0,1,0]
 v_pk_mul_f32 v[94:95], v[86:87], v[62:63] op_sel:[0,0] op_sel_hi:[0,1]
 v_pk_fma_f32 v[94:95], v[86:87], v[62:63], v[94:95] op_sel:[1,1,0] op_sel_hi:[1,0,1] neg_lo:[0,1,0]
 v_cvt_pk_bf16_f32 v102, v92, v93
 v_cvt_pk_bf16_f32 v103, v94, v95
 ds_write_b64 v24, v[102:103] offset:1088
 s_lshl_b32 s94, s93, 9
 s_lshl_b32 s95, s93, 7
 s_add_u32 s95, s95, 1024
 v_lshlrev_b32 v252, 7, v250
 v_add_u32 v252, s94, v252
 v_mov_b32 v248, s95
 v_cmp_eq_u32 vcc, 4, v250
 v_mul_u32_u24 v249, 1280, v249
 s_nop 0
 v_cndmask_b32 v252, v252, v248, vcc
 v_add_u32_e64 v252, v252, v249
 s_mov_b32 s96, s14
 s_mov_b32 s97, s15
 s_mov_b32 s98, 819200
 s_mov_b32 s99, 0x20000
 buffer_load_dword v254, v252, s[96:99], 0 offen
 v_pk_mul_f32 v[96:97], v[84:85], v[68:69] op_sel:[0,0] op_sel_hi:[0,1]
 v_pk_fma_f32 v[96:97], v[84:85], v[68:69], v[96:97] op_sel:[1,1,0] op_sel_hi:[1,0,1] neg_lo:[0,1,0]
 v_pk_mul_f32 v[98:99], v[86:87], v[70:71] op_sel:[0,0] op_sel_hi:[0,1]
 v_pk_fma_f32 v[98:99], v[86:87], v[70:71], v[98:99] op_sel:[1,1,0] op_sel_hi:[1,0,1] neg_lo:[0,1,0]
 v_cvt_pk_bf16_f32 v104, v96, v97
 v_cvt_pk_bf16_f32 v105, v98, v99
 ds_write_b64 v24, v[104:105] offset:1632
 v_pk_mul_f32 v[88:89], v[84:85], v[80:81] op_sel:[0,0] op_sel_hi:[0,1]
 v_pk_fma_f32 v[88:89], v[84:85], v[80:81], v[88:89] op_sel:[1,1,0] op_sel_hi:[1,0,1] neg_lo:[0,1,0]
 v_pk_mul_f32 v[90:91], v[86:87], v[82:83] op_sel:[0,0] op_sel_hi:[0,1]
 v_pk_fma_f32 v[90:91], v[86:87], v[82:83], v[90:91] op_sel:[1,1,0] op_sel_hi:[1,0,1] neg_lo:[0,1,0]
 s_waitcnt lgkmcnt(11)
 v_mfma_f32_16x16x32_bf16 v[172:175], v[140:143], v[108:111], 0
 s_waitcnt lgkmcnt(10)
 v_mfma_f32_16x16x32_bf16 v[172:175], v[144:147], v[112:115], v[172:175]
 s_waitcnt lgkmcnt(9)
 v_mfma_f32_16x16x32_bf16 v[172:175], v[148:151], v[116:119], v[172:175]
 s_waitcnt lgkmcnt(8)
 v_mfma_f32_16x16x32_bf16 v[172:175], v[152:155], v[120:123], v[172:175]
 s_waitcnt lgkmcnt(7)
 v_mfma_f32_16x16x32_bf16 v[172:175], v[156:159], v[124:127], v[172:175]
 s_waitcnt lgkmcnt(6)
 v_mfma_f32_16x16x32_bf16 v[172:175], v[160:163], v[128:131], v[172:175]
 s_waitcnt lgkmcnt(5)
 v_mfma_f32_16x16x32_bf16 v[172:175], v[164:167], v[132:135], v[172:175]
 s_waitcnt lgkmcnt(4)
 v_mfma_f32_16x16x32_bf16 v[172:175], v[168:171], v[136:139], v[172:175]
 v_cvt_pk_bf16_f32 v106, v88, v89
 v_cvt_pk_bf16_f32 v107, v90, v91
 ds_write_b64 v24, v[106:107] offset:2176
 v_pk_mul_f32 v[96:97], v[88:89], v[52:53] op_sel:[0,0] op_sel_hi:[0,1]
 v_pk_fma_f32 v[96:97], v[88:89], v[52:53], v[96:97] op_sel:[1,1,0] op_sel_hi:[1,0,1] neg_lo:[0,1,0]
 v_pk_mul_f32 v[98:99], v[90:91], v[54:55] op_sel:[0,0] op_sel_hi:[0,1]
 v_pk_fma_f32 v[98:99], v[90:91], v[54:55], v[98:99] op_sel:[1,1,0] op_sel_hi:[1,0,1] neg_lo:[0,1,0]
 v_cvt_pk_bf16_f32 v100, v96, v97
 v_cvt_pk_bf16_f32 v101, v98, v99
 ds_write_b64 v24, v[100:101] offset:2720
 v_pk_mul_f32 v[92:93], v[88:89], v[60:61] op_sel:[0,0] op_sel_hi:[0,1]
 v_pk_fma_f32 v[92:93], v[88:89], v[60:61], v[92:93] op_sel:[1,1,0] op_sel_hi:[1,0,1] neg_lo:[0,1,0]
 v_pk_mul_f32 v[94:95], v[90:91], v[62:63] op_sel:[0,0] op_sel_hi:[0,1]
 v_pk_fma_f32 v[94:95], v[90:91], v[62:63], v[94:95] op_sel:[1,1,0] op_sel_hi:[1,0,1] neg_lo:[0,1,0]
 v_cvt_pk_bf16_f32 v102, v92, v93
 v_cvt_pk_bf16_f32 v103, v94, v95
 ds_write_b64 v24, v[102:103] offset:3264
 v_pk_mul_f32 v[96:97], v[88:89], v[68:69] op_sel:[0,0] op_sel_hi:[0,1]
 v_pk_fma_f32 v[96:97], v[88:89], v[68:69], v[96:97] op_sel:[1,1,0] op_sel_hi:[1,0,1] neg_lo:[0,1,0]
 v_pk_mul_f32 v[98:99], v[90:91], v[70:71] op_sel:[0,0] op_sel_hi:[0,1]
 v_pk_fma_f32 v[98:99], v[90:91], v[70:71], v[98:99] op_sel:[1,1,0] op_sel_hi:[1,0,1] neg_lo:[0,1,0]
 v_cvt_pk_bf16_f32 v104, v96, v97
 v_cvt_pk_bf16_f32 v105, v98, v99
 ds_write_b64 v24, v[104:105] offset:3808
 s_add_u32 s81, s5, 1
 s_and_b32 s81, s81, 31
 s_mul_i32 s82, s81, 81920
 s_lshl_b32 s81, s81, 10
 s_add_u32 m0, s81, 256
 s_nop 0
 buffer_load_dwordx4 v6, s[40:43], s82 offen lds
 v_pk_mul_f32 v[84:85], v[88:89], v[80:81] op_sel:[0,0] op_sel_hi:[0,1]
 v_pk_fma_f32 v[84:85], v[88:89], v[80:81], v[84:85] op_sel:[1,1,0] op_sel_hi:[1,0,1] neg_lo:[0,1,0]
 v_pk_mul_f32 v[86:87], v[90:91], v[82:83] op_sel:[0,0] op_sel_hi:[0,1]
 v_pk_fma_f32 v[86:87], v[90:91], v[82:83], v[86:87] op_sel:[1,1,0] op_sel_hi:[1,0,1] neg_lo:[0,1,0]
 v_cvt_pk_bf16_f32 v106, v84, v85
 v_cvt_pk_bf16_f32 v107, v86, v87
 ds_write_b64 v24, v[106:107] offset:4352
 v_pk_mul_f32 v[96:97], v[84:85], v[60:61] op_sel:[0,0] op_sel_hi:[0,1]
 v_pk_fma_f32 v[96:97], v[84:85], v[60:61], v[96:97] op_sel:[1,1,0] op_sel_hi:[1,0,1] neg_lo:[0,1,0]
 v_pk_mul_f32 v[98:99], v[86:87], v[62:63] op_sel:[0,0] op_sel_hi:[0,1]
 v_pk_fma_f32 v[98:99], v[86:87], v[62:63], v[98:99] op_sel:[1,1,0] op_sel_hi:[1,0,1] neg_lo:[0,1,0]
 v_cvt_pk_bf16_f32 v100, v96, v97
 v_cvt_pk_bf16_f32 v101, v98, v99
 ds_write_b64 v24, v[100:101] offset:4896
 v_pk_mul_f32 v[88:89], v[84:85], v[80:81] op_sel:[0,0] op_sel_hi:[0,1]
 v_pk_fma_f32 v[88:89], v[84:85], v[80:81], v[88:89] op_sel:[1,1,0] op_sel_hi:[1,0,1] neg_lo:[0,1,0]
 v_pk_mul_f32 v[90:91], v[86:87], v[82:83] op_sel:[0,0] op_sel_hi:[0,1]
 v_pk_fma_f32 v[90:91], v[86:87], v[82:83], v[90:91] op_sel:[1,1,0] op_sel_hi:[1,0,1] neg_lo:[0,1,0]
 v_cvt_pk_bf16_f32 v102, v88, v89
 v_cvt_pk_bf16_f32 v103, v90, v91
 ds_write_b64 v24, v[102:103] offset:5440
 v_pk_mul_f32 v[96:97], v[88:89], v[60:61] op_sel:[0,0] op_sel_hi:[0,1]
 v_pk_fma_f32 v[96:97], v[88:89], v[60:61], v[96:97] op_sel:[1,1,0] op_sel_hi:[1,0,1] neg_lo:[0,1,0]
 v_pk_mul_f32 v[98:99], v[90:91], v[62:63] op_sel:[0,0] op_sel_hi:[0,1]
 v_pk_fma_f32 v[98:99], v[90:91], v[62:63], v[98:99] op_sel:[1,1,0] op_sel_hi:[1,0,1] neg_lo:[0,1,0]
 v_cvt_pk_bf16_f32 v104, v96, v97
 v_cvt_pk_bf16_f32 v105, v98, v99
 ds_write_b64 v24, v[104:105] offset:5984
 v_pk_mul_f32 v[84:85], v[88:89], v[80:81] op_sel:[0,0] op_sel_hi:[0,1]
 v_pk_fma_f32 v[84:85], v[88:89], v[80:81], v[84:85] op_sel:[1,1,0] op_sel_hi:[1,0,1] neg_lo:[0,1,0]
 v_pk_mul_f32 v[86:87], v[90:91], v[82:83] op_sel:[0,0] op_sel_hi:[0,1]
 v_pk_fma_f32 v[86:87], v[90:91], v[82:83], v[86:87] op_sel:[1,1,0] op_sel_hi:[1,0,1] neg_lo:[0,1,0]
 v_cvt_pk_bf16_f32 v106, v84, v85
 v_cvt_pk_bf16_f32 v107, v86, v87
 ds_write_b64 v24, v[106:107] offset:6528
 v_pk_mul_f32 v[96:97], v[84:85], v[60:61] op_sel:[0,0] op_sel_hi:[0,1]
 v_pk_fma_f32 v[96:97], v[84:85], v[60:61], v[96:97] op_sel:[1,1,0] op_sel_hi:[1,0,1] neg_lo:[0,1,0]
 v_pk_mul_f32 v[98:99], v[86:87], v[62:63] op_sel:[0,0] op_sel_hi:[0,1]
 v_pk_fma_f32 v[98:99], v[86:87], v[62:63], v[98:99] op_sel:[1,1,0] op_sel_hi:[1,0,1] neg_lo:[0,1,0]
 v_cvt_pk_bf16_f32 v100, v96, v97
 v_cvt_pk_bf16_f32 v101, v98, v99
 s_branch pb1_skip
.p2align 12
pb1:
 s_setpc_b64 s[36:37]
 s_nop 0
pb1_skip:
 ds_write_b64 v24, v[100:101] offset:7072
 v_pk_mul_f32 v[88:89], v[84:85], v[80:81] op_sel:[0,0] op_sel_hi:[0,1]
 v_pk_fma_f32 v[88:89], v[84:85], v[80:81], v[88:89] op_sel:[1,1,0] op_sel_hi:[1,0,1] neg_lo:[0,1,0]
 v_pk_mul_f32 v[90:91], v[86:87], v[82:83] op_sel:[0,0] op_sel_hi:[0,1]
 v_pk_fma_f32 v[90:91], v[86:87], v[82:83], v[90:91] op_sel:[1,1,0] op_sel_hi:[1,0,1] neg_lo:[0,1,0]
 v_cvt_pk_bf16_f32 v102, v88, v89
 v_cvt_pk_bf16_f32 v103, v90, v91
 ds_write_b64 v24, v[102:103] offset:7616
 v_pk_mul_f32 v[96:97], v[88:89], v[60:61] op_sel:[0,0] op_sel_hi:[0,1]
 v_pk_fma_f32 v[96:97], v[88:89], v[60:61], v[96:97] op_sel:[1,1,0] op_sel_hi:[1,0,1] neg_lo:[0,1,0]
 v_pk_mul_f32 v[98:99], v[90:91], v[62:63] op_sel:[0,0] op_sel_hi:[0,1]
 v_pk_fma_f32 v[98:99], v[90:91], v[62:63], v[98:99] op_sel:[1,1,0] op_sel_hi:[1,0,1] neg_lo:[0,1,0]
 v_cvt_pk_bf16_f32 v104, v96, v97
 v_cvt_pk_bf16_f32 v105, v98, v99
 ds_write_b64 v24, v[104:105] offset:8160
 s_add_u32 s81, s5, 2
 s_and_b32 s81, s81, 31
 s_mul_i32 s82, s81, 81920
 s_lshl_b32 s81, s81, 10
 s_add_u32 m0, s81, 256
 s_nop 0
 buffer_load_dwordx4 v6, s[40:43], s82 offen lds
 v_pk_mul_f32 v[84:85], v[88:89], v[80:81] op_sel:[0,0] op_sel_hi:[0,1]
 v_pk_fma_f32 v[84:85], v[88:89], v[80:81], v[84:85] op_sel:[1,1,0] op_sel_hi:[1,0,1] neg_lo:[0,1,0]
 v_pk_mul_f32 v[86:87], v[90:91], v[82:83] op_sel:[0,0] op_sel_hi:[0,1]
 v_pk_fma_f32 v[86:87], v[90:91], v[82:83], v[86:87] op_sel:[1,1,0] op_sel_hi:[1,0,1] neg_lo:[0,1,0]
 ds_read_b128 v[140:143], v25 offset:0
 ds_read_b128 v[144:147], v25 offset:64
 ds_read_b128 v[148:151], v25 offset:128
 ds_read_b128 v[152:155], v25 offset:192
 ds_read_b128 v[156:159], v25 offset:256
 ds_read_b128 v[160:163], v25 offset:320
 ds_read_b128 v[164:167], v25 offset:384
 ds_read_b128 v[168:171], v25 offset:448
 v_cvt_pk_bf16_f32 v106, v84, v85
 v_cvt_pk_bf16_f32 v107, v86, v87
 ds_write_b64 v24, v[106:107] offset:0
 v_pk_mul_f32 v[88:89], v[84:85], v[80:81] op_sel:[0,0] op_sel_hi:[0,1]
 v_pk_fma_f32 v[88:89], v[84:85], v[80:81], v[88:89] op_sel:[1,1,0] op_sel_hi:[1,0,1] neg_lo:[0,1,0]
 v_pk_mul_f32 v[90:91], v[86:87], v[82:83] op_sel:[0,0] op_sel_hi:[0,1]
 v_pk_fma_f32 v[90:91], v[86:87], v[82:83], v[90:91] op_sel:[1,1,0] op_sel_hi:[1,0,1] neg_lo:[0,1,0]
 v_cvt_pk_bf16_f32 v100, v88, v89
 v_cvt_pk_bf16_f32 v101, v90, v91
 ds_write_b64 v24, v[100:101] offset:544
 v_pk_mul_f32 v[84:85], v[88:89], v[80:81] op_sel:[0,0] op_sel_hi:[0,1]
 v_pk_fma_f32 v[84:85], v[88:89], v[80:81], v[84:85] op_sel:[1,1,0] op_sel_hi:[1,0,1] neg_lo:[0,1,0]
 v_pk_mul_f32 v[86:87], v[90:91], v[82:83] op_sel:[0,0] op_sel_hi:[0,1]
 v_pk_fma_f32 v[86:87], v[90:91], v[82:83], v[86:87] op_sel:[1,1,0] op_sel_hi:[1,0,1] neg_lo:[0,1,0]
 v_cvt_pk_bf16_f32 v102, v84, v85
 v_cvt_pk_bf16_f32 v103, v86, v87
 ds_write_b64 v24, v[102:103] offset:1088
 v_pk_mul_f32 v[88:89], v[84:85], v[80:81] op_sel:[0,0] op_sel_hi:[0,1]
 v_pk_fma_f32 v[88:89], v[84:85], v[80:81], v[88:89] op_sel:[1,1,0] op_sel_hi:[1,0,1] neg_lo:[0,1,0]
 v_pk_mul_f32 v[90:91], v[86:87], v[82:83] op_sel:[0,0] op_sel_hi:[0,1]
 v_pk_fma_f32 v[90:91], v[86:87], v[82:83], v[90:91] op_sel:[1,1,0] op_sel_hi:[1,0,1] neg_lo:[0,1,0]
 v_cvt_pk_bf16_f32 v104, v88, v89
 v_cvt_pk_bf16_f32 v105, v90, v91
 ds_write_b64 v24, v[104:105] offset:1632
 v_pk_mul_f32 v[84:85], v[88:89], v[80:81] op_sel:[0,0] op_sel_hi:[0,1]
 v_pk_fma_f32 v[84:85], v[88:89], v[80:81], v[84:85] op_sel:[1,1,0] op_sel_hi:[1,0,1] neg_lo:[0,1,0]
 v_pk_mul_f32 v[86:87], v[90:91], v[82:83] op_sel:[0,0] op_sel_hi:[0,1]
 v_pk_fma_f32 v[86:87], v[90:91], v[82:83], v[86:87] op_sel:[1,1,0] op_sel_hi:[1,0,1] neg_lo:[0,1,0]
 s_waitcnt lgkmcnt(11)
 v_mfma_f32_16x16x32_bf16 v[176:179], v[140:143], v[108:111], 0
 s_waitcnt lgkmcnt(10)
 v_mfma_f32_16x16x32_bf16 v[176:179], v[144:147], v[112:115], v[176:179]
 s_waitcnt lgkmcnt(9)
 v_mfma_f32_16x16x32_bf16 v[176:179], v[148:151], v[116:119], v[176:179]
 s_waitcnt lgkmcnt(8)
 v_mfma_f32_16x16x32_bf16 v[176:179], v[152:155], v[120:123], v[176:179]
 s_waitcnt lgkmcnt(7)
 v_mfma_f32_16x16x32_bf16 v[176:179], v[156:159], v[124:127], v[176:179]
 s_waitcnt lgkmcnt(6)
 v_mfma_f32_16x16x32_bf16 v[176:179], v[160:163], v[128:131], v[176:179]
 s_waitcnt lgkmcnt(5)
 v_mfma_f32_16x16x32_bf16 v[176:179], v[164:167], v[132:135], v[176:179]
 s_waitcnt lgkmcnt(4)
 v_mfma_f32_16x16x32_bf16 v[176:179], v[168:171], v[136:139], v[176:179]
 v_cvt_pk_bf16_f32 v106, v84, v85
 v_cvt_pk_bf16_f32 v107, v86, v87
 ds_write_b64 v24, v[106:107] offset:2176
 v_pk_mul_f32 v[88:89], v[84:85], v[80:81] op_sel:[0,0] op_sel_hi:[0,1]
 v_pk_fma_f32 v[88:89], v[84:85], v[80:81], v[88:89] op_sel:[1,1,0] op_sel_hi:[1,0,1] neg_lo:[0,1,0]
 v_pk_mul_f32 v[90:91], v[86:87], v[82:83] op_sel:[0,0] op_sel_hi:[0,1]
 v_pk_fma_f32 v[90:91], v[86:87], v[82:83], v[90:91] op_sel:[1,1,0] op_sel_hi:[1,0,1] neg_lo:[0,1,0]
 v_cvt_pk_bf16_f32 v100, v88, v89
 v_cvt_pk_bf16_f32 v101, v90, v91
 ds_write_b64 v24, v[100:101] offset:2720
 v_pk_mul_f32 v[84:85], v[88:89], v[80:81] op_sel:[0,0] op_sel_hi:[0,1]
 v_pk_fma_f32 v[84:85], v[88:89], v[80:81], v[84:85] op_sel:[1,1,0] op_sel_hi:[1,0,1] neg_lo:[0,1,0]
 v_pk_mul_f32 v[86:87], v[90:91], v[82:83] op_sel:[0,0] op_sel_hi:[0,1]
 v_pk_fma_f32 v[86:87], v[90:91], v[82:83], v[86:87] op_sel:[1,1,0] op_sel_hi:[1,0,1] neg_lo:[0,1,0]
 v_cvt_pk_bf16_f32 v102, v84, v85
 v_cvt_pk_bf16_f32 v103, v86, v87
 ds_write_b64 v24, v[102:103] offset:3264
 v_pk_mul_f32 v[88:89], v[84:85], v[80:81] op_sel:[0,0] op_sel_hi:[0,1]
 v_pk_fma_f32 v[88:89], v[84:85], v[80:81], v[88:89] op_sel:[1,1,0] op_sel_hi:[1,0,1] neg_lo:[0,1,0]
 v_pk_mul_f32 v[90:91], v[86:87], v[82:83] op_sel:[0,0] op_sel_hi:[0,1]
 v_pk_fma_f32 v[90:91], v[86:87], v[82:83], v[90:91] op_sel:[1,1,0] op_sel_hi:[1,0,1] neg_lo:[0,1,0]
 v_cvt_pk_bf16_f32 v104, v88, v89
 v_cvt_pk_bf16_f32 v105, v90, v91
 ds_write_b64 v24, v[104:105] offset:3808
 v_pk_mul_f32 v[84:85], v[88:89], v[80:81] op_sel:[0,0] op_sel_hi:[0,1]
 v_pk_fma_f32 v[84:85], v[88:89], v[80:81], v[84:85] op_sel:[1,1,0] op_sel_hi:[1,0,1] neg_lo:[0,1,0]
 v_pk_mul_f32 v[86:87], v[90:91], v[82:83] op_sel:[0,0] op_sel_hi:[0,1]
 v_pk_fma_f32 v[86:87], v[90:91], v[82:83], v[86:87] op_sel:[1,1,0] op_sel_hi:[1,0,1] neg_lo:[0,1,0]
 v_cvt_pk_bf16_f32 v106, v84, v85
 v_cvt_pk_bf16_f32 v107, v86, v87
 ds_write_b64 v24, v[106:107] offset:4352
 ds_read_b128 v[140:143], v25 offset:0
 ds_read_b128 v[144:147], v25 offset:64
 ds_read_b128 v[148:151], v25 offset:128
 ds_read_b128 v[152:155], v25 offset:192
 ds_read_b128 v[156:159], v25 offset:256
 ds_read_b128 v[160:163], v25 offset:320
 ds_read_b128 v[164:167], v25 offset:384
 ds_read_b128 v[168:171], v25 offset:448
 v_cmp_eq_u32 vcc, 0, v1
 v_lshlrev_b32 v40, 16, v13
 s_nop 0
 v_cndmask_b32 v40, v4, v40, vcc
 v_add_f32_e64 v172, v172, v40
 v_cvt_pk_bf16_f32 v172, v172, v172
 v_cvt_pk_bf16_f32 v173, v173, v173
 v_cvt_pk_bf16_f32 v174, v174, v174
 v_cvt_pk_bf16_f32 v175, v175, v175
 v_cvt_pk_bf16_f32 v176, v176, v176
 v_cvt_pk_bf16_f32 v177, v177, v177
 v_cvt_pk_bf16_f32 v178, v178, v178
 v_cvt_pk_bf16_f32 v179, v179, v179
 s_waitcnt lgkmcnt(0)
 v_mfma_f32_16x16x32_bf16 v[180:183], v[140:143], v[108:111], 0
 ds_write_b128 v26, v[172:175]
 v_mfma_f32_16x16x32_bf16 v[180:183], v[144:147], v[112:115], v[180:183]
 v_mfma_f32_16x16x32_bf16 v[180:183], v[148:151], v[116:119], v[180:183]
 v_mfma_f32_16x16x32_bf16 v[180:183], v[152:155], v[120:123], v[180:183]
 ds_write_b64 v27, v[176:177] offset:1024
 v_mfma_f32_16x16x32_bf16 v[180:183], v[156:159], v[124:127], v[180:183]
 v_mfma_f32_16x16x32_bf16 v[180:183], v[160:163], v[128:131], v[180:183]
 ds_write_b64 v28, v[178:179] offset:1024
 v_mfma_f32_16x16x32_bf16 v[180:183], v[164:167], v[132:135], v[180:183]
 v_mfma_f32_16x16x32_bf16 v[180:183], v[168:171], v[136:139], v[180:183]
 ds_read_b128 v[132:135], v33
 ds_read_b128 v[136:139], v33 offset:16
 ds_read_b128 v[124:127], v32 offset:1024
 ds_read_b32 v128, v32 offset:1040
 s_nop 3
 v_cvt_pk_bf16_f32 v180, v180, v180
 v_cvt_pk_bf16_f32 v181, v181, v181
 v_cvt_pk_bf16_f32 v182, v182, v182
 v_cvt_pk_bf16_f32 v183, v183, v183
 ds_write_b32 v29, v180 offset:2048
 ds_write_b32 v29, v181 offset:2112
 ds_write_b32 v29, v182 offset:2176
 ds_write_b32 v29, v183 offset:2240
 ds_read_b32 v116, v31 offset:1544
 ds_read_b32 v117, v31 offset:1540
 ds_read_b32 v119, v31 offset:1536
 ds_read_b32 v108, v30 offset:2052
 ds_read_b32 v110, v30 offset:2048
 ds_read_b32 v111, v30 offset:2048
 ds_read_b32 v112, v30 offset:2308
 ds_read_b32 v114, v30 offset:2304
 ds_read_b32 v115, v30 offset:2304
 s_waitcnt lgkmcnt(13)
 v_bfi_b32 v120, s85, v128, v127
 v_mov_b32 v121, v126
 v_bfi_b32 v122, s85, v126, v125
 v_mov_b32_e64 v123, v124
 ds_write_b128 v35, v[120:123] offset:3072
 v_bfi_b32 v124, s85, v139, v138
 v_bfi_b32 v125, s85, v137, v136
 v_bfi_b32 v126, s85, v135, v134
 v_bfi_b32 v127, s85, v133, v132
 ds_write_b128 v35, v[124:127] offset:3584
 s_waitcnt lgkmcnt(8)
 v_bfi_b32 v118, s85, v117, v119
 ds_write_b128 v34, v[116:119] offset:2048
 s_waitcnt lgkmcnt(7)
 v_bfi_b32 v109, v37, v108, v110
 s_waitcnt lgkmcnt(6)
 ds_write_b128 v34, v[108:111] offset:1024
 s_waitcnt lgkmcnt(5)
 v_bfi_b32 v113, v37, v112, v114
 s_waitcnt lgkmcnt(4)
 ds_write_b128 v34, v[112:115] offset:0
 v_and_b32 v17, 31, v0
 v_lshlrev_b32 v17, 7, v17
 s_lshl_b32 s38, s69, 15
 s_lshl_b32 s80, s68, 13
 s_add_u32 s38, s38, s80
 s_add_u32 s38, s38, 7340032
 s_add_u32 s80, s80, 256
 s_add_u32 s81, s5, 3
 s_and_b32 s81, s81, 31
 s_mul_i32 s82, s81, 81920
 s_lshl_b32 s81, s81, 10
 s_add_u32 m0, s81, 256
 s_nop 0
 buffer_load_dwordx4 v6, s[40:43], s82 offen lds
 s_add_u32 s81, s5, 4
 s_and_b32 s81, s81, 31
 s_mul_i32 s82, s81, 81920
 s_lshl_b32 s81, s81, 10
 s_add_u32 m0, s81, 256
 s_nop 0
 buffer_load_dwordx4 v6, s[40:43], s82 offen lds
 s_mov_b32 s99, s5
 v_bfe_u32 v42, v0, 2, 2
 v_and_b32 v41, 1, v0
 v_lshlrev_b32_e64 v41, 3, v41
 v_lshl_add_u32 v42, v42, 4, v41
 v_bfe_u32 v41, v0, 1, 1
 v_lshl_add_u32 v41, v3, 1, v41
 v_lshl_add_u32 v40, v41, 6, v42
 s_lshl_b32 s80, s68, 13
 v_lshl_add_u32 v42, v41, 10, v42
 v_add_u32 v42, s80, v42
 v_and_b32_e64 v41, 7, v0
 v_mul_u32_u24 v41, 8336, v41
 v_bfe_u32 v43, v0, 3, 1
 v_lshl_add_u32 v43, v3, 1, v43
 v_lshl_add_u32 v46, v43, 7, v41
 v_lshl_add_u32 v41, v43, 3, v41
 s_lshl_b32 s80, s68, 10
 v_add_u32 v43, s80, v46
 s_mul_i32 s81, s68, 8336
 s_add_u32 s81, s81, 33280
 v_and_b32_e64 v44, 1, v0
 v_mul_u32_u24 v44, 4172, v44
 v_lshrrev_b32_e64 v45, 1, v2
 v_lshl_add_u32 v45, v3, 2, v45
 v_lshl_add_u32 v44, v45, 2, v44
 v_add_u32_e64 v216, s81, v44
 v_add_u32 v217, 1024, v216
 v_add_u32 v218, 2048, v216
 v_add_u32 v219, 3072, v216
 s_mul_i32 s80, s68, 4160
 v_lshlrev_b32_e64 v44, 5, v2
 v_lshl_add_u32 v44, v3, 3, v44
 v_add_u32 v220, s80, v44
 s_lshl_b32 s90, s69, 2
 s_add_u32 s90, s90, s68
 s_lshl_b32 s91, s90, 12
 s_add_u32 s91, s91, 4194304
 s_lshl_b32 s90, s90, 7
 s_add_u32 s90, s90, 196608
 s_sub_u32 s92, s84, s83
 v_add_u32_e64 v38, s92, v38
 v_bfe_u32 v224, v0, 2, 2
 v_mul_u32_u24 v224, 4160, v224
 v_and_b32_e64 v225, 3, v0
 v_lshl_add_u32 v224, v225, 3, v224
 v_lshl_add_u32 v224, v3, 5, v224
 s_lshl_b32 s80, s68, 10
 v_add_u32_e64 v224, s80, v224
 s_lshr_b32 s80, s69, 3
 s_and_b32 s81, s69, 7
 s_lshl_b32 s81, s81, 2
 s_add_u32 s81, s81, s68
 s_lshl_b32 s96, s80, 18
 s_lshl_b32 s82, s81, 10
 s_add_u32 s96, s96, s82
 s_add_u32 s96, s96, 10485760
 s_mul_i32 s97, s81, 163840
 s_lshl_b32 s80, s80, 7
 s_add_u32 s97, s97, s80
 s_add_u32 s97, s97, 1280
 s_mul_i32 s98, s68, 8448
 s_add_u32 s98, s98, 33280
 v_lshrrev_b32 v226, 3, v1
 v_and_b32 v227, 7, v0
 v_lshlrev_b32_e64 v228, 15, v226
 v_lshl_add_u32 v228, v227, 7, v228
 v_mul_u32_u24 v229, 1040, v227
 v_lshl_add_u32 v229, v226, 4, v229
 v_add_u32_e64 v229, s98, v229
 v_mul_u32_u24 v230, 2560, v226
 v_lshl_add_u32 v230, v227, 4, v230
 s_nop 0
 ds_write_b128 v38, v[20:23] offset:4096
 v_mov_b32 v8, -1
 v_mov_b32 v9, -1
 v_mov_b32 v10, -1
 v_mov_b32 v11, -1
 v_mov_b32 v12, v39
 s_cmp_lg_u32 s68, 0
 s_cbranch_scc1 b_t0
 s_call_b64 s[36:37], pb0
b_t0:
 s_cmp_lg_u32 s68, 1
 s_cbranch_scc1 b_t1
 s_call_b64 s[36:37], pb1
b_t1:
 s_cmp_lg_u32 s68, 2
 s_cbranch_scc1 b_t2
 s_call_b64 s[36:37], pb2
b_t2:
 s_cmp_lg_u32 s68, 3
 s_cbranch_scc1 b_t3
 s_call_b64 s[36:37], pb3
b_t3:
 s_add_u32 s81, s99, 0
 s_and_b32 s81, s81, 31
 s_lshl_b32 s80, s81, 10
 s_lshl_b32 s81, s81, 7
 v_add_u32 v64, s80, v40
 v_add_u32 v65, s81, v41
 s_add_u32 s81, s5, 5
 s_and_b32 s81, s81, 31
 s_mul_i32 s82, s81, 81920
 s_lshl_b32 s81, s81, 10
 s_add_u32 m0, s81, 256
 s_nop 0
 buffer_load_dwordx4 v6, s[40:43], s82 offen lds
 s_waitcnt vmcnt(7)
 ds_read_b64_tr_b16 v[48:49], v64 offset:272
 ds_read_b64_tr_b16 v[50:51], v64 offset:256
 ds_read_b64_tr_b16 v[52:53], v64 offset:784
 ds_read_b64_tr_b16 v[54:55], v64 offset:768
 s_waitcnt lgkmcnt(3)
 ds_write_b64 v65, v[48:49] offset:33312
 s_waitcnt lgkmcnt(3)
 ds_write_b64 v65, v[50:51] offset:37480
 s_waitcnt lgkmcnt(3)
 ds_write_b64 v65, v[52:53] offset:33376
 s_waitcnt lgkmcnt(3)
 ds_write_b64 v65, v[54:55] offset:37544
 s_add_u32 s81, s99, 1
 s_and_b32 s81, s81, 31
 s_lshl_b32 s80, s81, 10
 s_lshl_b32 s81, s81, 7
 v_add_u32 v66, s80, v40
 v_add_u32_e64 v67, s81, v41
 s_add_u32 s81, s5, 6
 s_and_b32 s81, s81, 31
 s_mul_i32 s82, s81, 81920
 s_lshl_b32 s81, s81, 10
 s_add_u32 m0, s81, 256
 s_nop 0
 buffer_load_dwordx4 v6, s[40:43], s82 offen lds
 s_waitcnt vmcnt(5)
 ds_read_b64_tr_b16 v[56:57], v66 offset:272
 ds_read_b64_tr_b16 v[58:59], v66 offset:256
 ds_read_b64_tr_b16 v[60:61], v66 offset:784
 ds_read_b64_tr_b16 v[62:63], v66 offset:768
 s_waitcnt lgkmcnt(3)
 ds_write_b64 v67, v[56:57] offset:33312
 s_waitcnt lgkmcnt(3)
 ds_write_b64 v67, v[58:59] offset:37480
 s_waitcnt lgkmcnt(3)
 ds_write_b64 v67, v[60:61] offset:33376
 s_waitcnt lgkmcnt(3)
 ds_write_b64 v67, v[62:63] offset:37544
 s_add_u32 s81, s99, 2
 s_and_b32 s81, s81, 31
 s_lshl_b32 s80, s81, 10
 s_lshl_b32 s81, s81, 7
 v_add_u32 v64, s80, v40
 v_add_u32_e64 v65, s81, v41
 s_add_u32 s81, s5, 7
 s_and_b32 s81, s81, 31
 s_mul_i32 s82, s81, 81920
 s_lshl_b32 s81, s81, 10
 s_add_u32 m0, s81, 256
 s_nop 0
 buffer_load_dwordx4 v6, s[40:43], s82 offen lds
 s_waitcnt vmcnt(5)
 ds_read_b64_tr_b16 v[48:49], v64 offset:272
 ds_read_b64_tr_b16 v[50:51], v64 offset:256
 ds_read_b64_tr_b16 v[52:53], v64 offset:784
 ds_read_b64_tr_b16 v[54:55], v64 offset:768
 s_waitcnt lgkmcnt(3)
 ds_write_b64 v65, v[48:49] offset:33312
 s_waitcnt lgkmcnt(3)
 ds_write_b64 v65, v[50:51] offset:37480
 s_waitcnt lgkmcnt(3)
 ds_write_b64 v65, v[52:53] offset:33376
 s_waitcnt lgkmcnt(3)
 ds_write_b64 v65, v[54:55] offset:37544
 s_add_u32 s81, s99, 3
 s_and_b32 s81, s81, 31
 s_lshl_b32 s80, s81, 10
 s_lshl_b32 s81, s81, 7
 v_add_u32 v66, s80, v40
 v_add_u32 v67, s81, v41
 s_waitcnt vmcnt(4)
 ds_read_b64_tr_b16 v[56:57], v66 offset:272
 ds_read_b64_tr_b16 v[58:59], v66 offset:256
 ds_read_b64_tr_b16 v[60:61], v66 offset:784
 ds_read_b64_tr_b16 v[62:63], v66 offset:768
 s_waitcnt lgkmcnt(3)
 ds_write_b64 v67, v[56:57] offset:33312
 s_waitcnt lgkmcnt(3)
 ds_write_b64 v67, v[58:59] offset:37480
 s_waitcnt lgkmcnt(3)
 ds_write_b64 v67, v[60:61] offset:33376
 s_waitcnt lgkmcnt(3)
 ds_write_b64 v67, v[62:63] offset:37544
 s_add_u32 s81, s99, 4
 s_and_b32 s81, s81, 31
 s_lshl_b32 s80, s81, 10
 s_lshl_b32 s81, s81, 7
 v_add_u32 v64, s80, v40
 v_add_u32_e64 v65, s81, v41
 s_waitcnt vmcnt(3)
 ds_read_b64_tr_b16 v[48:49], v64 offset:272
 ds_read_b64_tr_b16 v[50:51], v64 offset:256
 ds_read_b64_tr_b16 v[52:53], v64 offset:784
 ds_read_b64_tr_b16 v[54:55], v64 offset:768
 s_waitcnt lgkmcnt(3)
 ds_write_b64 v65, v[48:49] offset:33312
 s_waitcnt lgkmcnt(3)
 ds_write_b64 v65, v[50:51] offset:37480
 s_waitcnt lgkmcnt(3)
 ds_write_b64 v65, v[52:53] offset:33376
 s_waitcnt lgkmcnt(3)
 ds_write_b64 v65, v[54:55] offset:37544
 s_add_u32 s81, s99, 5
 s_and_b32 s81, s81, 31
 s_lshl_b32 s80, s81, 10
 s_lshl_b32 s81, s81, 7
 v_add_u32 v66, s80, v40
 v_add_u32_e64 v67, s81, v41
 s_waitcnt vmcnt(2)
 ds_read_b64_tr_b16 v[56:57], v66 offset:272
 ds_read_b64_tr_b16 v[58:59], v66 offset:256
 ds_read_b64_tr_b16 v[60:61], v66 offset:784
 ds_read_b64_tr_b16 v[62:63], v66 offset:768
 s_waitcnt lgkmcnt(3)
 ds_write_b64 v67, v[56:57] offset:33312
 s_waitcnt lgkmcnt(3)
 ds_write_b64 v67, v[58:59] offset:37480
 s_waitcnt lgkmcnt(3)
 ds_write_b64 v67, v[60:61] offset:33376
 s_waitcnt lgkmcnt(3)
 ds_write_b64 v67, v[62:63] offset:37544
 s_add_u32 s81, s99, 6
 s_and_b32 s81, s81, 31
 s_lshl_b32 s80, s81, 10
 s_lshl_b32 s81, s81, 7
 v_add_u32 v64, s80, v40
 v_add_u32_e64 v65, s81, v41
 s_waitcnt vmcnt(1)
 ds_read_b64_tr_b16 v[48:49], v64 offset:272
 ds_read_b64_tr_b16 v[50:51], v64 offset:256
 ds_read_b64_tr_b16 v[52:53], v64 offset:784
 ds_read_b64_tr_b16 v[54:55], v64 offset:768
 s_waitcnt lgkmcnt(3)
 ds_write_b64 v65, v[48:49] offset:33312
 s_waitcnt lgkmcnt(3)
 ds_write_b64 v65, v[50:51] offset:37480
 s_waitcnt lgkmcnt(3)
 ds_write_b64 v65, v[52:53] offset:33376
 s_waitcnt lgkmcnt(3)
 ds_write_b64 v65, v[54:55] offset:37544
 s_add_u32 s81, s99, 7
 s_and_b32 s81, s81, 31
 s_lshl_b32 s80, s81, 10
 s_lshl_b32 s81, s81, 7
 v_add_u32 v66, s80, v40
 v_add_u32_e64 v67, s81, v41
 s_waitcnt vmcnt(0)
 ds_read_b64_tr_b16 v[56:57], v66 offset:272
 ds_read_b64_tr_b16 v[58:59], v66 offset:256
 ds_read_b64_tr_b16 v[60:61], v66 offset:784
 ds_read_b64_tr_b16 v[62:63], v66 offset:768
 s_waitcnt lgkmcnt(3)
 ds_write_b64 v67, v[56:57] offset:33312
 s_waitcnt lgkmcnt(3)
 ds_write_b64 v67, v[58:59] offset:37480
 s_waitcnt lgkmcnt(3)
 ds_write_b64 v67, v[60:61] offset:33376
 s_waitcnt lgkmcnt(3)
 ds_write_b64 v67, v[62:63] offset:37544
 s_waitcnt lgkmcnt(0)
 s_barrier
 ds_read_b64_tr_b16 v[48:49], v42 offset:208
 s_waitcnt lgkmcnt(0)
 ds_write_b64 v43, v[48:49] offset:33304
 s_mov_b32 s93, 0
 s_mov_b32 s95, 0
 s_waitcnt lgkmcnt(0)
 s_barrier
b_conv:
 ds_read_b128 a[32:35], v36 offset:3584
 ds_read2_b32 a[0:1], v216 offset0:0 offset1:1
 ds_read2_b32 a[2:3], v216 offset0:2 offset1:3
 ds_read_b128 a[36:39], v36 offset:3072
 ds_read2_b32 a[4:5], v216 offset0:128 offset1:129
 ds_read2_b32 a[6:7], v216 offset0:130 offset1:131
 ds_read_b128 a[40:43], v36 offset:2560
 ds_read2_b32 a[8:9], v217 offset0:0 offset1:1
 ds_read2_b32 a[10:11], v217 offset0:2 offset1:3
 ds_read_b128 a[44:47], v36 offset:2048
 ds_read2_b32 a[12:13], v217 offset0:128 offset1:129
 ds_read2_b32 a[14:15], v217 offset0:130 offset1:131
 ds_read_b128 a[48:51], v36 offset:1536
 ds_read2_b32 a[16:17], v218 offset0:0 offset1:1
 ds_read2_b32 a[18:19], v218 offset0:2 offset1:3
 ds_read_b128 a[52:55], v36 offset:1024
 ds_read2_b32 a[20:21], v218 offset0:128 offset1:129
 ds_read2_b32 a[22:23], v218 offset0:130 offset1:131
 ds_read_b128 a[56:59], v36 offset:512
 ds_read2_b32 a[24:25], v219 offset0:0 offset1:1
 ds_read2_b32 a[26:27], v219 offset0:2 offset1:3
 ds_read_b128 a[60:63], v36 offset:0
 ds_read2_b32 a[28:29], v219 offset0:128 offset1:129
 ds_read2_b32 a[30:31], v219 offset0:130 offset1:131
 s_waitcnt lgkmcnt(14)
 v_mfma_f32_16x16x32_bf16 v[184:187], a[0:3], a[32:35], 0
 s_waitcnt lgkmcnt(14)
 v_mfma_f32_16x16x32_bf16 v[188:191], a[0:3], a[36:39], 0
 v_mfma_f32_16x16x32_bf16 v[192:195], a[4:7], a[36:39], 0
 ds_read_b128 a[96:99], v36 offset:3648
 v_mfma_f32_16x16x32_bf16 v[188:191], a[4:7], a[32:35], v[188:191]
 ds_read2_b32 a[64:65], v216 offset0:16 offset1:17
 s_waitcnt lgkmcnt(14)
 v_mfma_f32_16x16x32_bf16 v[192:195], a[0:3], a[40:43], v[192:195]
 ds_read2_b32 a[66:67], v216 offset0:18 offset1:19
 v_mfma_f32_16x16x32_bf16 v[196:199], a[4:7], a[40:43], 0
 v_mfma_f32_16x16x32_bf16 v[200:203], a[8:11], a[40:43], 0
 ds_read_b128 a[100:103], v36 offset:3136
 v_mfma_f32_16x16x32_bf16 v[192:195], a[8:11], a[32:35], v[192:195]
 ds_read2_b32 a[68:69], v216 offset0:144 offset1:145
 v_mfma_f32_16x16x32_bf16 v[196:199], a[8:11], a[36:39], v[196:199]
 ds_read2_b32 a[70:71], v216 offset0:146 offset1:147
 s_waitcnt lgkmcnt(14)
 v_mfma_f32_16x16x32_bf16 v[196:199], a[0:3], a[44:47], v[196:199]
 ds_read_b128 a[104:107], v36 offset:2624
 v_mfma_f32_16x16x32_bf16 v[200:203], a[4:7], a[44:47], v[200:203]
 ds_read2_b32 a[72:73], v217 offset0:16 offset1:17
 v_mfma_f32_16x16x32_bf16 v[204:207], a[8:11], a[44:47], 0
 ds_read2_b32 a[74:75], v217 offset0:18 offset1:19
 v_mfma_f32_16x16x32_bf16 v[208:211], a[12:15], a[44:47], 0
 buffer_store_dwordx4 v[8:11], v12, s[76:79], s6 offen offset:0 sc1
 v_mfma_f32_16x16x32_bf16 v[196:199], a[12:15], a[32:35], v[196:199]
 ds_read_b128 a[108:111], v36 offset:2112
 v_mfma_f32_16x16x32_bf16 v[200:203], a[12:15], a[36:39], v[200:203]
 ds_read2_b32 a[76:77], v217 offset0:144 offset1:145
 v_mfma_f32_16x16x32_bf16 v[204:207], a[12:15], a[40:43], v[204:207]
 ds_read2_b32 a[78:79], v217 offset0:146 offset1:147
 s_waitcnt lgkmcnt(14)
 v_mfma_f32_16x16x32_bf16 v[200:203], a[0:3], a[48:51], v[200:203]
 ds_read_b128 a[112:115], v36 offset:1600
 v_mfma_f32_16x16x32_bf16 v[204:207], a[4:7], a[48:51], v[204:207]
 ds_read2_b32 a[80:81], v218 offset0:16 offset1:17
 v_mfma_f32_16x16x32_bf16 v[208:211], a[8:11], a[48:51], v[208:211]
 ds_read2_b32 a[82:83], v218 offset0:18 offset1:19
 v_mfma_f32_16x16x32_bf16 v[212:215], a[12:15], a[48:51], 0
 buffer_store_dwordx4 v[8:11], v12, s[76:79], s6 offen offset:1024 sc1
 v_mfma_f32_16x16x32_bf16 v[200:203], a[16:19], a[32:35], v[200:203]
 ds_read_b128 a[116:119], v36 offset:1088
 v_mfma_f32_16x16x32_bf16 v[204:207], a[16:19], a[36:39], v[204:207]
 ds_read2_b32 a[84:85], v218 offset0:144 offset1:145
 v_mfma_f32_16x16x32_bf16 v[208:211], a[16:19], a[40:43], v[208:211]
 ds_read2_b32 a[86:87], v218 offset0:146 offset1:147
 v_mfma_f32_16x16x32_bf16 v[212:215], a[16:19], a[44:47], v[212:215]
 ds_read_b128 a[120:123], v36 offset:576
 s_waitcnt lgkmcnt(14)
 v_mfma_f32_16x16x32_bf16 v[204:207], a[0:3], a[52:55], v[204:207]
 ds_read2_b32 a[88:89], v219 offset0:16 offset1:17
 v_mfma_f32_16x16x32_bf16 v[208:211], a[4:7], a[52:55], v[208:211]
 ds_read2_b32 a[90:91], v219 offset0:18 offset1:19
 v_mfma_f32_16x16x32_bf16 v[212:215], a[8:11], a[52:55], v[212:215]
 buffer_store_dwordx4 v[8:11], v12, s[76:79], s6 offen offset:2048 sc1
 v_mfma_f32_16x16x32_bf16 v[204:207], a[20:23], a[32:35], v[204:207]
 ds_read_b128 a[124:127], v36 offset:64
 v_mfma_f32_16x16x32_bf16 v[208:211], a[20:23], a[36:39], v[208:211]
 ds_read2_b32 a[92:93], v219 offset0:144 offset1:145
 v_mfma_f32_16x16x32_bf16 v[212:215], a[20:23], a[40:43], v[212:215]
 ds_read2_b32 a[94:95], v219 offset0:146 offset1:147
 s_waitcnt lgkmcnt(14)
 v_mfma_f32_16x16x32_bf16 v[208:211], a[0:3], a[56:59], v[208:211]
 buffer_store_dwordx4 v[8:11], v12, s[76:79], s6 offen offset:3072 sc1
 v_mfma_f32_16x16x32_bf16 v[212:215], a[4:7], a[56:59], v[212:215]
 v_mfma_f32_16x16x32_bf16 v[208:211], a[24:27], a[32:35], v[208:211]
 v_mfma_f32_16x16x32_bf16 v[212:215], a[24:27], a[36:39], v[212:215]
 s_waitcnt lgkmcnt(14)
 v_mfma_f32_16x16x32_bf16 v[212:215], a[0:3], a[60:63], v[212:215]
 v_mfma_f32_16x16x32_bf16 v[212:215], a[28:31], a[32:35], v[212:215]
 s_waitcnt lgkmcnt(12)
 v_mfma_f32_16x16x32_bf16 v[184:187], a[64:67], a[96:99], v[184:187]
 v_mfma_f32_16x16x32_bf16 v[188:191], a[64:67], a[100:103], v[188:191]
 v_mfma_f32_16x16x32_bf16 v[192:195], a[68:71], a[100:103], v[192:195]
 ds_read_b128 a[32:35], v36 offset:3712
 v_mfma_f32_16x16x32_bf16 v[188:191], a[68:71], a[96:99], v[188:191]
 ds_read2_b32 a[0:1], v216 offset0:32 offset1:33
 v_mfma_f32_16x16x32_bf16 v[192:195], a[64:67], a[104:107], v[192:195]
 ds_read2_b32 a[2:3], v216 offset0:34 offset1:35
 v_mfma_f32_16x16x32_bf16 v[196:199], a[68:71], a[104:107], v[196:199]
 v_mfma_f32_16x16x32_bf16 v[200:203], a[72:75], a[104:107], v[200:203]
 ds_read_b128 a[36:39], v36 offset:3200
 v_mfma_f32_16x16x32_bf16 v[192:195], a[72:75], a[96:99], v[192:195]
 ds_read2_b32 a[4:5], v216 offset0:160 offset1:161
 v_mfma_f32_16x16x32_bf16 v[196:199], a[72:75], a[100:103], v[196:199]
 ds_read2_b32 a[6:7], v216 offset0:162 offset1:163
 v_mfma_f32_16x16x32_bf16 v[196:199], a[64:67], a[108:111], v[196:199]
 ds_read_b128 a[40:43], v36 offset:2688
 s_branch pb2_skip
.p2align 12
pb2:
 s_setpc_b64 s[36:37]
 s_nop 0
pb2_skip:
 v_mfma_f32_16x16x32_bf16 v[200:203], a[68:71], a[108:111], v[200:203]
 ds_read2_b32 a[8:9], v217 offset0:32 offset1:33
 v_mfma_f32_16x16x32_bf16 v[204:207], a[72:75], a[108:111], v[204:207]
 ds_read2_b32 a[10:11], v217 offset0:34 offset1:35
 v_mfma_f32_16x16x32_bf16 v[208:211], a[76:79], a[108:111], v[208:211]
 buffer_store_dwordx4 v[8:11], v12, s[76:79], s7 offen offset:0 sc1
 v_mfma_f32_16x16x32_bf16 v[196:199], a[76:79], a[96:99], v[196:199]
 ds_read_b128 a[44:47], v36 offset:2176
 v_mfma_f32_16x16x32_bf16 v[200:203], a[76:79], a[100:103], v[200:203]
 ds_read2_b32 a[12:13], v217 offset0:160 offset1:161
 v_mfma_f32_16x16x32_bf16 v[204:207], a[76:79], a[104:107], v[204:207]
 ds_read2_b32 a[14:15], v217 offset0:162 offset1:163
 s_waitcnt lgkmcnt(12)
 v_mfma_f32_16x16x32_bf16 v[200:203], a[64:67], a[112:115], v[200:203]
 ds_read_b128 a[48:51], v36 offset:1664
 v_mfma_f32_16x16x32_bf16 v[204:207], a[68:71], a[112:115], v[204:207]
 ds_read2_b32 a[16:17], v218 offset0:32 offset1:33
 v_mfma_f32_16x16x32_bf16 v[208:211], a[72:75], a[112:115], v[208:211]
 ds_read2_b32 a[18:19], v218 offset0:34 offset1:35
 v_mfma_f32_16x16x32_bf16 v[212:215], a[76:79], a[112:115], v[212:215]
 buffer_store_dwordx4 v[8:11], v12, s[76:79], s7 offen offset:1024 sc1
 v_mfma_f32_16x16x32_bf16 v[200:203], a[80:83], a[96:99], v[200:203]
 ds_read_b128 a[52:55], v36 offset:1152
 v_mfma_f32_16x16x32_bf16 v[204:207], a[80:83], a[100:103], v[204:207]
 ds_read2_b32 a[20:21], v218 offset0:160 offset1:161
 v_mfma_f32_16x16x32_bf16 v[208:211], a[80:83], a[104:107], v[208:211]
 ds_read2_b32 a[22:23], v218 offset0:162 offset1:163
 v_mfma_f32_16x16x32_bf16 v[212:215], a[80:83], a[108:111], v[212:215]
 ds_read_b128 a[56:59], v36 offset:640
 v_mfma_f32_16x16x32_bf16 v[204:207], a[64:67], a[116:119], v[204:207]
 ds_read2_b32 a[24:25], v219 offset0:32 offset1:33
 v_mfma_f32_16x16x32_bf16 v[208:211], a[68:71], a[116:119], v[208:211]
 ds_read2_b32 a[26:27], v219 offset0:34 offset1:35
 v_mfma_f32_16x16x32_bf16 v[212:215], a[72:75], a[116:119], v[212:215]
 buffer_store_dwordx4 v[8:11], v12, s[76:79], s7 offen offset:2048 sc1
 v_mfma_f32_16x16x32_bf16 v[204:207], a[84:87], a[96:99], v[204:207]
 ds_read_b128 a[60:63], v36 offset:128
 v_mfma_f32_16x16x32_bf16 v[208:211], a[84:87], a[100:103], v[208:211]
 ds_read2_b32 a[28:29], v219 offset0:160 offset1:161
 v_mfma_f32_16x16x32_bf16 v[212:215], a[84:87], a[104:107], v[212:215]
 ds_read2_b32 a[30:31], v219 offset0:162 offset1:163
 v_mfma_f32_16x16x32_bf16 v[208:211], a[64:67], a[120:123], v[208:211]
 buffer_store_dwordx4 v[8:11], v12, s[76:79], s7 offen offset:3072 sc1
 v_mfma_f32_16x16x32_bf16 v[212:215], a[68:71], a[120:123], v[212:215]
 v_mfma_f32_16x16x32_bf16 v[208:211], a[88:91], a[96:99], v[208:211]
 v_mfma_f32_16x16x32_bf16 v[212:215], a[88:91], a[100:103], v[212:215]
 v_mfma_f32_16x16x32_bf16 v[212:215], a[64:67], a[124:127], v[212:215]
 v_mfma_f32_16x16x32_bf16 v[212:215], a[92:95], a[96:99], v[212:215]
 s_waitcnt lgkmcnt(12)
 v_mfma_f32_16x16x32_bf16 v[184:187], a[0:3], a[32:35], v[184:187]
 v_mfma_f32_16x16x32_bf16 v[188:191], a[0:3], a[36:39], v[188:191]
 v_mfma_f32_16x16x32_bf16 v[192:195], a[4:7], a[36:39], v[192:195]
 ds_read_b128 a[96:99], v36 offset:3776
 v_mfma_f32_16x16x32_bf16 v[188:191], a[4:7], a[32:35], v[188:191]
 ds_read2_b32 a[64:65], v216 offset0:48 offset1:49
 v_mfma_f32_16x16x32_bf16 v[192:195], a[0:3], a[40:43], v[192:195]
 ds_read2_b32 a[66:67], v216 offset0:50 offset1:51
 v_mfma_f32_16x16x32_bf16 v[196:199], a[4:7], a[40:43], v[196:199]
 v_mfma_f32_16x16x32_bf16 v[200:203], a[8:11], a[40:43], v[200:203]
 ds_read_b128 a[100:103], v36 offset:3264
 v_mfma_f32_16x16x32_bf16 v[192:195], a[8:11], a[32:35], v[192:195]
 ds_read2_b32 a[68:69], v216 offset0:176 offset1:177
 v_mfma_f32_16x16x32_bf16 v[196:199], a[8:11], a[36:39], v[196:199]
 ds_read2_b32 a[70:71], v216 offset0:178 offset1:179
 v_mfma_f32_16x16x32_bf16 v[196:199], a[0:3], a[44:47], v[196:199]
 ds_read_b128 a[104:107], v36 offset:2752
 v_mfma_f32_16x16x32_bf16 v[200:203], a[4:7], a[44:47], v[200:203]
 ds_read2_b32 a[72:73], v217 offset0:48 offset1:49
 v_mfma_f32_16x16x32_bf16 v[204:207], a[8:11], a[44:47], v[204:207]
 ds_read2_b32 a[74:75], v217 offset0:50 offset1:51
 v_mfma_f32_16x16x32_bf16 v[208:211], a[12:15], a[44:47], v[208:211]
 v_mfma_f32_16x16x32_bf16 v[196:199], a[12:15], a[32:35], v[196:199]
 ds_read_b128 a[108:111], v36 offset:2240
 v_mfma_f32_16x16x32_bf16 v[200:203], a[12:15], a[36:39], v[200:203]
 ds_read2_b32 a[76:77], v217 offset0:176 offset1:177
 v_mfma_f32_16x16x32_bf16 v[204:207], a[12:15], a[40:43], v[204:207]
 ds_read2_b32 a[78:79], v217 offset0:178 offset1:179
 s_waitcnt lgkmcnt(12)
 v_mfma_f32_16x16x32_bf16 v[200:203], a[0:3], a[48:51], v[200:203]
 ds_read_b128 a[112:115], v36 offset:1728
 v_mfma_f32_16x16x32_bf16 v[204:207], a[4:7], a[48:51], v[204:207]
 ds_read2_b32 a[80:81], v218 offset0:48 offset1:49
 v_mfma_f32_16x16x32_bf16 v[208:211], a[8:11], a[48:51], v[208:211]
 ds_read2_b32 a[82:83], v218 offset0:50 offset1:51
 v_mfma_f32_16x16x32_bf16 v[212:215], a[12:15], a[48:51], v[212:215]
 v_mfma_f32_16x16x32_bf16 v[200:203], a[16:19], a[32:35], v[200:203]
 ds_read_b128 a[116:119], v36 offset:1216
 v_mfma_f32_16x16x32_bf16 v[204:207], a[16:19], a[36:39], v[204:207]
 ds_read2_b32 a[84:85], v218 offset0:176 offset1:177
 v_mfma_f32_16x16x32_bf16 v[208:211], a[16:19], a[40:43], v[208:211]
 ds_read2_b32 a[86:87], v218 offset0:178 offset1:179
 v_mfma_f32_16x16x32_bf16 v[212:215], a[16:19], a[44:47], v[212:215]
 ds_read_b128 a[120:123], v36 offset:704
 v_mfma_f32_16x16x32_bf16 v[204:207], a[0:3], a[52:55], v[204:207]
 ds_read2_b32 a[88:89], v219 offset0:48 offset1:49
 v_mfma_f32_16x16x32_bf16 v[208:211], a[4:7], a[52:55], v[208:211]
 ds_read2_b32 a[90:91], v219 offset0:50 offset1:51
 v_mfma_f32_16x16x32_bf16 v[212:215], a[8:11], a[52:55], v[212:215]
 v_mfma_f32_16x16x32_bf16 v[204:207], a[20:23], a[32:35], v[204:207]
 ds_read_b128 a[124:127], v36 offset:192
 v_mfma_f32_16x16x32_bf16 v[208:211], a[20:23], a[36:39], v[208:211]
 ds_read2_b32 a[92:93], v219 offset0:176 offset1:177
 v_mfma_f32_16x16x32_bf16 v[212:215], a[20:23], a[40:43], v[212:215]
 ds_read2_b32 a[94:95], v219 offset0:178 offset1:179
 v_mfma_f32_16x16x32_bf16 v[208:211], a[0:3], a[56:59], v[208:211]
 v_mfma_f32_16x16x32_bf16 v[212:215], a[4:7], a[56:59], v[212:215]
 v_mfma_f32_16x16x32_bf16 v[208:211], a[24:27], a[32:35], v[208:211]
 v_mfma_f32_16x16x32_bf16 v[212:215], a[24:27], a[36:39], v[212:215]
 v_mfma_f32_16x16x32_bf16 v[212:215], a[0:3], a[60:63], v[212:215]
 v_mfma_f32_16x16x32_bf16 v[212:215], a[28:31], a[32:35], v[212:215]
 s_waitcnt lgkmcnt(12)
 v_mfma_f32_16x16x32_bf16 v[184:187], a[64:67], a[96:99], v[184:187]
 v_mfma_f32_16x16x32_bf16 v[188:191], a[64:67], a[100:103], v[188:191]
 v_mfma_f32_16x16x32_bf16 v[192:195], a[68:71], a[100:103], v[192:195]
 ds_read_b128 a[32:35], v36 offset:3840
 v_mfma_f32_16x16x32_bf16 v[188:191], a[68:71], a[96:99], v[188:191]
 ds_read2_b32 a[0:1], v216 offset0:64 offset1:65
 v_mfma_f32_16x16x32_bf16 v[192:195], a[64:67], a[104:107], v[192:195]
 ds_read2_b32 a[2:3], v216 offset0:66 offset1:67
 v_mfma_f32_16x16x32_bf16 v[196:199], a[68:71], a[104:107], v[196:199]
 v_mfma_f32_16x16x32_bf16 v[200:203], a[72:75], a[104:107], v[200:203]
 ds_read_b128 a[36:39], v36 offset:3328
 v_mfma_f32_16x16x32_bf16 v[192:195], a[72:75], a[96:99], v[192:195]
 ds_read2_b32 a[4:5], v216 offset0:192 offset1:193
 v_mfma_f32_16x16x32_bf16 v[196:199], a[72:75], a[100:103], v[196:199]
 ds_read2_b32 a[6:7], v216 offset0:194 offset1:195
 v_mfma_f32_16x16x32_bf16 v[196:199], a[64:67], a[108:111], v[196:199]
 ds_read_b128 a[40:43], v36 offset:2816
 v_mfma_f32_16x16x32_bf16 v[200:203], a[68:71], a[108:111], v[200:203]
 ds_read2_b32 a[8:9], v217 offset0:64 offset1:65
 v_mfma_f32_16x16x32_bf16 v[204:207], a[72:75], a[108:111], v[204:207]
 ds_read2_b32 a[10:11], v217 offset0:66 offset1:67
 v_mfma_f32_16x16x32_bf16 v[208:211], a[76:79], a[108:111], v[208:211]
 v_mfma_f32_16x16x32_bf16 v[196:199], a[76:79], a[96:99], v[196:199]
 ds_read_b128 a[44:47], v36 offset:2304
 v_mfma_f32_16x16x32_bf16 v[200:203], a[76:79], a[100:103], v[200:203]
 ds_read2_b32 a[12:13], v217 offset0:192 offset1:193
 v_mfma_f32_16x16x32_bf16 v[204:207], a[76:79], a[104:107], v[204:207]
 ds_read2_b32 a[14:15], v217 offset0:194 offset1:195
 s_waitcnt lgkmcnt(12)
 v_mfma_f32_16x16x32_bf16 v[200:203], a[64:67], a[112:115], v[200:203]
 ds_read_b128 a[48:51], v36 offset:1792
 v_mfma_f32_16x16x32_bf16 v[204:207], a[68:71], a[112:115], v[204:207]
 ds_read2_b32 a[16:17], v218 offset0:64 offset1:65
 v_mfma_f32_16x16x32_bf16 v[208:211], a[72:75], a[112:115], v[208:211]
 ds_read2_b32 a[18:19], v218 offset0:66 offset1:67
 v_mfma_f32_16x16x32_bf16 v[212:215], a[76:79], a[112:115], v[212:215]
 v_mfma_f32_16x16x32_bf16 v[200:203], a[80:83], a[96:99], v[200:203]
 ds_read_b128 a[52:55], v36 offset:1280
 v_mfma_f32_16x16x32_bf16 v[204:207], a[80:83], a[100:103], v[204:207]
 ds_read2_b32 a[20:21], v218 offset0:192 offset1:193
 v_mfma_f32_16x16x32_bf16 v[208:211], a[80:83], a[104:107], v[208:211]
 ds_read2_b32 a[22:23], v218 offset0:194 offset1:195
 v_mfma_f32_16x16x32_bf16 v[212:215], a[80:83], a[108:111], v[212:215]
 ds_read_b128 a[56:59], v36 offset:768
 v_mfma_f32_16x16x32_bf16 v[204:207], a[64:67], a[116:119], v[204:207]
 ds_read2_b32 a[24:25], v219 offset0:64 offset1:65
 v_mfma_f32_16x16x32_bf16 v[208:211], a[68:71], a[116:119], v[208:211]
 ds_read2_b32 a[26:27], v219 offset0:66 offset1:67
 v_mfma_f32_16x16x32_bf16 v[212:215], a[72:75], a[116:119], v[212:215]
 v_mfma_f32_16x16x32_bf16 v[204:207], a[84:87], a[96:99], v[204:207]
 ds_read_b128 a[60:63], v36 offset:256
 v_mfma_f32_16x16x32_bf16 v[208:211], a[84:87], a[100:103], v[208:211]
 ds_read2_b32 a[28:29], v219 offset0:192 offset1:193
 v_mfma_f32_16x16x32_bf16 v[212:215], a[84:87], a[104:107], v[212:215]
 ds_read2_b32 a[30:31], v219 offset0:194 offset1:195
 v_mfma_f32_16x16x32_bf16 v[208:211], a[64:67], a[120:123], v[208:211]
 v_mfma_f32_16x16x32_bf16 v[212:215], a[68:71], a[120:123], v[212:215]
 v_mfma_f32_16x16x32_bf16 v[208:211], a[88:91], a[96:99], v[208:211]
 v_mfma_f32_16x16x32_bf16 v[212:215], a[88:91], a[100:103], v[212:215]
 v_mfma_f32_16x16x32_bf16 v[212:215], a[64:67], a[124:127], v[212:215]
 v_mfma_f32_16x16x32_bf16 v[212:215], a[92:95], a[96:99], v[212:215]
 s_waitcnt lgkmcnt(12)
 v_mfma_f32_16x16x32_bf16 v[184:187], a[0:3], a[32:35], v[184:187]
 v_mfma_f32_16x16x32_bf16 v[188:191], a[0:3], a[36:39], v[188:191]
 v_mfma_f32_16x16x32_bf16 v[192:195], a[4:7], a[36:39], v[192:195]
 ds_read_b128 a[96:99], v36 offset:3904
 v_mfma_f32_16x16x32_bf16 v[188:191], a[4:7], a[32:35], v[188:191]
 ds_read2_b32 a[64:65], v216 offset0:80 offset1:81
 v_mfma_f32_16x16x32_bf16 v[192:195], a[0:3], a[40:43], v[192:195]
 ds_read2_b32 a[66:67], v216 offset0:82 offset1:83
 v_mfma_f32_16x16x32_bf16 v[196:199], a[4:7], a[40:43], v[196:199]
 v_mfma_f32_16x16x32_bf16 v[200:203], a[8:11], a[40:43], v[200:203]
 ds_read_b128 a[100:103], v36 offset:3392
 v_mfma_f32_16x16x32_bf16 v[192:195], a[8:11], a[32:35], v[192:195]
 ds_read2_b32 a[68:69], v216 offset0:208 offset1:209
 v_mfma_f32_16x16x32_bf16 v[196:199], a[8:11], a[36:39], v[196:199]
 ds_read2_b32 a[70:71], v216 offset0:210 offset1:211
 v_mfma_f32_16x16x32_bf16 v[196:199], a[0:3], a[44:47], v[196:199]
 ds_read_b128 a[104:107], v36 offset:2880
 v_mfma_f32_16x16x32_bf16 v[200:203], a[4:7], a[44:47], v[200:203]
 ds_read2_b32 a[72:73], v217 offset0:80 offset1:81
 v_mfma_f32_16x16x32_bf16 v[204:207], a[8:11], a[44:47], v[204:207]
 ds_read2_b32 a[74:75], v217 offset0:82 offset1:83
 v_mfma_f32_16x16x32_bf16 v[208:211], a[12:15], a[44:47], v[208:211]
 v_mfma_f32_16x16x32_bf16 v[196:199], a[12:15], a[32:35], v[196:199]
 ds_read_b128 a[108:111], v36 offset:2368
 v_mfma_f32_16x16x32_bf16 v[200:203], a[12:15], a[36:39], v[200:203]
 ds_read2_b32 a[76:77], v217 offset0:208 offset1:209
 v_mfma_f32_16x16x32_bf16 v[204:207], a[12:15], a[40:43], v[204:207]
 ds_read2_b32 a[78:79], v217 offset0:210 offset1:211
 s_waitcnt lgkmcnt(12)
 v_mfma_f32_16x16x32_bf16 v[200:203], a[0:3], a[48:51], v[200:203]
 ds_read_b128 a[112:115], v36 offset:1856
 v_mfma_f32_16x16x32_bf16 v[204:207], a[4:7], a[48:51], v[204:207]
 ds_read2_b32 a[80:81], v218 offset0:80 offset1:81
 v_mfma_f32_16x16x32_bf16 v[208:211], a[8:11], a[48:51], v[208:211]
 ds_read2_b32 a[82:83], v218 offset0:82 offset1:83
 v_mfma_f32_16x16x32_bf16 v[212:215], a[12:15], a[48:51], v[212:215]
 v_mfma_f32_16x16x32_bf16 v[200:203], a[16:19], a[32:35], v[200:203]
 ds_read_b128 a[116:119], v36 offset:1344
 v_mfma_f32_16x16x32_bf16 v[204:207], a[16:19], a[36:39], v[204:207]
 ds_read2_b32 a[84:85], v218 offset0:208 offset1:209
 v_mfma_f32_16x16x32_bf16 v[208:211], a[16:19], a[40:43], v[208:211]
 ds_read2_b32 a[86:87], v218 offset0:210 offset1:211
 v_mfma_f32_16x16x32_bf16 v[212:215], a[16:19], a[44:47], v[212:215]
 ds_read_b128 a[120:123], v36 offset:832
 v_mfma_f32_16x16x32_bf16 v[204:207], a[0:3], a[52:55], v[204:207]
 ds_read2_b32 a[88:89], v219 offset0:80 offset1:81
 v_mfma_f32_16x16x32_bf16 v[208:211], a[4:7], a[52:55], v[208:211]
 ds_read2_b32 a[90:91], v219 offset0:82 offset1:83
 v_mfma_f32_16x16x32_bf16 v[212:215], a[8:11], a[52:55], v[212:215]
 v_mfma_f32_16x16x32_bf16 v[204:207], a[20:23], a[32:35], v[204:207]
 ds_read_b128 a[124:127], v36 offset:320
 v_mfma_f32_16x16x32_bf16 v[208:211], a[20:23], a[36:39], v[208:211]
 ds_read2_b32 a[92:93], v219 offset0:208 offset1:209
 v_mfma_f32_16x16x32_bf16 v[212:215], a[20:23], a[40:43], v[212:215]
 ds_read2_b32 a[94:95], v219 offset0:210 offset1:211
 v_mfma_f32_16x16x32_bf16 v[208:211], a[0:3], a[56:59], v[208:211]
 v_mfma_f32_16x16x32_bf16 v[212:215], a[4:7], a[56:59], v[212:215]
 v_mfma_f32_16x16x32_bf16 v[208:211], a[24:27], a[32:35], v[208:211]
 v_mfma_f32_16x16x32_bf16 v[212:215], a[24:27], a[36:39], v[212:215]
 v_mfma_f32_16x16x32_bf16 v[212:215], a[0:3], a[60:63], v[212:215]
 v_mfma_f32_16x16x32_bf16 v[212:215], a[28:31], a[32:35], v[212:215]
 buffer_load_dword v7, v4, s[76:79], s90 offen sc1
 s_waitcnt lgkmcnt(12)
 v_mfma_f32_16x16x32_bf16 v[184:187], a[64:67], a[96:99], v[184:187]
 v_mfma_f32_16x16x32_bf16 v[188:191], a[64:67], a[100:103], v[188:191]
 v_mfma_f32_16x16x32_bf16 v[192:195], a[68:71], a[100:103], v[192:195]
 ds_read_b128 a[32:35], v36 offset:3968
 v_mfma_f32_16x16x32_bf16 v[188:191], a[68:71], a[96:99], v[188:191]
 ds_read2_b32 a[0:1], v216 offset0:96 offset1:97
 v_mfma_f32_16x16x32_bf16 v[192:195], a[64:67], a[104:107], v[192:195]
 ds_read2_b32 a[2:3], v216 offset0:98 offset1:99
 v_mfma_f32_16x16x32_bf16 v[196:199], a[68:71], a[104:107], v[196:199]
 v_mfma_f32_16x16x32_bf16 v[200:203], a[72:75], a[104:107], v[200:203]
 ds_read_b128 a[36:39], v36 offset:3456
 v_mfma_f32_16x16x32_bf16 v[192:195], a[72:75], a[96:99], v[192:195]
 ds_read2_b32 a[4:5], v216 offset0:224 offset1:225
 v_mfma_f32_16x16x32_bf16 v[196:199], a[72:75], a[100:103], v[196:199]
 ds_read2_b32 a[6:7], v216 offset0:226 offset1:227
 v_mfma_f32_16x16x32_bf16 v[196:199], a[64:67], a[108:111], v[196:199]
 ds_read_b128 a[40:43], v36 offset:2944
 v_mfma_f32_16x16x32_bf16 v[200:203], a[68:71], a[108:111], v[200:203]
 ds_read2_b32 a[8:9], v217 offset0:96 offset1:97
 v_mfma_f32_16x16x32_bf16 v[204:207], a[72:75], a[108:111], v[204:207]
 ds_read2_b32 a[10:11], v217 offset0:98 offset1:99
 v_mfma_f32_16x16x32_bf16 v[208:211], a[76:79], a[108:111], v[208:211]
 v_mfma_f32_16x16x32_bf16 v[196:199], a[76:79], a[96:99], v[196:199]
 ds_read_b128 a[44:47], v36 offset:2432
 v_mfma_f32_16x16x32_bf16 v[200:203], a[76:79], a[100:103], v[200:203]
 ds_read2_b32 a[12:13], v217 offset0:224 offset1:225
 v_mfma_f32_16x16x32_bf16 v[204:207], a[76:79], a[104:107], v[204:207]
 ds_read2_b32 a[14:15], v217 offset0:226 offset1:227
 s_waitcnt lgkmcnt(12)
 v_mfma_f32_16x16x32_bf16 v[200:203], a[64:67], a[112:115], v[200:203]
 ds_read_b128 a[48:51], v36 offset:1920
 v_mfma_f32_16x16x32_bf16 v[204:207], a[68:71], a[112:115], v[204:207]
 ds_read2_b32 a[16:17], v218 offset0:96 offset1:97
 v_mfma_f32_16x16x32_bf16 v[208:211], a[72:75], a[112:115], v[208:211]
 ds_read2_b32 a[18:19], v218 offset0:98 offset1:99
 v_mfma_f32_16x16x32_bf16 v[212:215], a[76:79], a[112:115], v[212:215]
 v_mfma_f32_16x16x32_bf16 v[200:203], a[80:83], a[96:99], v[200:203]
 ds_read_b128 a[52:55], v36 offset:1408
 v_mfma_f32_16x16x32_bf16 v[204:207], a[80:83], a[100:103], v[204:207]
 ds_read2_b32 a[20:21], v218 offset0:224 offset1:225
 v_mfma_f32_16x16x32_bf16 v[208:211], a[80:83], a[104:107], v[208:211]
 ds_read2_b32 a[22:23], v218 offset0:226 offset1:227
 v_mfma_f32_16x16x32_bf16 v[212:215], a[80:83], a[108:111], v[212:215]
 ds_read_b128 a[56:59], v36 offset:896
 v_mfma_f32_16x16x32_bf16 v[204:207], a[64:67], a[116:119], v[204:207]
 ds_read2_b32 a[24:25], v219 offset0:96 offset1:97
 v_mfma_f32_16x16x32_bf16 v[208:211], a[68:71], a[116:119], v[208:211]
 ds_read2_b32 a[26:27], v219 offset0:98 offset1:99
 v_mfma_f32_16x16x32_bf16 v[212:215], a[72:75], a[116:119], v[212:215]
 v_mfma_f32_16x16x32_bf16 v[204:207], a[84:87], a[96:99], v[204:207]
 ds_read_b128 a[60:63], v36 offset:384
 v_mfma_f32_16x16x32_bf16 v[208:211], a[84:87], a[100:103], v[208:211]
 ds_read2_b32 a[28:29], v219 offset0:224 offset1:225
 v_mfma_f32_16x16x32_bf16 v[212:215], a[84:87], a[104:107], v[212:215]
 ds_read2_b32 a[30:31], v219 offset0:226 offset1:227
 v_mfma_f32_16x16x32_bf16 v[208:211], a[64:67], a[120:123], v[208:211]
 v_mfma_f32_16x16x32_bf16 v[212:215], a[68:71], a[120:123], v[212:215]
 v_mfma_f32_16x16x32_bf16 v[208:211], a[88:91], a[96:99], v[208:211]
 v_mfma_f32_16x16x32_bf16 v[212:215], a[88:91], a[100:103], v[212:215]
 v_mfma_f32_16x16x32_bf16 v[212:215], a[64:67], a[124:127], v[212:215]
 v_mfma_f32_16x16x32_bf16 v[212:215], a[92:95], a[96:99], v[212:215]
 s_waitcnt vmcnt(0)
 v_cmp_eq_u32_e64 vcc, v253, v7
 s_cmp_lg_u32 s93, 0
 s_cselect_b64 s[80:81], 0, -1
 s_and_b64 vcc, vcc, s[80:81]
 s_cbranch_scc0 b_noearly
 s_add_u32 m0, s84, 0
 s_nop 0
 buffer_load_dwordx4 v39, s[76:79], s91 offen sc1 lds
 s_add_u32 s91, s91, 1024
 s_add_u32 m0, s84, 1024
 s_nop 0
 buffer_load_dwordx4 v39, s[76:79], s91 offen sc1 lds
 s_add_u32 s91, s91, 1024
 s_add_u32 m0, s84, 2048
 s_nop 0
 buffer_load_dwordx4 v39, s[76:79], s91 offen sc1 lds
 s_add_u32 s91, s91, 1024
 s_add_u32 m0, s84, 3072
 s_nop 0
 buffer_load_dwordx4 v39, s[76:79], s91 offen sc1 lds
 s_add_u32 s91, s91, 1024
 s_mov_b32 s95, 1
b_noearly:
 buffer_load_dword v18, v17, s[76:79], s101 offen sc1
 s_waitcnt lgkmcnt(12)
 v_mfma_f32_16x16x32_bf16 v[184:187], a[0:3], a[32:35], v[184:187]
 v_mfma_f32_16x16x32_bf16 v[188:191], a[0:3], a[36:39], v[188:191]
 v_mfma_f32_16x16x32_bf16 v[192:195], a[4:7], a[36:39], v[192:195]
 ds_read_b128 a[96:99], v36 offset:4032
 v_mfma_f32_16x16x32_bf16 v[188:191], a[4:7], a[32:35], v[188:191]
 ds_read2_b32 a[64:65], v216 offset0:112 offset1:113
 v_mfma_f32_16x16x32_bf16 v[192:195], a[0:3], a[40:43], v[192:195]
 ds_read2_b32 a[66:67], v216 offset0:114 offset1:115
 v_mfma_f32_16x16x32_bf16 v[196:199], a[4:7], a[40:43], v[196:199]
 v_mfma_f32_16x16x32_bf16 v[200:203], a[8:11], a[40:43], v[200:203]
 ds_read_b128 a[100:103], v36 offset:3520
 v_mfma_f32_16x16x32_bf16 v[192:195], a[8:11], a[32:35], v[192:195]
 ds_read2_b32 a[68:69], v216 offset0:240 offset1:241
 v_mfma_f32_16x16x32_bf16 v[196:199], a[8:11], a[36:39], v[196:199]
 ds_read2_b32 a[70:71], v216 offset0:242 offset1:243
 v_mfma_f32_16x16x32_bf16 v[196:199], a[0:3], a[44:47], v[196:199]
 ds_read_b128 a[104:107], v36 offset:3008
 v_mfma_f32_16x16x32_bf16 v[200:203], a[4:7], a[44:47], v[200:203]
 ds_read2_b32 a[72:73], v217 offset0:112 offset1:113
 v_mfma_f32_16x16x32_bf16 v[204:207], a[8:11], a[44:47], v[204:207]
 ds_read2_b32 a[74:75], v217 offset0:114 offset1:115
 v_mfma_f32_16x16x32_bf16 v[208:211], a[12:15], a[44:47], v[208:211]
 v_mfma_f32_16x16x32_bf16 v[196:199], a[12:15], a[32:35], v[196:199]
 ds_read_b128 a[108:111], v36 offset:2496
 v_mfma_f32_16x16x32_bf16 v[200:203], a[12:15], a[36:39], v[200:203]
 ds_read2_b32 a[76:77], v217 offset0:240 offset1:241
 v_mfma_f32_16x16x32_bf16 v[204:207], a[12:15], a[40:43], v[204:207]
 ds_read2_b32 a[78:79], v217 offset0:242 offset1:243
 s_waitcnt lgkmcnt(12)
 v_mfma_f32_16x16x32_bf16 v[200:203], a[0:3], a[48:51], v[200:203]
 ds_read_b128 a[112:115], v36 offset:1984
 v_mfma_f32_16x16x32_bf16 v[204:207], a[4:7], a[48:51], v[204:207]
 ds_read2_b32 a[80:81], v218 offset0:112 offset1:113
 v_mfma_f32_16x16x32_bf16 v[208:211], a[8:11], a[48:51], v[208:211]
 ds_read2_b32 a[82:83], v218 offset0:114 offset1:115
 v_mfma_f32_16x16x32_bf16 v[212:215], a[12:15], a[48:51], v[212:215]
 v_mfma_f32_16x16x32_bf16 v[200:203], a[16:19], a[32:35], v[200:203]
 ds_read_b128 a[116:119], v36 offset:1472
 v_mfma_f32_16x16x32_bf16 v[204:207], a[16:19], a[36:39], v[204:207]
 ds_read2_b32 a[84:85], v218 offset0:240 offset1:241
 v_mfma_f32_16x16x32_bf16 v[208:211], a[16:19], a[40:43], v[208:211]
 ds_read2_b32 a[86:87], v218 offset0:242 offset1:243
 v_mfma_f32_16x16x32_bf16 v[212:215], a[16:19], a[44:47], v[212:215]
 ds_read_b128 a[120:123], v36 offset:960
 v_mfma_f32_16x16x32_bf16 v[204:207], a[0:3], a[52:55], v[204:207]
 ds_read2_b32 a[88:89], v219 offset0:112 offset1:113
 v_mfma_f32_16x16x32_bf16 v[208:211], a[4:7], a[52:55], v[208:211]
 ds_read2_b32 a[90:91], v219 offset0:114 offset1:115
 v_mfma_f32_16x16x32_bf16 v[212:215], a[8:11], a[52:55], v[212:215]
 v_mfma_f32_16x16x32_bf16 v[204:207], a[20:23], a[32:35], v[204:207]
 ds_read_b128 a[124:127], v36 offset:448
 v_mfma_f32_16x16x32_bf16 v[208:211], a[20:23], a[36:39], v[208:211]
 ds_read2_b32 a[92:93], v219 offset0:240 offset1:241
 v_mfma_f32_16x16x32_bf16 v[212:215], a[20:23], a[40:43], v[212:215]
 ds_read2_b32 a[94:95], v219 offset0:242 offset1:243
 v_mfma_f32_16x16x32_bf16 v[208:211], a[0:3], a[56:59], v[208:211]
 v_mfma_f32_16x16x32_bf16 v[212:215], a[4:7], a[56:59], v[212:215]
 v_mfma_f32_16x16x32_bf16 v[208:211], a[24:27], a[32:35], v[208:211]
 v_mfma_f32_16x16x32_bf16 v[212:215], a[24:27], a[36:39], v[212:215]
 v_mfma_f32_16x16x32_bf16 v[212:215], a[0:3], a[60:63], v[212:215]
 v_mfma_f32_16x16x32_bf16 v[212:215], a[28:31], a[32:35], v[212:215]
 s_waitcnt lgkmcnt(12)
 v_mfma_f32_16x16x32_bf16 v[184:187], a[64:67], a[96:99], v[184:187]
 v_mfma_f32_16x16x32_bf16 v[188:191], a[64:67], a[100:103], v[188:191]
 v_mfma_f32_16x16x32_bf16 v[192:195], a[68:71], a[100:103], v[192:195]
 v_mfma_f32_16x16x32_bf16 v[188:191], a[68:71], a[96:99], v[188:191]
 v_mfma_f32_16x16x32_bf16 v[192:195], a[64:67], a[104:107], v[192:195]
 v_mfma_f32_16x16x32_bf16 v[196:199], a[68:71], a[104:107], v[196:199]
 v_mfma_f32_16x16x32_bf16 v[200:203], a[72:75], a[104:107], v[200:203]
 v_mfma_f32_16x16x32_bf16 v[192:195], a[72:75], a[96:99], v[192:195]
 v_mfma_f32_16x16x32_bf16 v[196:199], a[72:75], a[100:103], v[196:199]
 v_mfma_f32_16x16x32_bf16 v[196:199], a[64:67], a[108:111], v[196:199]
 v_mfma_f32_16x16x32_bf16 v[200:203], a[68:71], a[108:111], v[200:203]
 v_mfma_f32_16x16x32_bf16 v[204:207], a[72:75], a[108:111], v[204:207]
 v_mfma_f32_16x16x32_bf16 v[208:211], a[76:79], a[108:111], v[208:211]
 v_mfma_f32_16x16x32_bf16 v[196:199], a[76:79], a[96:99], v[196:199]
 v_mfma_f32_16x16x32_bf16 v[200:203], a[76:79], a[100:103], v[200:203]
 v_mfma_f32_16x16x32_bf16 v[204:207], a[76:79], a[104:107], v[204:207]
 s_waitcnt lgkmcnt(0)
 v_mfma_f32_16x16x32_bf16 v[200:203], a[64:67], a[112:115], v[200:203]
 v_mfma_f32_16x16x32_bf16 v[204:207], a[68:71], a[112:115], v[204:207]
 v_mfma_f32_16x16x32_bf16 v[208:211], a[72:75], a[112:115], v[208:211]
 v_mfma_f32_16x16x32_bf16 v[212:215], a[76:79], a[112:115], v[212:215]
 v_mfma_f32_16x16x32_bf16 v[200:203], a[80:83], a[96:99], v[200:203]
 v_mfma_f32_16x16x32_bf16 v[204:207], a[80:83], a[100:103], v[204:207]
 v_mfma_f32_16x16x32_bf16 v[208:211], a[80:83], a[104:107], v[208:211]
 v_mfma_f32_16x16x32_bf16 v[212:215], a[80:83], a[108:111], v[212:215]
 v_mfma_f32_16x16x32_bf16 v[204:207], a[64:67], a[116:119], v[204:207]
 v_mfma_f32_16x16x32_bf16 v[208:211], a[68:71], a[116:119], v[208:211]
 v_mfma_f32_16x16x32_bf16 v[212:215], a[72:75], a[116:119], v[212:215]
 v_mfma_f32_16x16x32_bf16 v[204:207], a[84:87], a[96:99], v[204:207]
 v_mfma_f32_16x16x32_bf16 v[208:211], a[84:87], a[100:103], v[208:211]
 v_mfma_f32_16x16x32_bf16 v[212:215], a[84:87], a[104:107], v[212:215]
 v_mfma_f32_16x16x32_bf16 v[208:211], a[64:67], a[120:123], v[208:211]
 v_mfma_f32_16x16x32_bf16 v[212:215], a[68:71], a[120:123], v[212:215]
 v_mfma_f32_16x16x32_bf16 v[208:211], a[88:91], a[96:99], v[208:211]
 v_mfma_f32_16x16x32_bf16 v[212:215], a[88:91], a[100:103], v[212:215]
 v_mfma_f32_16x16x32_bf16 v[212:215], a[64:67], a[124:127], v[212:215]
 v_mfma_f32_16x16x32_bf16 v[212:215], a[92:95], a[96:99], v[212:215]
 v_cvt_pk_bf16_f32 v40, v184, v185
 v_cvt_pk_bf16_f32 v41, v186, v187
 ds_write_b64 v220, v[40:41] offset:0
 v_cvt_pk_bf16_f32 v42, v188, v189
 v_cvt_pk_bf16_f32 v43, v190, v191
 ds_write_b64 v220, v[42:43] offset:512
 v_cvt_pk_bf16_f32 v44, v192, v193
 v_cvt_pk_bf16_f32 v45, v194, v195
 ds_write_b64 v220, v[44:45] offset:1024
 v_cvt_pk_bf16_f32 v46, v196, v197
 v_cvt_pk_bf16_f32 v47, v198, v199
 ds_write_b64 v220, v[46:47] offset:1536
 v_cvt_pk_bf16_f32 v40, v200, v201
 v_cvt_pk_bf16_f32 v41, v202, v203
 ds_write_b64 v220, v[40:41] offset:2048
 v_cvt_pk_bf16_f32 v42, v204, v205
 v_cvt_pk_bf16_f32 v43, v206, v207
 ds_write_b64 v220, v[42:43] offset:2560
 v_cvt_pk_bf16_f32 v44, v208, v209
 v_cvt_pk_bf16_f32 v45, v210, v211
 ds_write_b64 v220, v[44:45] offset:3072
 v_cvt_pk_bf16_f32 v46, v212, v213
 v_cvt_pk_bf16_f32 v47, v214, v215
 ds_write_b64 v220, v[46:47] offset:3584
 s_cmp_lg_u32 s93, 0
 s_cbranch_scc1 b_fin
 s_mov_b32 s93, 1
 v_mov_b32 v12, 0x80000000
 v_add_u32 v36, s92, v36
 v_add_u32 v216, 33344, v216
 v_add_u32 v217, 33344, v217
 v_add_u32 v218, 33344, v218
 v_add_u32 v219, 33344, v219
 v_add_u32 v220, 16640, v220
 s_cmp_eq_u32 s95, 1
 s_cbranch_scc1 b_have
 s_mov_b32 s94, 400000
b_poll:
 buffer_load_dword v7, v4, s[76:79], s90 offen sc1
 s_sub_u32 s94, s94, 1
 s_waitcnt vmcnt(0)
 v_cmp_eq_u32 vcc, v253, v7
 s_cmp_eq_u32 s94, 0
 s_cbranch_scc1 b_got
 s_cmp_eq_u64 vcc, 0
 s_cbranch_scc1 b_poll
b_got:
 s_add_u32 m0, s84, 0
 s_nop 0
 buffer_load_dwordx4 v39, s[76:79], s91 offen sc1 lds
 s_add_u32 s91, s91, 1024
 s_add_u32 m0, s84, 1024
 s_nop 0
 buffer_load_dwordx4 v39, s[76:79], s91 offen sc1 lds
 s_add_u32 s91, s91, 1024
 s_add_u32 m0, s84, 2048
 s_nop 0
 buffer_load_dwordx4 v39, s[76:79], s91 offen sc1 lds
 s_add_u32 s91, s91, 1024
 s_add_u32 m0, s84, 3072
 s_nop 0
 buffer_load_dwordx4 v39, s[76:79], s91 offen sc1 lds
 s_add_u32 s91, s91, 1024
b_have:
 s_waitcnt vmcnt(0)
 buffer_store_dword v253, v15, s[76:79], s101 offen sc1
 s_add_u32 s101, s39, 40960
 s_branch b_conv
b_fin:
 s_waitcnt vmcnt(0)
 v_cmp_eq_u32_e64 vcc, v253, v18
 s_nop 1
 s_cmp_eq_u64 vcc, -1
 s_cbranch_scc1 b_pf_x
 s_mov_b32 s94, 400000
b_pf:
 buffer_load_dword v18, v17, s[76:79], s101 offen sc1
 s_sub_u32 s94, s94, 1
 s_waitcnt vmcnt(0)
 v_cmp_eq_u32 vcc, v253, v18
 s_cmp_eq_u32 s94, 0
 s_cbranch_scc1 b_pf_x
 s_cmp_eq_u64 vcc, -1
 s_cbranch_scc0 b_pf
b_pf_x:
 s_mov_b32 s94, 400000
 s_waitcnt lgkmcnt(0)
 s_barrier
 ds_read_b64_tr_b16 v[56:57], v224 offset:0
 ds_read_b64_tr_b16 v[58:59], v224 offset:16640
 ds_read_b64_tr_b16 v[60:61], v224 offset:128
 ds_read_b64_tr_b16 v[62:63], v224 offset:16768
 ds_read_b64_tr_b16 v[64:65], v224 offset:256
 ds_read_b64_tr_b16 v[66:67], v224 offset:16896
 ds_read_b64_tr_b16 v[68:69], v224 offset:384
 ds_read_b64_tr_b16 v[70:71], v224 offset:17024
 ds_read_b64_tr_b16 v[72:73], v224 offset:512
 ds_read_b64_tr_b16 v[74:75], v224 offset:17152
 ds_read_b64_tr_b16 v[76:77], v224 offset:640
 ds_read_b64_tr_b16 v[78:79], v224 offset:17280
 ds_read_b64_tr_b16 v[80:81], v224 offset:768
 ds_read_b64_tr_b16 v[82:83], v224 offset:17408
 ds_read_b64_tr_b16 v[84:85], v224 offset:896
 ds_read_b64_tr_b16 v[86:87], v224 offset:17536
 s_waitcnt lgkmcnt(14)
 buffer_store_dwordx4 v[56:59], v39, s[76:79], s6 offen offset:0 sc1
 s_waitcnt lgkmcnt(12)
 buffer_store_dwordx4 v[60:63], v39, s[76:79], s6 offen offset:1024 sc1
 s_waitcnt lgkmcnt(10)
 buffer_store_dwordx4 v[64:67], v39, s[76:79], s6 offen offset:2048 sc1
 s_waitcnt lgkmcnt(8)
 buffer_store_dwordx4 v[68:71], v39, s[76:79], s6 offen offset:3072 sc1
 s_waitcnt lgkmcnt(6)
 buffer_store_dwordx4 v[72:75], v39, s[76:79], s7 offen offset:0 sc1
 s_waitcnt lgkmcnt(4)
 s_branch pb3_skip
.p2align 12
pb3:
 s_setpc_b64 s[36:37]
 s_nop 0
pb3_skip:
 buffer_store_dwordx4 v[76:79], v39, s[76:79], s7 offen offset:1024 sc1
 s_waitcnt lgkmcnt(2)
 buffer_store_dwordx4 v[80:83], v39, s[76:79], s7 offen offset:2048 sc1
 s_waitcnt lgkmcnt(0)
 buffer_store_dwordx4 v[84:87], v39, s[76:79], s7 offen offset:3072 sc1
b_yp:
 buffer_load_dword v19, v228, s[76:79], s96 offen sc1
 s_sub_u32 s94, s94, 1
 s_waitcnt vmcnt(0)
 v_cmp_ne_u32 vcc, -1, v19
 s_cmp_lt_i32 s94, 1
 s_cbranch_scc1 b_yg
 s_cmp_eq_u64 vcc, -1
 s_cbranch_scc1 b_yg
 s_sleep 8
 s_branch b_yp
b_yg:
 s_mov_b32 s82, s96
 s_add_u32 m0, s98, 0
 s_nop 0
 buffer_load_dwordx4 v39, s[76:79], s82 offen sc1 lds
 s_add_u32 s82, s82, 32768
 s_add_u32 m0, s98, 1040
 s_nop 0
 buffer_load_dwordx4 v39, s[76:79], s82 offen sc1 lds
 s_add_u32 s82, s82, 32768
 s_add_u32 m0, s98, 2080
 s_nop 0
 buffer_load_dwordx4 v39, s[76:79], s82 offen sc1 lds
 s_add_u32 s82, s82, 32768
 s_add_u32 m0, s98, 3120
 s_nop 0
 buffer_load_dwordx4 v39, s[76:79], s82 offen sc1 lds
 s_add_u32 s82, s82, 32768
 s_add_u32 m0, s98, 4160
 s_nop 0
 buffer_load_dwordx4 v39, s[76:79], s82 offen sc1 lds
 s_add_u32 s82, s82, 32768
 s_add_u32 m0, s98, 5200
 s_nop 0
 buffer_load_dwordx4 v39, s[76:79], s82 offen sc1 lds
 s_add_u32 s82, s82, 32768
 s_add_u32 m0, s98, 6240
 s_nop 0
 buffer_load_dwordx4 v39, s[76:79], s82 offen sc1 lds
 s_add_u32 s82, s82, 32768
 s_add_u32 m0, s98, 7280
 s_nop 0
 buffer_load_dwordx4 v39, s[76:79], s82 offen sc1 lds
 s_add_u32 s82, s82, 32768
 v_mov_b32 v18, 0
 s_waitcnt vmcnt(0)
 ds_read_b128 v[56:59], v229 offset:0
 ds_read_b128 v[60:63], v229 offset:128
 ds_read_b128 v[64:67], v229 offset:256
 ds_read_b128 v[68:71], v229 offset:384
 ds_read_b128 v[72:75], v229 offset:512
 ds_read_b128 v[76:79], v229 offset:640
 ds_read_b128 v[80:83], v229 offset:768
 ds_read_b128 v[84:87], v229 offset:896
 s_waitcnt lgkmcnt(7)
 v_max3_u32 v18, v18, v56, v57
 v_max3_u32 v18, v18, v58, v59
 s_waitcnt lgkmcnt(6)
 v_max3_u32 v18, v18, v60, v61
 v_max3_u32 v18, v18, v62, v63
 s_waitcnt lgkmcnt(5)
 v_max3_u32 v18, v18, v64, v65
 v_max3_u32 v18, v18, v66, v67
 s_waitcnt lgkmcnt(4)
 v_max3_u32 v18, v18, v68, v69
 v_max3_u32 v18, v18, v70, v71
 s_waitcnt lgkmcnt(3)
 v_max3_u32 v18, v18, v72, v73
 v_max3_u32 v18, v18, v74, v75
 s_waitcnt lgkmcnt(2)
 v_max3_u32 v18, v18, v76, v77
 v_max3_u32 v18, v18, v78, v79
 s_waitcnt lgkmcnt(1)
 v_max3_u32 v18, v18, v80, v81
 v_max3_u32 v18, v18, v82, v83
 s_waitcnt lgkmcnt(0)
 v_max3_u32 v18, v18, v84, v85
 v_max3_u32 v18, v18, v86, v87
 v_cmp_eq_u32 vcc, -1, v18
 s_cmp_lt_i32 s94, 1
 s_cbranch_scc1 b_yo
 s_cmp_lg_u64 vcc, 0
 s_cbranch_scc1 b_yp
b_yo:
 buffer_store_dwordx4 v[56:59], v230, s[72:75], s97 offen sc1
 s_add_u32 s97, s97, 20480
 buffer_store_dwordx4 v[60:63], v230, s[72:75], s97 offen sc1
 s_add_u32 s97, s97, 20480
 buffer_store_dwordx4 v[64:67], v230, s[72:75], s97 offen sc1
 s_add_u32 s97, s97, 20480
 buffer_store_dwordx4 v[68:71], v230, s[72:75], s97 offen sc1
 s_add_u32 s97, s97, 20480
 buffer_store_dwordx4 v[72:75], v230, s[72:75], s97 offen sc1
 s_add_u32 s97, s97, 20480
 buffer_store_dwordx4 v[76:79], v230, s[72:75], s97 offen sc1
 s_add_u32 s97, s97, 20480
 buffer_store_dwordx4 v[80:83], v230, s[72:75], s97 offen sc1
 s_add_u32 s97, s97, 20480
 buffer_store_dwordx4 v[84:87], v230, s[72:75], s97 offen sc1
 s_add_u32 s97, s97, 20480
 s_endpgm
roleS:
 s_getpc_b64 s[40:41]
cpf_here:
 s_sub_u32 s40, s40, cpf_here-concat_heads__linear_kernel_hedgehog__ssm_conv_s4d__prompt_kernel
 s_subb_u32 s41, s41, 0
 s_lshr_b32 s42, s2, 3
 s_and_b32 s42, s42, 1
 s_lshl_b32 s42, s42, 15
 v_lshlrev_b32 v8, 7, v0
 v_add_u32_e64 v8, s42, v8
 v_cmp_gt_u32 vcc, code_end-concat_heads__linear_kernel_hedgehog__ssm_conv_s4d__prompt_kernel, v8
 s_nop 1
 v_cndmask_b32 v8, 0, v8, vcc
 global_load_dword v254, v8, s[40:41]
 s_sub_u32 s69, s2, 208
 v_and_b32 v1, 63, v0
 v_and_b32 v2, 15, v0
 v_bfe_u32 v3, v0, 4, 2
 v_mov_b32 v4, 0
 v_lshlrev_b32_e64 v5, 2, v1
 s_waitcnt lgkmcnt(0)
 s_mov_b32 s44, s18
 s_mov_b32 s45, s19
 s_mov_b32 s46, 163840
 s_mov_b32 s47, 0x20000
 s_mov_b32 s48, s20
 s_mov_b32 s49, s21
 s_mov_b32 s50, 163840
 s_mov_b32 s51, 0x20000
 s_mov_b32 s52, s22
 s_mov_b32 s53, s23
 s_mov_b32 s54, 163840
 s_mov_b32 s55, 0x20000
 s_mov_b32 s56, s24
 s_mov_b32 s57, s25
 s_mov_b32 s58, 163840
 s_mov_b32 s59, 0x20000
 s_mov_b32 s60, s26
 s_mov_b32 s61, s27
 s_mov_b32 s62, 1280
 s_mov_b32 s63, 0x20000
 s_mov_b32 s64, s28
 s_mov_b32 s65, s29
 s_mov_b32 s66, 1280
 s_mov_b32 s67, 0x20000
 s_lshl_b32 s90, s69, 2
 s_add_u32 s90, s90, s68
 s_lshl_b32 s71, s69, 3
 s_add_u32 s71, s71, s68
 s_add_u32 s71, s71, 4
 s_lshl_b32 s81, s71, 8
 s_lshl_b32 s80, s71, 1
 buffer_load_ushort v12, v4, s[60:63], s80 offen
 buffer_load_dword v8, v5, s[44:47], s81 offen nt
 buffer_load_dword v9, v5, s[48:51], s81 offen nt
 buffer_load_dword v10, v5, s[52:55], s81 offen nt
 buffer_load_dword v11, v5, s[56:59], s81 offen nt
 buffer_load_ushort v13, v4, s[64:67], s80 offen
 s_add_u32 s71, s71, 384
 s_min_u32 s71, s71, 639
 s_lshl_b32 s81, s71, 8
 s_lshl_b32 s80, s71, 1
 buffer_load_ushort v18, v4, s[60:63], s80 offen
 buffer_load_dword v14, v5, s[44:47], s81 offen nt
 buffer_load_dword v15, v5, s[48:51], s81 offen nt
 buffer_load_dword v16, v5, s[52:55], s81 offen nt
 buffer_load_dword v17, v5, s[56:59], s81 offen nt
 buffer_load_ushort v19, v4, s[64:67], s80 offen
 s_mov_b32 s40, s34
 s_mov_b32 s41, s35
 s_mov_b32 s42, 131072
 s_mov_b32 s43, 0x20000
 s_mov_b32 s72, s32
 s_mov_b32 s73, s33
 s_mov_b32 s74, 256
 s_mov_b32 s75, 0x20000
 s_mov_b32 s76, s34
 s_mov_b32 s77, s35
 s_mov_b32 s78, 13631488
 s_mov_b32 s79, 0x20000
 s_mov_b32 s4, 385024
 buffer_load_dword v253, v4, s[76:79], s4 offen sc1
 s_lshl_b32 s70, s69, 12
 v_lshlrev_b32 v6, 4, v0
 v_mov_b32 v20, 0
 v_mov_b32 v21, 0
 v_mov_b32 v22, 0
 v_mov_b32_e64 v23, 0
 buffer_store_dwordx4 v[20:23], v6, s[40:43], s70 offen sc1
 s_mov_b32 s96, s16
 s_mov_b32 s97, s17
 s_mov_b32 s98, 2621440
 s_mov_b32 s99, 0x20000
 v_lshrrev_b32_e64 v240, 3, v1
 v_mul_u32_u24 v240, 1280, v240
 v_and_b32 v241, 7, v0
 v_xor_b32 v241, v241, v3
 v_lshl_add_u32 v240, v241, 4, v240
 v_xor_b32_e64 v241, 64, v240
 v_add_u32 v241, 10240, v241
 s_lshl_b32 s5, s68, 14
 s_lshr_b32 s93, s2, 3
 s_sub_u32 s93, s93, 16
 s_and_b32 s94, s2, 6
 s_lshl_b32 s94, s94, 1
 s_and_b32 s92, s2, 1
 s_lshl_b32 s92, s92, 2
 s_and_b32 s4, s93, 3
 s_add_u32 s92, s92, s4
 s_lshr_b32 s93, s93, 2
 s_add_u32 s94, s94, s93
 s_add_u32 s93, s94, s92
 s_mul_i32 s93, s93, 3
 s_mul_i32 s92, s92, 160
 s_lshr_b32 s95, s68, 1
 s_add_u32 s95, s95, 1
 s_mul_i32 s95, s95, 1280
 s_add_u32 s92, s92, s95
 s_andn2_b32 s92, s92, 127
 s_and_b32 s95, s68, 1
 s_lshl_b32 s95, s95, 7
 s_add_u32 s92, s92, s95
 v_mul_u32_u24 v250, 3840, v1
 v_mul_u32_u24 v249, 1280, v1
 s_lshl_b32 s94, s94, 1
 s_and_b32 s95, s68, 1
 s_add_u32 s94, s94, s95
 s_mul_i32 s94, s94, 81920
 s_mov_b32 s96, s10
 s_mov_b32 s97, s11
 s_mov_b32 s98, 2457600
 s_mov_b32 s99, 0x20000
 s_add_u32 s100, s93, 1
 s_mul_i32 s95, s100, 205
 s_lshr_b32 s95, s95, 11
 s_mul_i32 s95, s95, 10
 s_sub_u32 s100, s100, s95
 s_mul_i32 s100, s100, 245760
 s_add_u32 s100, s100, s92
 buffer_load_dword v254, v250, s[96:99], s100 offen
 s_mov_b32 s96, s8
 s_mov_b32 s97, s9
 s_mov_b32 s98, 2621440
 s_mov_b32 s99, 0x20000
 s_lshr_b32 s100, s68, 1
 s_add_u32 s100, s100, s93
 s_add_u32 s100, s100, 1
 s_mul_i32 s95, s100, 205
 s_lshr_b32 s95, s95, 11
 s_mul_i32 s95, s95, 10
 s_sub_u32 s100, s100, s95
 s_lshl_b32 s100, s100, 7
 s_add_u32 s100, s100, s94
 buffer_load_dword v254, v249, s[96:99], s100 offen
 s_mov_b32 s96, s10
 s_mov_b32 s97, s11
 s_mov_b32 s98, 2457600
 s_mov_b32 s99, 0x20000
 s_add_u32 s100, s93, 2
 s_mul_i32 s95, s100, 205
 s_lshr_b32 s95, s95, 11
 s_mul_i32 s95, s95, 10
 s_sub_u32 s100, s100, s95
 s_mul_i32 s100, s100, 245760
 s_add_u32 s100, s100, s92
 buffer_load_dword v254, v250, s[96:99], s100 offen
 s_mov_b32 s96, s10
 s_mov_b32 s97, s11
 s_mov_b32 s98, 2457600
 s_mov_b32 s99, 0x20000
 s_add_u32 s100, s93, 3
 s_mul_i32 s95, s100, 205
 s_lshr_b32 s95, s95, 11
 s_mul_i32 s95, s95, 10
 s_sub_u32 s100, s100, s95
 s_mul_i32 s100, s100, 245760
 s_add_u32 s100, s100, s92
 buffer_load_dword v254, v250, s[96:99], s100 offen
 s_mov_b32 s96, s8
 s_mov_b32 s97, s9
 s_mov_b32 s98, 2621440
 s_mov_b32 s99, 0x20000
 s_lshr_b32 s100, s68, 1
 s_add_u32 s100, s100, s93
 s_add_u32 s100, s100, 3
 s_mul_i32 s95, s100, 205
 s_lshr_b32 s95, s95, 11
 s_mul_i32 s95, s95, 10
 s_sub_u32 s100, s100, s95
 s_lshl_b32 s100, s100, 7
 s_add_u32 s100, s100, s94
 buffer_load_dword v254, v249, s[96:99], s100 offen
 s_cmp_lt_u32 s69, 32
 s_cselect_b32 s4, 0, -1
 v_cmp_eq_u32 vcc, s4, v0
 v_mov_b32_e64 v7, 1
 v_mov_b32 v38, 0x80000000
 v_cndmask_b32_e64 v39, v38, v4, vcc
 s_mul_i32 s83, s68, 4608
 s_add_u32 s83, s83, 81920
 s_mul_i32 s84, s68, 8704
 s_add_u32 s84, s84, 100352
 v_lshl_add_u32 v24, v1, 3, s84
 v_mul_u32_u24 v25, 544, v2
 v_lshl_add_u32 v25, v3, 4, v25
 v_add_u32 v25, s84, v25
 v_cmp_gt_u32 vcc, 2, v3
 v_lshrrev_b32 v40, 1, v3
 v_and_b32 v41, 1, v3
 v_lshlrev_b32_e64 v26, 9, v40
 v_lshl_add_u32 v26, v41, 4, v26
 v_lshl_add_u32 v26, v2, 5, v26
 v_add_u32 v26, s84, v26
 v_lshlrev_b32 v42, 4, v2
 v_lshlrev_b32 v43, 3, v2
 v_cndmask_b32 v42, v43, v42, vcc
 v_lshl_add_u32 v27, v3, 8, v42
 v_add_u32_e64 v27, s84, v27
 v_mov_b32 v42, 128
 v_mov_b32 v43, 8
 v_cndmask_b32 v42, v42, v43, vcc
 v_add_u32 v28, v27, v42
 v_lshlrev_b32 v29, 8, v3
 v_lshl_add_u32 v29, v2, 2, v29
 v_add_u32_e64 v29, s84, v29
 v_lshl_add_u32 v30, v1, 2, s84
 v_lshl_add_u32 v31, v1, 3, s84
 v_and_b32_e64 v40, 31, v0
 v_lshl_add_u32 v32, v40, 4, s84
 v_lshl_add_u32 v33, v40, 5, s84
 v_lshlrev_b32 v41, 4, v1
 v_sub_u32 v34, s83, v41
 v_add_u32 v34, 1008, v34
 v_lshlrev_b32 v41, 4, v40
 v_sub_u32 v35, s83, v41
 v_add_u32 v35, 496, v35
 v_and_b32 v40, 1, v0
 v_cmp_eq_u32 vcc, 1, v40
 v_mov_b32 v41, 0xffff
 v_mov_b32 v42, -1
 v_cndmask_b32 v37, v41, v42, vcc
 s_mov_b32 s85, 0xffff
 s_mov_b32 s86, 0x3fb8aa3b
 s_mov_b32 s87, 0x32a57060
 s_mov_b32 s88, 0x3f317218
 s_mov_b32 s89, 0xffff0000
 v_cmp_eq_u32 vcc, 0, v1
 v_lshlrev_b32 v184, 4, v1
 v_add_u32 v185, s83, v184
 v_cndmask_b32 v38, v38, v4, vcc
 v_bfe_u32 v242, v0, 1, 3
 v_lshlrev_b32_e64 v242, 4, v242
 v_lshl_add_u32 v242, v1, 7, v242
 v_add_u32_e64 v242, s5, v242
 s_waitcnt vmcnt(5)
 s_barrier
 buffer_atomic_add v7, v39, s[72:75], 0 offen sc1
 s_mov_b32 s4, 0x9e3779b1
 v_mul_lo_u32 v253, v253, s4
 v_add_u32 v253, 0x7f4a7c15, v253
 s_mov_b32 s6, 1073741824
 s_mov_b32 s7, 1073741824
s_kloop:
 v_lshlrev_b32 v46, 16, v12
 v_mul_f32 v40, s86, v46
 v_fma_f32 v41, v46, s86, -v40
 v_exp_f32_e64 v40, v40
 v_fma_f32 v41, v46, s87, v41
 v_mul_f32_e64 v41, s88, v41
 v_fma_f32 v40, v40, v41, v40
 v_cvt_pk_bf16_f32 v40, v40, v40
 v_and_b32 v47, s89, v40
 v_add_f32 v44, v47, v47
 v_lshlrev_b32 v46, 16, v8
 v_mul_f32 v40, s86, v46
 v_fma_f32 v41, v46, s86, -v40
 v_exp_f32_e64 v40, v40
 v_fma_f32 v41, v46, s87, v41
 v_mul_f32_e64 v41, s88, v41
 v_fma_f32 v40, v40, v41, v40
 v_cvt_pk_bf16_f32 v40, v40, v40
 v_and_b32 v45, s89, v40
 v_mul_f32 v45, v45, v47
 v_mul_f32 v92, s86, v45
 v_lshlrev_b32 v46, 16, v9
 v_mul_f32 v46, v46, v47
 v_mul_f32 v94, 0.15915494, v46
 v_lshlrev_b32 v45, 16, v10
 v_lshlrev_b32 v46, 16, v11
 v_mul_f32 v84, v45, v44
 v_mul_f32 v85, v46, v44
 v_and_b32 v46, s89, v8
 v_mul_f32 v40, s86, v46
 v_fma_f32 v41, v46, s86, -v40
 v_exp_f32_e64 v40, v40
 v_fma_f32 v41, v46, s87, v41
 v_mul_f32_e64 v41, s88, v41
 v_fma_f32 v40, v40, v41, v40
 v_cvt_pk_bf16_f32 v40, v40, v40
 v_and_b32 v45, s89, v40
 v_mul_f32 v45, v45, v47
 v_mul_f32 v93, s86, v45
 v_and_b32 v46, s89, v9
 v_mul_f32 v46, v46, v47
 v_mul_f32 v95, 0.15915494, v46
 v_and_b32 v45, s89, v10
 v_and_b32 v46, s89, v11
 v_mul_f32 v86, v45, v44
 v_mul_f32 v87, v46, v44
 v_mul_f32 v40, 0xc1000000, v92
 v_mul_f32 v41, 0x41000000, v94
 v_mul_f32 v42, 0xc1000000, v93
 v_mul_f32 v43, 0x41000000, v95
 v_exp_f32 v40, v40
 v_fract_f32 v41, v41
 v_exp_f32 v42, v42
 v_fract_f32 v43, v43
 v_cos_f32 v76, v41
 v_sin_f32 v77, v41
 v_cos_f32 v78, v43
 v_sin_f32 v79, v43
 v_pk_mul_f32 v[76:77], v[76:77], v[40:41] op_sel_hi:[1,0]
 v_pk_mul_f32 v[78:79], v[78:79], v[42:43] op_sel_hi:[1,0]
 v_mul_f32 v40, 0xbf800000, v92
 v_mul_f32 v41, 0x3f800000, v94
 v_mul_f32 v42, 0xbf800000, v93
 v_mul_f32 v43, 0x3f800000, v95
 v_exp_f32 v40, v40
 v_fract_f32 v41, v41
 v_exp_f32 v42, v42
 v_fract_f32 v43, v43
 v_cos_f32 v48, v41
 v_sin_f32 v49, v41
 v_cos_f32 v50, v43
 v_sin_f32 v51, v43
 v_pk_mul_f32 v[48:49], v[48:49], v[40:41] op_sel_hi:[1,0]
 v_pk_mul_f32 v[50:51], v[50:51], v[42:43] op_sel_hi:[1,0]
 v_mul_f32 v40, 0xc3000000, v92
 v_mul_f32 v41, 0x43000000, v94
 v_mul_f32 v42, 0xc3000000, v93
 v_mul_f32 v43, 0x43000000, v95
 v_exp_f32 v40, v40
 v_fract_f32 v41, v41
 v_exp_f32 v42, v42
 v_fract_f32 v43, v43
 v_cos_f32 v80, v41
 v_sin_f32 v81, v41
 v_cos_f32 v82, v43
 v_sin_f32 v83, v43
 v_pk_mul_f32 v[80:81], v[80:81], v[40:41] op_sel_hi:[1,0]
 v_pk_mul_f32 v[82:83], v[82:83], v[42:43] op_sel_hi:[1,0]
 v_mov_b32 v106, 0x3f80
 v_mov_b32 v107, 0x3f80
 ds_write_b64 v24, v[106:107]
 v_cvt_pk_bf16_f32 v100, v76, -v77
 v_cvt_pk_bf16_f32 v101, v78, -v79
 ds_write_b64 v24, v[100:101] offset:544
 v_pk_mul_f32 v[92:93], v[76:77], v[76:77] op_sel:[0,0] op_sel_hi:[0,1]
 v_pk_fma_f32 v[92:93], v[76:77], v[76:77], v[92:93] op_sel:[1,1,0] op_sel_hi:[1,0,1] neg_lo:[0,1,0]
 v_pk_mul_f32 v[94:95], v[78:79], v[78:79] op_sel:[0,0] op_sel_hi:[0,1]
 v_pk_fma_f32 v[94:95], v[78:79], v[78:79], v[94:95] op_sel:[1,1,0] op_sel_hi:[1,0,1] neg_lo:[0,1,0]
 v_cvt_pk_bf16_f32 v102, v92, -v93
 v_cvt_pk_bf16_f32 v103, v94, -v95
 ds_write_b64 v24, v[102:103] offset:1088
 v_pk_mul_f32 v[96:97], v[92:93], v[76:77] op_sel:[0,0] op_sel_hi:[0,1]
 v_pk_fma_f32 v[96:97], v[92:93], v[76:77], v[96:97] op_sel:[1,1,0] op_sel_hi:[1,0,1] neg_lo:[0,1,0]
 v_pk_mul_f32 v[98:99], v[94:95], v[78:79] op_sel:[0,0] op_sel_hi:[0,1]
 v_pk_fma_f32 v[98:99], v[94:95], v[78:79], v[98:99] op_sel:[1,1,0] op_sel_hi:[1,0,1] neg_lo:[0,1,0]
 v_cvt_pk_bf16_f32 v104, v96, -v97
 v_cvt_pk_bf16_f32 v105, v98, -v99
 ds_write_b64 v24, v[104:105] offset:1632
 v_pk_mul_f32 v[92:93], v[96:97], v[76:77] op_sel:[0,0] op_sel_hi:[0,1]
 v_pk_fma_f32 v[92:93], v[96:97], v[76:77], v[92:93] op_sel:[1,1,0] op_sel_hi:[1,0,1] neg_lo:[0,1,0]
 v_pk_mul_f32 v[94:95], v[98:99], v[78:79] op_sel:[0,0] op_sel_hi:[0,1]
 v_pk_fma_f32 v[94:95], v[98:99], v[78:79], v[94:95] op_sel:[1,1,0] op_sel_hi:[1,0,1] neg_lo:[0,1,0]
 v_cvt_pk_bf16_f32 v106, v92, -v93
 v_cvt_pk_bf16_f32 v107, v94, -v95
 ds_write_b64 v24, v[106:107] offset:2176
 v_pk_mul_f32 v[96:97], v[92:93], v[76:77] op_sel:[0,0] op_sel_hi:[0,1]
 v_pk_fma_f32 v[96:97], v[92:93], v[76:77], v[96:97] op_sel:[1,1,0] op_sel_hi:[1,0,1] neg_lo:[0,1,0]
 v_pk_mul_f32 v[98:99], v[94:95], v[78:79] op_sel:[0,0] op_sel_hi:[0,1]
 v_pk_fma_f32 v[98:99], v[94:95], v[78:79], v[98:99] op_sel:[1,1,0] op_sel_hi:[1,0,1] neg_lo:[0,1,0]
 v_cvt_pk_bf16_f32 v100, v96, -v97
 v_cvt_pk_bf16_f32 v101, v98, -v99
 ds_write_b64 v24, v[100:101] offset:2720
 v_pk_mul_f32 v[92:93], v[96:97], v[76:77] op_sel:[0,0] op_sel_hi:[0,1]
 v_pk_fma_f32 v[92:93], v[96:97], v[76:77], v[92:93] op_sel:[1,1,0] op_sel_hi:[1,0,1] neg_lo:[0,1,0]
 v_pk_mul_f32 v[94:95], v[98:99], v[78:79] op_sel:[0,0] op_sel_hi:[0,1]
 v_pk_fma_f32 v[94:95], v[98:99], v[78:79], v[94:95] op_sel:[1,1,0] op_sel_hi:[1,0,1] neg_lo:[0,1,0]
 v_cvt_pk_bf16_f32 v102, v92, -v93
 v_cvt_pk_bf16_f32 v103, v94, -v95
 ds_write_b64 v24, v[102:103] offset:3264
 v_pk_mul_f32 v[96:97], v[92:93], v[76:77] op_sel:[0,0] op_sel_hi:[0,1]
 v_pk_fma_f32 v[96:97], v[92:93], v[76:77], v[96:97] op_sel:[1,1,0] op_sel_hi:[1,0,1] neg_lo:[0,1,0]
 v_pk_mul_f32 v[98:99], v[94:95], v[78:79] op_sel:[0,0] op_sel_hi:[0,1]
 v_pk_fma_f32 v[98:99], v[94:95], v[78:79], v[98:99] op_sel:[1,1,0] op_sel_hi:[1,0,1] neg_lo:[0,1,0]
 v_cvt_pk_bf16_f32 v104, v96, -v97
 v_cvt_pk_bf16_f32 v105, v98, -v99
 ds_write_b64 v24, v[104:105] offset:3808
 v_pk_mul_f32 v[92:93], v[96:97], v[76:77] op_sel:[0,0] op_sel_hi:[0,1]
 v_pk_fma_f32 v[92:93], v[96:97], v[76:77], v[92:93] op_sel:[1,1,0] op_sel_hi:[1,0,1] neg_lo:[0,1,0]
 v_pk_mul_f32 v[94:95], v[98:99], v[78:79] op_sel:[0,0] op_sel_hi:[0,1]
 v_pk_fma_f32 v[94:95], v[98:99], v[78:79], v[94:95] op_sel:[1,1,0] op_sel_hi:[1,0,1] neg_lo:[0,1,0]
 v_cvt_pk_bf16_f32 v106, v92, -v93
 v_cvt_pk_bf16_f32 v107, v94, -v95
 ds_write_b64 v24, v[106:107] offset:4352
 v_pk_mul_f32 v[96:97], v[92:93], v[76:77] op_sel:[0,0] op_sel_hi:[0,1]
 v_pk_fma_f32 v[96:97], v[92:93], v[76:77], v[96:97] op_sel:[1,1,0] op_sel_hi:[1,0,1] neg_lo:[0,1,0]
 v_pk_mul_f32 v[98:99], v[94:95], v[78:79] op_sel:[0,0] op_sel_hi:[0,1]
 v_pk_fma_f32 v[98:99], v[94:95], v[78:79], v[98:99] op_sel:[1,1,0] op_sel_hi:[1,0,1] neg_lo:[0,1,0]
 v_cvt_pk_bf16_f32 v100, v96, -v97
 v_cvt_pk_bf16_f32 v101, v98, -v99
 ds_write_b64 v24, v[100:101] offset:4896
 v_pk_mul_f32 v[92:93], v[96:97], v[76:77] op_sel:[0,0] op_sel_hi:[0,1]
 v_pk_fma_f32 v[92:93], v[96:97], v[76:77], v[92:93] op_sel:[1,1,0] op_sel_hi:[1,0,1] neg_lo:[0,1,0]
 v_pk_mul_f32 v[94:95], v[98:99], v[78:79] op_sel:[0,0] op_sel_hi:[0,1]
 v_pk_fma_f32 v[94:95], v[98:99], v[78:79], v[94:95] op_sel:[1,1,0] op_sel_hi:[1,0,1] neg_lo:[0,1,0]
 v_cvt_pk_bf16_f32 v102, v92, -v93
 v_cvt_pk_bf16_f32 v103, v94, -v95
 ds_write_b64 v24, v[102:103] offset:5440
 v_pk_mul_f32 v[96:97], v[92:93], v[76:77] op_sel:[0,0] op_sel_hi:[0,1]
 v_pk_fma_f32 v[96:97], v[92:93], v[76:77], v[96:97] op_sel:[1,1,0] op_sel_hi:[1,0,1] neg_lo:[0,1,0]
 v_pk_mul_f32 v[98:99], v[94:95], v[78:79] op_sel:[0,0] op_sel_hi:[0,1]
 v_pk_fma_f32 v[98:99], v[94:95], v[78:79], v[98:99] op_sel:[1,1,0] op_sel_hi:[1,0,1] neg_lo:[0,1,0]
 v_cvt_pk_bf16_f32 v104, v96, -v97
 v_cvt_pk_bf16_f32 v105, v98, -v99
 ds_write_b64 v24, v[104:105] offset:5984
 v_pk_mul_f32 v[92:93], v[96:97], v[76:77] op_sel:[0,0] op_sel_hi:[0,1]
 v_pk_fma_f32 v[92:93], v[96:97], v[76:77], v[92:93] op_sel:[1,1,0] op_sel_hi:[1,0,1] neg_lo:[0,1,0]
 v_pk_mul_f32 v[94:95], v[98:99], v[78:79] op_sel:[0,0] op_sel_hi:[0,1]
 v_pk_fma_f32 v[94:95], v[98:99], v[78:79], v[94:95] op_sel:[1,1,0] op_sel_hi:[1,0,1] neg_lo:[0,1,0]
 v_cvt_pk_bf16_f32 v106, v92, -v93
 v_cvt_pk_bf16_f32 v107, v94, -v95
 ds_write_b64 v24, v[106:107] offset:6528
 v_pk_mul_f32 v[96:97], v[92:93], v[76:77] op_sel:[0,0] op_sel_hi:[0,1]
 v_pk_fma_f32 v[96:97], v[92:93], v[76:77], v[96:97] op_sel:[1,1,0] op_sel_hi:[1,0,1] neg_lo:[0,1,0]
 v_pk_mul_f32 v[98:99], v[94:95], v[78:79] op_sel:[0,0] op_sel_hi:[0,1]
 v_pk_fma_f32 v[98:99], v[94:95], v[78:79], v[98:99] op_sel:[1,1,0] op_sel_hi:[1,0,1] neg_lo:[0,1,0]
 v_cvt_pk_bf16_f32 v100, v96, -v97
 v_cvt_pk_bf16_f32 v101, v98, -v99
 ds_write_b64 v24, v[100:101] offset:7072
 v_pk_mul_f32 v[92:93], v[96:97], v[76:77] op_sel:[0,0] op_sel_hi:[0,1]
 v_pk_fma_f32 v[92:93], v[96:97], v[76:77], v[92:93] op_sel:[1,1,0] op_sel_hi:[1,0,1] neg_lo:[0,1,0]
 v_pk_mul_f32 v[94:95], v[98:99], v[78:79] op_sel:[0,0] op_sel_hi:[0,1]
 v_pk_fma_f32 v[94:95], v[98:99], v[78:79], v[94:95] op_sel:[1,1,0] op_sel_hi:[1,0,1] neg_lo:[0,1,0]
 v_cvt_pk_bf16_f32 v102, v92, -v93
 v_cvt_pk_bf16_f32 v103, v94, -v95
 ds_write_b64 v24, v[102:103] offset:7616
 v_pk_mul_f32 v[96:97], v[92:93], v[76:77] op_sel:[0,0] op_sel_hi:[0,1]
 v_pk_fma_f32 v[96:97], v[92:93], v[76:77], v[96:97] op_sel:[1,1,0] op_sel_hi:[1,0,1] neg_lo:[0,1,0]
 v_pk_mul_f32 v[98:99], v[94:95], v[78:79] op_sel:[0,0] op_sel_hi:[0,1]
 v_pk_fma_f32 v[98:99], v[94:95], v[78:79], v[98:99] op_sel:[1,1,0] op_sel_hi:[1,0,1] neg_lo:[0,1,0]
 v_cvt_pk_bf16_f32 v104, v96, -v97
 v_cvt_pk_bf16_f32 v105, v98, -v99
 ds_write_b64 v24, v[104:105] offset:8160
 ds_read_b128 v[108:111], v25 offset:0
 ds_read_b128 v[112:115], v25 offset:64
 ds_read_b128 v[116:119], v25 offset:128
 ds_read_b128 v[120:123], v25 offset:192
 ds_read_b128 v[124:127], v25 offset:256
 ds_read_b128 v[128:131], v25 offset:320
 ds_read_b128 v[132:135], v25 offset:384
 ds_read_b128 v[136:139], v25 offset:448
 v_pk_mul_f32 v[52:53], v[48:49], v[48:49] op_sel:[0,0] op_sel_hi:[0,1]
 v_pk_fma_f32 v[52:53], v[48:49], v[48:49], v[52:53] op_sel:[1,1,0] op_sel_hi:[1,0,1] neg_lo:[0,1,0]
 v_pk_mul_f32 v[54:55], v[50:51], v[50:51] op_sel:[0,0] op_sel_hi:[0,1]
 v_pk_fma_f32 v[54:55], v[50:51], v[50:51], v[54:55] op_sel:[1,1,0] op_sel_hi:[1,0,1] neg_lo:[0,1,0]
 v_pk_mul_f32 v[56:57], v[52:53], v[48:49] op_sel:[0,0] op_sel_hi:[0,1]
 v_pk_fma_f32 v[56:57], v[52:53], v[48:49], v[56:57] op_sel:[1,1,0] op_sel_hi:[1,0,1] neg_lo:[0,1,0]
 v_pk_mul_f32 v[58:59], v[54:55], v[50:51] op_sel:[0,0] op_sel_hi:[0,1]
 v_pk_fma_f32 v[58:59], v[54:55], v[50:51], v[58:59] op_sel:[1,1,0] op_sel_hi:[1,0,1] neg_lo:[0,1,0]
 v_pk_mul_f32 v[60:61], v[56:57], v[48:49] op_sel:[0,0] op_sel_hi:[0,1]
 v_pk_fma_f32 v[60:61], v[56:57], v[48:49], v[60:61] op_sel:[1,1,0] op_sel_hi:[1,0,1] neg_lo:[0,1,0]
 v_pk_mul_f32 v[62:63], v[58:59], v[50:51] op_sel:[0,0] op_sel_hi:[0,1]
 v_pk_fma_f32 v[62:63], v[58:59], v[50:51], v[62:63] op_sel:[1,1,0] op_sel_hi:[1,0,1] neg_lo:[0,1,0]
 v_pk_mul_f32 v[64:65], v[60:61], v[48:49] op_sel:[0,0] op_sel_hi:[0,1]
 v_pk_fma_f32 v[64:65], v[60:61], v[48:49], v[64:65] op_sel:[1,1,0] op_sel_hi:[1,0,1] neg_lo:[0,1,0]
 v_pk_mul_f32 v[66:67], v[62:63], v[50:51] op_sel:[0,0] op_sel_hi:[0,1]
 v_pk_fma_f32 v[66:67], v[62:63], v[50:51], v[66:67] op_sel:[1,1,0] op_sel_hi:[1,0,1] neg_lo:[0,1,0]
 v_pk_mul_f32 v[68:69], v[64:65], v[48:49] op_sel:[0,0] op_sel_hi:[0,1]
 v_pk_fma_f32 v[68:69], v[64:65], v[48:49], v[68:69] op_sel:[1,1,0] op_sel_hi:[1,0,1] neg_lo:[0,1,0]
 v_pk_mul_f32 v[70:71], v[66:67], v[50:51] op_sel:[0,0] op_sel_hi:[0,1]
 v_pk_fma_f32 v[70:71], v[66:67], v[50:51], v[70:71] op_sel:[1,1,0] op_sel_hi:[1,0,1] neg_lo:[0,1,0]
 v_pk_mul_f32 v[72:73], v[68:69], v[48:49] op_sel:[0,0] op_sel_hi:[0,1]
 v_pk_fma_f32 v[72:73], v[68:69], v[48:49], v[72:73] op_sel:[1,1,0] op_sel_hi:[1,0,1] neg_lo:[0,1,0]
 v_pk_mul_f32 v[74:75], v[70:71], v[50:51] op_sel:[0,0] op_sel_hi:[0,1]
 v_pk_fma_f32 v[74:75], v[70:71], v[50:51], v[74:75] op_sel:[1,1,0] op_sel_hi:[1,0,1] neg_lo:[0,1,0]
 v_cvt_pk_bf16_f32 v106, v84, v85
 v_cvt_pk_bf16_f32 v107, v86, v87
 ds_write_b64 v24, v[106:107] offset:0
 v_pk_mul_f32 v[96:97], v[84:85], v[48:49] op_sel:[0,0] op_sel_hi:[0,1]
 v_pk_fma_f32 v[96:97], v[84:85], v[48:49], v[96:97] op_sel:[1,1,0] op_sel_hi:[1,0,1] neg_lo:[0,1,0]
 v_pk_mul_f32 v[98:99], v[86:87], v[50:51] op_sel:[0,0] op_sel_hi:[0,1]
 v_pk_fma_f32 v[98:99], v[86:87], v[50:51], v[98:99] op_sel:[1,1,0] op_sel_hi:[1,0,1] neg_lo:[0,1,0]
 v_cvt_pk_bf16_f32 v100, v96, v97
 v_cvt_pk_bf16_f32 v101, v98, v99
 ds_write_b64 v24, v[100:101] offset:544
 v_pk_mul_f32 v[92:93], v[84:85], v[52:53] op_sel:[0,0] op_sel_hi:[0,1]
 v_pk_fma_f32 v[92:93], v[84:85], v[52:53], v[92:93] op_sel:[1,1,0] op_sel_hi:[1,0,1] neg_lo:[0,1,0]
 v_pk_mul_f32 v[94:95], v[86:87], v[54:55] op_sel:[0,0] op_sel_hi:[0,1]
 v_pk_fma_f32 v[94:95], v[86:87], v[54:55], v[94:95] op_sel:[1,1,0] op_sel_hi:[1,0,1] neg_lo:[0,1,0]
 v_cvt_pk_bf16_f32 v102, v92, v93
 v_cvt_pk_bf16_f32 v103, v94, v95
 ds_write_b64 v24, v[102:103] offset:1088
 v_pk_mul_f32 v[96:97], v[84:85], v[56:57] op_sel:[0,0] op_sel_hi:[0,1]
 v_pk_fma_f32 v[96:97], v[84:85], v[56:57], v[96:97] op_sel:[1,1,0] op_sel_hi:[1,0,1] neg_lo:[0,1,0]
 v_pk_mul_f32 v[98:99], v[86:87], v[58:59] op_sel:[0,0] op_sel_hi:[0,1]
 v_pk_fma_f32 v[98:99], v[86:87], v[58:59], v[98:99] op_sel:[1,1,0] op_sel_hi:[1,0,1] neg_lo:[0,1,0]
 v_cvt_pk_bf16_f32 v104, v96, v97
 v_cvt_pk_bf16_f32 v105, v98, v99
 ds_write_b64 v24, v[104:105] offset:1632
 v_pk_mul_f32 v[92:93], v[84:85], v[60:61] op_sel:[0,0] op_sel_hi:[0,1]
 v_pk_fma_f32 v[92:93], v[84:85], v[60:61], v[92:93] op_sel:[1,1,0] op_sel_hi:[1,0,1] neg_lo:[0,1,0]
 v_pk_mul_f32 v[94:95], v[86:87], v[62:63] op_sel:[0,0] op_sel_hi:[0,1]
 v_pk_fma_f32 v[94:95], v[86:87], v[62:63], v[94:95] op_sel:[1,1,0] op_sel_hi:[1,0,1] neg_lo:[0,1,0]
 v_cvt_pk_bf16_f32 v106, v92, v93
 v_cvt_pk_bf16_f32 v107, v94, v95
 ds_write_b64 v24, v[106:107] offset:2176
 v_pk_mul_f32 v[96:97], v[84:85], v[64:65] op_sel:[0,0] op_sel_hi:[0,1]
 v_pk_fma_f32 v[96:97], v[84:85], v[64:65], v[96:97] op_sel:[1,1,0] op_sel_hi:[1,0,1] neg_lo:[0,1,0]
 v_pk_mul_f32 v[98:99], v[86:87], v[66:67] op_sel:[0,0] op_sel_hi:[0,1]
 v_pk_fma_f32 v[98:99], v[86:87], v[66:67], v[98:99] op_sel:[1,1,0] op_sel_hi:[1,0,1] neg_lo:[0,1,0]
 v_cvt_pk_bf16_f32 v100, v96, v97
 v_cvt_pk_bf16_f32 v101, v98, v99
 ds_write_b64 v24, v[100:101] offset:2720
 s_lshr_b32 s92, s2, 3
 s_sub_u32 s92, s92, 26
 s_lshl_b32 s92, s92, 2
 s_add_u32 s92, s92, s68
 s_add_u32 s92, s92, 0
 s_mul_i32 s92, s92, 81920
 s_and_b32 s93, s2, 4
 s_lshl_b32 s93, s93, 5
 s_add_u32 s92, s92, s93
 s_add_u32 s92, s92, 1024
 v_mul_u32_u24 v252, 1280, v1
 s_mov_b32 s96, s16
 s_mov_b32 s97, s17
 s_mov_b32 s98, 2621440
 s_mov_b32 s99, 0x20000
 buffer_load_dword v254, v252, s[96:99], s92 offen
 v_pk_mul_f32 v[92:93], v[84:85], v[68:69] op_sel:[0,0] op_sel_hi:[0,1]
 v_pk_fma_f32 v[92:93], v[84:85], v[68:69], v[92:93] op_sel:[1,1,0] op_sel_hi:[1,0,1] neg_lo:[0,1,0]
 v_pk_mul_f32 v[94:95], v[86:87], v[70:71] op_sel:[0,0] op_sel_hi:[0,1]
 v_pk_fma_f32 v[94:95], v[86:87], v[70:71], v[94:95] op_sel:[1,1,0] op_sel_hi:[1,0,1] neg_lo:[0,1,0]
 v_cvt_pk_bf16_f32 v102, v92, v93
 v_cvt_pk_bf16_f32 v103, v94, v95
 ds_write_b64 v24, v[102:103] offset:3264
 v_pk_mul_f32 v[96:97], v[84:85], v[72:73] op_sel:[0,0] op_sel_hi:[0,1]
 v_pk_fma_f32 v[96:97], v[84:85], v[72:73], v[96:97] op_sel:[1,1,0] op_sel_hi:[1,0,1] neg_lo:[0,1,0]
 v_pk_mul_f32 v[98:99], v[86:87], v[74:75] op_sel:[0,0] op_sel_hi:[0,1]
 v_pk_fma_f32 v[98:99], v[86:87], v[74:75], v[98:99] op_sel:[1,1,0] op_sel_hi:[1,0,1] neg_lo:[0,1,0]
 v_cvt_pk_bf16_f32 v104, v96, v97
 v_cvt_pk_bf16_f32 v105, v98, v99
 ds_write_b64 v24, v[104:105] offset:3808
 v_pk_mul_f32 v[88:89], v[84:85], v[80:81] op_sel:[0,0] op_sel_hi:[0,1]
 v_pk_fma_f32 v[88:89], v[84:85], v[80:81], v[88:89] op_sel:[1,1,0] op_sel_hi:[1,0,1] neg_lo:[0,1,0]
 v_pk_mul_f32 v[90:91], v[86:87], v[82:83] op_sel:[0,0] op_sel_hi:[0,1]
 v_pk_fma_f32 v[90:91], v[86:87], v[82:83], v[90:91] op_sel:[1,1,0] op_sel_hi:[1,0,1] neg_lo:[0,1,0]
 v_cvt_pk_bf16_f32 v106, v88, v89
 v_cvt_pk_bf16_f32 v107, v90, v91
 ds_write_b64 v24, v[106:107] offset:4352
 v_pk_mul_f32 v[96:97], v[88:89], v[48:49] op_sel:[0,0] op_sel_hi:[0,1]
 v_pk_fma_f32 v[96:97], v[88:89], v[48:49], v[96:97] op_sel:[1,1,0] op_sel_hi:[1,0,1] neg_lo:[0,1,0]
 v_pk_mul_f32 v[98:99], v[90:91], v[50:51] op_sel:[0,0] op_sel_hi:[0,1]
 v_pk_fma_f32 v[98:99], v[90:91], v[50:51], v[98:99] op_sel:[1,1,0] op_sel_hi:[1,0,1] neg_lo:[0,1,0]
 v_cvt_pk_bf16_f32 v100, v96, v97
 v_cvt_pk_bf16_f32 v101, v98, v99
 ds_write_b64 v24, v[100:101] offset:4896
 s_waitcnt vmcnt(0)
 buffer_store_dword v253, v38, s[76:79], s6 offen sc1
 buffer_store_dword v253, v38, s[76:79], s7 offen sc1
 s_nop 0
 v_pk_mul_f32 v[92:93], v[88:89], v[52:53] op_sel:[0,0] op_sel_hi:[0,1]
 v_pk_fma_f32 v[92:93], v[88:89], v[52:53], v[92:93] op_sel:[1,1,0] op_sel_hi:[1,0,1] neg_lo:[0,1,0]
 v_pk_mul_f32 v[94:95], v[90:91], v[54:55] op_sel:[0,0] op_sel_hi:[0,1]
 v_pk_fma_f32 v[94:95], v[90:91], v[54:55], v[94:95] op_sel:[1,1,0] op_sel_hi:[1,0,1] neg_lo:[0,1,0]
 v_cvt_pk_bf16_f32 v102, v92, v93
 v_cvt_pk_bf16_f32 v103, v94, v95
 ds_write_b64 v24, v[102:103] offset:5440
 v_pk_mul_f32 v[96:97], v[88:89], v[56:57] op_sel:[0,0] op_sel_hi:[0,1]
 v_pk_fma_f32 v[96:97], v[88:89], v[56:57], v[96:97] op_sel:[1,1,0] op_sel_hi:[1,0,1] neg_lo:[0,1,0]
 v_pk_mul_f32 v[98:99], v[90:91], v[58:59] op_sel:[0,0] op_sel_hi:[0,1]
 v_pk_fma_f32 v[98:99], v[90:91], v[58:59], v[98:99] op_sel:[1,1,0] op_sel_hi:[1,0,1] neg_lo:[0,1,0]
 v_cvt_pk_bf16_f32 v104, v96, v97
 v_cvt_pk_bf16_f32 v105, v98, v99
 ds_write_b64 v24, v[104:105] offset:5984
 s_lshr_b32 s92, s2, 3
 s_sub_u32 s92, s92, 26
 s_lshl_b32 s92, s92, 2
 s_add_u32 s92, s92, s68
 s_add_u32 s92, s92, 24
 s_mul_i32 s92, s92, 81920
 s_and_b32 s93, s2, 4
 s_lshl_b32 s93, s93, 5
 s_add_u32 s92, s92, s93
 s_add_u32 s92, s92, 1024
 v_mul_u32_u24 v252, 1280, v1
 s_mov_b32 s96, s16
 s_mov_b32 s97, s17
 s_mov_b32 s98, 2621440
 s_mov_b32 s99, 0x20000
 buffer_load_dword v254, v252, s[96:99], s92 offen
 v_pk_mul_f32 v[92:93], v[88:89], v[60:61] op_sel:[0,0] op_sel_hi:[0,1]
 v_pk_fma_f32 v[92:93], v[88:89], v[60:61], v[92:93] op_sel:[1,1,0] op_sel_hi:[1,0,1] neg_lo:[0,1,0]
 v_pk_mul_f32 v[94:95], v[90:91], v[62:63] op_sel:[0,0] op_sel_hi:[0,1]
 v_pk_fma_f32 v[94:95], v[90:91], v[62:63], v[94:95] op_sel:[1,1,0] op_sel_hi:[1,0,1] neg_lo:[0,1,0]
 v_cvt_pk_bf16_f32 v106, v92, v93
 v_cvt_pk_bf16_f32 v107, v94, v95
 ds_write_b64 v24, v[106:107] offset:6528
 v_pk_mul_f32 v[96:97], v[88:89], v[64:65] op_sel:[0,0] op_sel_hi:[0,1]
 v_pk_fma_f32 v[96:97], v[88:89], v[64:65], v[96:97] op_sel:[1,1,0] op_sel_hi:[1,0,1] neg_lo:[0,1,0]
 v_pk_mul_f32 v[98:99], v[90:91], v[66:67] op_sel:[0,0] op_sel_hi:[0,1]
 v_pk_fma_f32 v[98:99], v[90:91], v[66:67], v[98:99] op_sel:[1,1,0] op_sel_hi:[1,0,1] neg_lo:[0,1,0]
 v_cvt_pk_bf16_f32 v100, v96, v97
 v_cvt_pk_bf16_f32 v101, v98, v99
 ds_write_b64 v24, v[100:101] offset:7072
 v_pk_mul_f32 v[92:93], v[88:89], v[68:69] op_sel:[0,0] op_sel_hi:[0,1]
 v_pk_fma_f32 v[92:93], v[88:89], v[68:69], v[92:93] op_sel:[1,1,0] op_sel_hi:[1,0,1] neg_lo:[0,1,0]
 v_pk_mul_f32 v[94:95], v[90:91], v[70:71] op_sel:[0,0] op_sel_hi:[0,1]
 v_pk_fma_f32 v[94:95], v[90:91], v[70:71], v[94:95] op_sel:[1,1,0] op_sel_hi:[1,0,1] neg_lo:[0,1,0]
 v_cvt_pk_bf16_f32 v102, v92, v93
 v_cvt_pk_bf16_f32 v103, v94, v95
 ds_write_b64 v24, v[102:103] offset:7616
 v_pk_mul_f32 v[96:97], v[88:89], v[72:73] op_sel:[0,0] op_sel_hi:[0,1]
 v_pk_fma_f32 v[96:97], v[88:89], v[72:73], v[96:97] op_sel:[1,1,0] op_sel_hi:[1,0,1] neg_lo:[0,1,0]
 v_pk_mul_f32 v[98:99], v[90:91], v[74:75] op_sel:[0,0] op_sel_hi:[0,1]
 v_pk_fma_f32 v[98:99], v[90:91], v[74:75], v[98:99] op_sel:[1,1,0] op_sel_hi:[1,0,1] neg_lo:[0,1,0]
 v_cvt_pk_bf16_f32 v104, v96, v97
 v_cvt_pk_bf16_f32 v105, v98, v99
 ds_write_b64 v24, v[104:105] offset:8160
 v_pk_mul_f32 v[84:85], v[88:89], v[80:81] op_sel:[0,0] op_sel_hi:[0,1]
 v_pk_fma_f32 v[84:85], v[88:89], v[80:81], v[84:85] op_sel:[1,1,0] op_sel_hi:[1,0,1] neg_lo:[0,1,0]
 v_pk_mul_f32 v[86:87], v[90:91], v[82:83] op_sel:[0,0] op_sel_hi:[0,1]
 v_pk_fma_f32 v[86:87], v[90:91], v[82:83], v[86:87] op_sel:[1,1,0] op_sel_hi:[1,0,1] neg_lo:[0,1,0]
 ds_read_b128 v[140:143], v25 offset:0
 ds_read_b128 v[144:147], v25 offset:64
 ds_read_b128 v[148:151], v25 offset:128
 ds_read_b128 v[152:155], v25 offset:192
 ds_read_b128 v[156:159], v25 offset:256
 ds_read_b128 v[160:163], v25 offset:320
 ds_read_b128 v[164:167], v25 offset:384
 ds_read_b128 v[168:171], v25 offset:448
 v_cvt_pk_bf16_f32 v106, v84, v85
 v_cvt_pk_bf16_f32 v107, v86, v87
 ds_write_b64 v24, v[106:107] offset:0
 v_pk_mul_f32 v[96:97], v[84:85], v[52:53] op_sel:[0,0] op_sel_hi:[0,1]
 v_pk_fma_f32 v[96:97], v[84:85], v[52:53], v[96:97] op_sel:[1,1,0] op_sel_hi:[1,0,1] neg_lo:[0,1,0]
 v_pk_mul_f32 v[98:99], v[86:87], v[54:55] op_sel:[0,0] op_sel_hi:[0,1]
 v_pk_fma_f32 v[98:99], v[86:87], v[54:55], v[98:99] op_sel:[1,1,0] op_sel_hi:[1,0,1] neg_lo:[0,1,0]
 v_cvt_pk_bf16_f32 v100, v96, v97
 v_cvt_pk_bf16_f32 v101, v98, v99
 ds_write_b64 v24, v[100:101] offset:544
 v_pk_mul_f32 v[92:93], v[84:85], v[60:61] op_sel:[0,0] op_sel_hi:[0,1]
 v_pk_fma_f32 v[92:93], v[84:85], v[60:61], v[92:93] op_sel:[1,1,0] op_sel_hi:[1,0,1] neg_lo:[0,1,0]
 v_pk_mul_f32 v[94:95], v[86:87], v[62:63] op_sel:[0,0] op_sel_hi:[0,1]
 v_pk_fma_f32 v[94:95], v[86:87], v[62:63], v[94:95] op_sel:[1,1,0] op_sel_hi:[1,0,1] neg_lo:[0,1,0]
 v_cvt_pk_bf16_f32 v102, v92, v93
 v_cvt_pk_bf16_f32 v103, v94, v95
 ds_write_b64 v24, v[102:103] offset:1088
 v_pk_mul_f32 v[96:97], v[84:85], v[68:69] op_sel:[0,0] op_sel_hi:[0,1]
 v_pk_fma_f32 v[96:97], v[84:85], v[68:69], v[96:97] op_sel:[1,1,0] op_sel_hi:[1,0,1] neg_lo:[0,1,0]
 v_pk_mul_f32 v[98:99], v[86:87], v[70:71] op_sel:[0,0] op_sel_hi:[0,1]
 v_pk_fma_f32 v[98:99], v[86:87], v[70:71], v[98:99] op_sel:[1,1,0] op_sel_hi:[1,0,1] neg_lo:[0,1,0]
 v_cvt_pk_bf16_f32 v104, v96, v97
 v_cvt_pk_bf16_f32 v105, v98, v99
 ds_write_b64 v24, v[104:105] offset:1632
 v_pk_mul_f32 v[88:89], v[84:85], v[80:81] op_sel:[0,0] op_sel_hi:[0,1]
 v_pk_fma_f32 v[88:89], v[84:85], v[80:81], v[88:89] op_sel:[1,1,0] op_sel_hi:[1,0,1] neg_lo:[0,1,0]
 v_pk_mul_f32 v[90:91], v[86:87], v[82:83] op_sel:[0,0] op_sel_hi:[0,1]
 v_pk_fma_f32 v[90:91], v[86:87], v[82:83], v[90:91] op_sel:[1,1,0] op_sel_hi:[1,0,1] neg_lo:[0,1,0]
 s_waitcnt lgkmcnt(11)
 v_mfma_f32_16x16x32_bf16 v[172:175], v[140:143], v[108:111], 0
 s_waitcnt lgkmcnt(10)
 v_mfma_f32_16x16x32_bf16 v[172:175], v[144:147], v[112:115], v[172:175]
 s_waitcnt lgkmcnt(9)
 v_mfma_f32_16x16x32_bf16 v[172:175], v[148:151], v[116:119], v[172:175]
 s_waitcnt lgkmcnt(8)
 v_mfma_f32_16x16x32_bf16 v[172:175], v[152:155], v[120:123], v[172:175]
 s_waitcnt lgkmcnt(7)
 v_mfma_f32_16x16x32_bf16 v[172:175], v[156:159], v[124:127], v[172:175]
 s_waitcnt lgkmcnt(6)
 v_mfma_f32_16x16x32_bf16 v[172:175], v[160:163], v[128:131], v[172:175]
 s_waitcnt lgkmcnt(5)
 v_mfma_f32_16x16x32_bf16 v[172:175], v[164:167], v[132:135], v[172:175]
 s_waitcnt lgkmcnt(4)
 v_mfma_f32_16x16x32_bf16 v[172:175], v[168:171], v[136:139], v[172:175]
 v_cvt_pk_bf16_f32 v106, v88, v89
 v_cvt_pk_bf16_f32 v107, v90, v91
 ds_write_b64 v24, v[106:107] offset:2176
 v_pk_mul_f32 v[96:97], v[88:89], v[52:53] op_sel:[0,0] op_sel_hi:[0,1]
 v_pk_fma_f32 v[96:97], v[88:89], v[52:53], v[96:97] op_sel:[1,1,0] op_sel_hi:[1,0,1] neg_lo:[0,1,0]
 v_pk_mul_f32 v[98:99], v[90:91], v[54:55] op_sel:[0,0] op_sel_hi:[0,1]
 v_pk_fma_f32 v[98:99], v[90:91], v[54:55], v[98:99] op_sel:[1,1,0] op_sel_hi:[1,0,1] neg_lo:[0,1,0]
 v_cvt_pk_bf16_f32 v100, v96, v97
 v_cvt_pk_bf16_f32 v101, v98, v99
 ds_write_b64 v24, v[100:101] offset:2720
 v_pk_mul_f32 v[92:93], v[88:89], v[60:61] op_sel:[0,0] op_sel_hi:[0,1]
 v_pk_fma_f32 v[92:93], v[88:89], v[60:61], v[92:93] op_sel:[1,1,0] op_sel_hi:[1,0,1] neg_lo:[0,1,0]
 v_pk_mul_f32 v[94:95], v[90:91], v[62:63] op_sel:[0,0] op_sel_hi:[0,1]
 v_pk_fma_f32 v[94:95], v[90:91], v[62:63], v[94:95] op_sel:[1,1,0] op_sel_hi:[1,0,1] neg_lo:[0,1,0]
 v_cvt_pk_bf16_f32 v102, v92, v93
 v_cvt_pk_bf16_f32 v103, v94, v95
 ds_write_b64 v24, v[102:103] offset:3264
 v_pk_mul_f32 v[96:97], v[88:89], v[68:69] op_sel:[0,0] op_sel_hi:[0,1]
 v_pk_fma_f32 v[96:97], v[88:89], v[68:69], v[96:97] op_sel:[1,1,0] op_sel_hi:[1,0,1] neg_lo:[0,1,0]
 v_pk_mul_f32 v[98:99], v[90:91], v[70:71] op_sel:[0,0] op_sel_hi:[0,1]
 v_pk_fma_f32 v[98:99], v[90:91], v[70:71], v[98:99] op_sel:[1,1,0] op_sel_hi:[1,0,1] neg_lo:[0,1,0]
 v_cvt_pk_bf16_f32 v104, v96, v97
 v_cvt_pk_bf16_f32 v105, v98, v99
 ds_write_b64 v24, v[104:105] offset:3808
 v_pk_mul_f32 v[84:85], v[88:89], v[80:81] op_sel:[0,0] op_sel_hi:[0,1]
 v_pk_fma_f32 v[84:85], v[88:89], v[80:81], v[84:85] op_sel:[1,1,0] op_sel_hi:[1,0,1] neg_lo:[0,1,0]
 v_pk_mul_f32 v[86:87], v[90:91], v[82:83] op_sel:[0,0] op_sel_hi:[0,1]
 v_pk_fma_f32 v[86:87], v[90:91], v[82:83], v[86:87] op_sel:[1,1,0] op_sel_hi:[1,0,1] neg_lo:[0,1,0]
 v_cvt_pk_bf16_f32 v106, v84, v85
 v_cvt_pk_bf16_f32 v107, v86, v87
 ds_write_b64 v24, v[106:107] offset:4352
 v_pk_mul_f32 v[96:97], v[84:85], v[60:61] op_sel:[0,0] op_sel_hi:[0,1]
 v_pk_fma_f32 v[96:97], v[84:85], v[60:61], v[96:97] op_sel:[1,1,0] op_sel_hi:[1,0,1] neg_lo:[0,1,0]
 v_pk_mul_f32 v[98:99], v[86:87], v[62:63] op_sel:[0,0] op_sel_hi:[0,1]
 v_pk_fma_f32 v[98:99], v[86:87], v[62:63], v[98:99] op_sel:[1,1,0] op_sel_hi:[1,0,1] neg_lo:[0,1,0]
 v_cvt_pk_bf16_f32 v100, v96, v97
 v_cvt_pk_bf16_f32 v101, v98, v99
 ds_write_b64 v24, v[100:101] offset:4896
 s_lshr_b32 s92, s2, 3
 s_sub_u32 s92, s92, 16
 s_lshl_b32 s92, s92, 2
 s_add_u32 s92, s92, s68
 s_lshl_b32 s92, s92, 6
 v_add_u32 v250, s92, v1
 v_mul_u32_u24 v249, 13108, v250
 v_lshrrev_b32 v249, 16, v249
 v_mul_u32_u24 v252, 5, v249
 v_sub_u32_e64 v250, v250, v252
 v_mul_u32_u24 v252, 3840, v249
 v_lshl_add_u32 v252, v250, 7, v252
 s_and_b32 s93, s2, 1
 s_mul_i32 s94, s93, 640
 s_mov_b32 s96, s10
 s_mov_b32 s97, s11
 s_mov_b32 s98, 2457600
 s_mov_b32 s99, 0x20000
 buffer_load_dword v254, v252, s[96:99], s94 offen
 s_nop 0
 v_pk_mul_f32 v[88:89], v[84:85], v[80:81] op_sel:[0,0] op_sel_hi:[0,1]
 v_pk_fma_f32 v[88:89], v[84:85], v[80:81], v[88:89] op_sel:[1,1,0] op_sel_hi:[1,0,1] neg_lo:[0,1,0]
 v_pk_mul_f32 v[90:91], v[86:87], v[82:83] op_sel:[0,0] op_sel_hi:[0,1]
 v_pk_fma_f32 v[90:91], v[86:87], v[82:83], v[90:91] op_sel:[1,1,0] op_sel_hi:[1,0,1] neg_lo:[0,1,0]
 v_cvt_pk_bf16_f32 v102, v88, v89
 v_cvt_pk_bf16_f32 v103, v90, v91
 ds_write_b64 v24, v[102:103] offset:5440
 v_pk_mul_f32 v[96:97], v[88:89], v[60:61] op_sel:[0,0] op_sel_hi:[0,1]
 v_pk_fma_f32 v[96:97], v[88:89], v[60:61], v[96:97] op_sel:[1,1,0] op_sel_hi:[1,0,1] neg_lo:[0,1,0]
 v_pk_mul_f32 v[98:99], v[90:91], v[62:63] op_sel:[0,0] op_sel_hi:[0,1]
 v_pk_fma_f32 v[98:99], v[90:91], v[62:63], v[98:99] op_sel:[1,1,0] op_sel_hi:[1,0,1] neg_lo:[0,1,0]
 v_cvt_pk_bf16_f32 v104, v96, v97
 v_cvt_pk_bf16_f32 v105, v98, v99
 ds_write_b64 v24, v[104:105] offset:5984
 v_pk_mul_f32 v[84:85], v[88:89], v[80:81] op_sel:[0,0] op_sel_hi:[0,1]
 v_pk_fma_f32 v[84:85], v[88:89], v[80:81], v[84:85] op_sel:[1,1,0] op_sel_hi:[1,0,1] neg_lo:[0,1,0]
 v_pk_mul_f32 v[86:87], v[90:91], v[82:83] op_sel:[0,0] op_sel_hi:[0,1]
 v_pk_fma_f32 v[86:87], v[90:91], v[82:83], v[86:87] op_sel:[1,1,0] op_sel_hi:[1,0,1] neg_lo:[0,1,0]
 v_cvt_pk_bf16_f32 v106, v84, v85
 v_cvt_pk_bf16_f32 v107, v86, v87
 ds_write_b64 v24, v[106:107] offset:6528
 s_lshl_b32 s94, s93, 9
 s_lshl_b32 s95, s93, 7
 s_add_u32 s95, s95, 1024
 v_lshlrev_b32 v252, 7, v250
 v_add_u32 v252, s94, v252
 v_mov_b32 v248, s95
 v_cmp_eq_u32 vcc, 4, v250
 v_mul_u32_u24 v249, 1280, v249
 s_nop 0
 v_cndmask_b32 v252, v252, v248, vcc
 v_add_u32_e64 v252, v252, v249
 s_mov_b32 s96, s14
 s_mov_b32 s97, s15
 s_mov_b32 s98, 819200
 s_mov_b32 s99, 0x20000
 buffer_load_dword v254, v252, s[96:99], 0 offen
 v_pk_mul_f32 v[96:97], v[84:85], v[60:61] op_sel:[0,0] op_sel_hi:[0,1]
 v_pk_fma_f32 v[96:97], v[84:85], v[60:61], v[96:97] op_sel:[1,1,0] op_sel_hi:[1,0,1] neg_lo:[0,1,0]
 v_pk_mul_f32 v[98:99], v[86:87], v[62:63] op_sel:[0,0] op_sel_hi:[0,1]
 v_pk_fma_f32 v[98:99], v[86:87], v[62:63], v[98:99] op_sel:[1,1,0] op_sel_hi:[1,0,1] neg_lo:[0,1,0]
 v_cvt_pk_bf16_f32 v100, v96, v97
 v_cvt_pk_bf16_f32 v101, v98, v99
 ds_write_b64 v24, v[100:101] offset:7072
 v_pk_mul_f32 v[88:89], v[84:85], v[80:81] op_sel:[0,0] op_sel_hi:[0,1]
 v_pk_fma_f32 v[88:89], v[84:85], v[80:81], v[88:89] op_sel:[1,1,0] op_sel_hi:[1,0,1] neg_lo:[0,1,0]
 v_pk_mul_f32 v[90:91], v[86:87], v[82:83] op_sel:[0,0] op_sel_hi:[0,1]
 v_pk_fma_f32 v[90:91], v[86:87], v[82:83], v[90:91] op_sel:[1,1,0] op_sel_hi:[1,0,1] neg_lo:[0,1,0]
 v_cvt_pk_bf16_f32 v102, v88, v89
 v_cvt_pk_bf16_f32 v103, v90, v91
 ds_write_b64 v24, v[102:103] offset:7616
 v_pk_mul_f32 v[96:97], v[88:89], v[60:61] op_sel:[0,0] op_sel_hi:[0,1]
 v_pk_fma_f32 v[96:97], v[88:89], v[60:61], v[96:97] op_sel:[1,1,0] op_sel_hi:[1,0,1] neg_lo:[0,1,0]
 v_pk_mul_f32 v[98:99], v[90:91], v[62:63] op_sel:[0,0] op_sel_hi:[0,1]
 v_pk_fma_f32 v[98:99], v[90:91], v[62:63], v[98:99] op_sel:[1,1,0] op_sel_hi:[1,0,1] neg_lo:[0,1,0]
 v_cvt_pk_bf16_f32 v104, v96, v97
 v_cvt_pk_bf16_f32 v105, v98, v99
 ds_write_b64 v24, v[104:105] offset:8160
 v_pk_mul_f32 v[84:85], v[88:89], v[80:81] op_sel:[0,0] op_sel_hi:[0,1]
 v_pk_fma_f32 v[84:85], v[88:89], v[80:81], v[84:85] op_sel:[1,1,0] op_sel_hi:[1,0,1] neg_lo:[0,1,0]
 v_pk_mul_f32 v[86:87], v[90:91], v[82:83] op_sel:[0,0] op_sel_hi:[0,1]
 v_pk_fma_f32 v[86:87], v[90:91], v[82:83], v[86:87] op_sel:[1,1,0] op_sel_hi:[1,0,1] neg_lo:[0,1,0]
 ds_read_b128 v[140:143], v25 offset:0
 ds_read_b128 v[144:147], v25 offset:64
 ds_read_b128 v[148:151], v25 offset:128
 ds_read_b128 v[152:155], v25 offset:192
 ds_read_b128 v[156:159], v25 offset:256
 ds_read_b128 v[160:163], v25 offset:320
 ds_read_b128 v[164:167], v25 offset:384
 ds_read_b128 v[168:171], v25 offset:448
 v_cvt_pk_bf16_f32 v106, v84, v85
 v_cvt_pk_bf16_f32 v107, v86, v87
 ds_write_b64 v24, v[106:107] offset:0
 v_pk_mul_f32 v[88:89], v[84:85], v[80:81] op_sel:[0,0] op_sel_hi:[0,1]
 v_pk_fma_f32 v[88:89], v[84:85], v[80:81], v[88:89] op_sel:[1,1,0] op_sel_hi:[1,0,1] neg_lo:[0,1,0]
 v_pk_mul_f32 v[90:91], v[86:87], v[82:83] op_sel:[0,0] op_sel_hi:[0,1]
 v_pk_fma_f32 v[90:91], v[86:87], v[82:83], v[90:91] op_sel:[1,1,0] op_sel_hi:[1,0,1] neg_lo:[0,1,0]
 v_cvt_pk_bf16_f32 v100, v88, v89
 v_cvt_pk_bf16_f32 v101, v90, v91
 ds_write_b64 v24, v[100:101] offset:544
 v_pk_mul_f32 v[84:85], v[88:89], v[80:81] op_sel:[0,0] op_sel_hi:[0,1]
 v_pk_fma_f32 v[84:85], v[88:89], v[80:81], v[84:85] op_sel:[1,1,0] op_sel_hi:[1,0,1] neg_lo:[0,1,0]
 v_pk_mul_f32 v[86:87], v[90:91], v[82:83] op_sel:[0,0] op_sel_hi:[0,1]
 v_pk_fma_f32 v[86:87], v[90:91], v[82:83], v[86:87] op_sel:[1,1,0] op_sel_hi:[1,0,1] neg_lo:[0,1,0]
 v_cvt_pk_bf16_f32 v102, v84, v85
 v_cvt_pk_bf16_f32 v103, v86, v87
 ds_write_b64 v24, v[102:103] offset:1088
 v_pk_mul_f32 v[88:89], v[84:85], v[80:81] op_sel:[0,0] op_sel_hi:[0,1]
 v_pk_fma_f32 v[88:89], v[84:85], v[80:81], v[88:89] op_sel:[1,1,0] op_sel_hi:[1,0,1] neg_lo:[0,1,0]
 v_pk_mul_f32 v[90:91], v[86:87], v[82:83] op_sel:[0,0] op_sel_hi:[0,1]
 v_pk_fma_f32 v[90:91], v[86:87], v[82:83], v[90:91] op_sel:[1,1,0] op_sel_hi:[1,0,1] neg_lo:[0,1,0]
 v_cvt_pk_bf16_f32 v104, v88, v89
 v_cvt_pk_bf16_f32 v105, v90, v91
 ds_write_b64 v24, v[104:105] offset:1632
 v_pk_mul_f32 v[84:85], v[88:89], v[80:81] op_sel:[0,0] op_sel_hi:[0,1]
 v_pk_fma_f32 v[84:85], v[88:89], v[80:81], v[84:85] op_sel:[1,1,0] op_sel_hi:[1,0,1] neg_lo:[0,1,0]
 v_pk_mul_f32 v[86:87], v[90:91], v[82:83] op_sel:[0,0] op_sel_hi:[0,1]
 v_pk_fma_f32 v[86:87], v[90:91], v[82:83], v[86:87] op_sel:[1,1,0] op_sel_hi:[1,0,1] neg_lo:[0,1,0]
 s_waitcnt lgkmcnt(11)
 v_mfma_f32_16x16x32_bf16 v[176:179], v[140:143], v[108:111], 0
 s_waitcnt lgkmcnt(10)
 v_mfma_f32_16x16x32_bf16 v[176:179], v[144:147], v[112:115], v[176:179]
 s_waitcnt lgkmcnt(9)
 v_mfma_f32_16x16x32_bf16 v[176:179], v[148:151], v[116:119], v[176:179]
 s_waitcnt lgkmcnt(8)
 v_mfma_f32_16x16x32_bf16 v[176:179], v[152:155], v[120:123], v[176:179]
 s_waitcnt lgkmcnt(7)
 v_mfma_f32_16x16x32_bf16 v[176:179], v[156:159], v[124:127], v[176:179]
 s_waitcnt lgkmcnt(6)
 v_mfma_f32_16x16x32_bf16 v[176:179], v[160:163], v[128:131], v[176:179]
 s_waitcnt lgkmcnt(5)
 v_mfma_f32_16x16x32_bf16 v[176:179], v[164:167], v[132:135], v[176:179]
 s_waitcnt lgkmcnt(4)
 v_mfma_f32_16x16x32_bf16 v[176:179], v[168:171], v[136:139], v[176:179]
 v_cvt_pk_bf16_f32 v106, v84, v85
 v_cvt_pk_bf16_f32 v107, v86, v87
 ds_write_b64 v24, v[106:107] offset:2176
 v_pk_mul_f32 v[88:89], v[84:85], v[80:81] op_sel:[0,0] op_sel_hi:[0,1]
 v_pk_fma_f32 v[88:89], v[84:85], v[80:81], v[88:89] op_sel:[1,1,0] op_sel_hi:[1,0,1] neg_lo:[0,1,0]
 v_pk_mul_f32 v[90:91], v[86:87], v[82:83] op_sel:[0,0] op_sel_hi:[0,1]
 v_pk_fma_f32 v[90:91], v[86:87], v[82:83], v[90:91] op_sel:[1,1,0] op_sel_hi:[1,0,1] neg_lo:[0,1,0]
 v_cvt_pk_bf16_f32 v100, v88, v89
 v_cvt_pk_bf16_f32 v101, v90, v91
 ds_write_b64 v24, v[100:101] offset:2720
 v_pk_mul_f32 v[84:85], v[88:89], v[80:81] op_sel:[0,0] op_sel_hi:[0,1]
 v_pk_fma_f32 v[84:85], v[88:89], v[80:81], v[84:85] op_sel:[1,1,0] op_sel_hi:[1,0,1] neg_lo:[0,1,0]
 v_pk_mul_f32 v[86:87], v[90:91], v[82:83] op_sel:[0,0] op_sel_hi:[0,1]
 v_pk_fma_f32 v[86:87], v[90:91], v[82:83], v[86:87] op_sel:[1,1,0] op_sel_hi:[1,0,1] neg_lo:[0,1,0]
 v_cvt_pk_bf16_f32 v102, v84, v85
 v_cvt_pk_bf16_f32 v103, v86, v87
 ds_write_b64 v24, v[102:103] offset:3264
 v_pk_mul_f32 v[88:89], v[84:85], v[80:81] op_sel:[0,0] op_sel_hi:[0,1]
 v_pk_fma_f32 v[88:89], v[84:85], v[80:81], v[88:89] op_sel:[1,1,0] op_sel_hi:[1,0,1] neg_lo:[0,1,0]
 v_pk_mul_f32 v[90:91], v[86:87], v[82:83] op_sel:[0,0] op_sel_hi:[0,1]
 v_pk_fma_f32 v[90:91], v[86:87], v[82:83], v[90:91] op_sel:[1,1,0] op_sel_hi:[1,0,1] neg_lo:[0,1,0]
 v_cvt_pk_bf16_f32 v104, v88, v89
 v_cvt_pk_bf16_f32 v105, v90, v91
 ds_write_b64 v24, v[104:105] offset:3808
 v_pk_mul_f32 v[84:85], v[88:89], v[80:81] op_sel:[0,0] op_sel_hi:[0,1]
 v_pk_fma_f32 v[84:85], v[88:89], v[80:81], v[84:85] op_sel:[1,1,0] op_sel_hi:[1,0,1] neg_lo:[0,1,0]
 v_pk_mul_f32 v[86:87], v[90:91], v[82:83] op_sel:[0,0] op_sel_hi:[0,1]
 v_pk_fma_f32 v[86:87], v[90:91], v[82:83], v[86:87] op_sel:[1,1,0] op_sel_hi:[1,0,1] neg_lo:[0,1,0]
 v_cvt_pk_bf16_f32 v106, v84, v85
 v_cvt_pk_bf16_f32 v107, v86, v87
 ds_write_b64 v24, v[106:107] offset:4352
 ds_read_b128 v[140:143], v25 offset:0
 ds_read_b128 v[144:147], v25 offset:64
 ds_read_b128 v[148:151], v25 offset:128
 ds_read_b128 v[152:155], v25 offset:192
 ds_read_b128 v[156:159], v25 offset:256
 ds_read_b128 v[160:163], v25 offset:320
 ds_read_b128 v[164:167], v25 offset:384
 ds_read_b128 v[168:171], v25 offset:448
 v_cmp_eq_u32 vcc, 0, v1
 v_lshlrev_b32 v40, 16, v13
 s_nop 0
 v_cndmask_b32 v40, v4, v40, vcc
 v_add_f32_e64 v172, v172, v40
 v_cvt_pk_bf16_f32 v172, v172, v172
 v_cvt_pk_bf16_f32 v173, v173, v173
 v_cvt_pk_bf16_f32 v174, v174, v174
 v_cvt_pk_bf16_f32 v175, v175, v175
 v_cvt_pk_bf16_f32 v176, v176, v176
 v_cvt_pk_bf16_f32 v177, v177, v177
 v_cvt_pk_bf16_f32 v178, v178, v178
 v_cvt_pk_bf16_f32 v179, v179, v179
 s_waitcnt lgkmcnt(0)
 v_mfma_f32_16x16x32_bf16 v[180:183], v[140:143], v[108:111], 0
 ds_write_b128 v26, v[172:175]
 v_mfma_f32_16x16x32_bf16 v[180:183], v[144:147], v[112:115], v[180:183]
 v_mfma_f32_16x16x32_bf16 v[180:183], v[148:151], v[116:119], v[180:183]
 v_mfma_f32_16x16x32_bf16 v[180:183], v[152:155], v[120:123], v[180:183]
 ds_write_b64 v27, v[176:177] offset:1024
 v_mfma_f32_16x16x32_bf16 v[180:183], v[156:159], v[124:127], v[180:183]
 v_mfma_f32_16x16x32_bf16 v[180:183], v[160:163], v[128:131], v[180:183]
 ds_write_b64 v28, v[178:179] offset:1024
 v_mfma_f32_16x16x32_bf16 v[180:183], v[164:167], v[132:135], v[180:183]
 v_mfma_f32_16x16x32_bf16 v[180:183], v[168:171], v[136:139], v[180:183]
 ds_read_b128 v[132:135], v33
 ds_read_b128 v[136:139], v33 offset:16
 ds_read_b128 v[124:127], v32 offset:1024
 ds_read_b32 v128, v32 offset:1040
 s_nop 3
 v_cvt_pk_bf16_f32 v180, v180, v180
 v_cvt_pk_bf16_f32 v181, v181, v181
 v_cvt_pk_bf16_f32 v182, v182, v182
 v_cvt_pk_bf16_f32 v183, v183, v183
 ds_write_b32 v29, v180 offset:2048
 ds_write_b32 v29, v181 offset:2112
 ds_write_b32 v29, v182 offset:2176
 ds_write_b32 v29, v183 offset:2240
 ds_read_b32 v116, v31 offset:1544
 ds_read_b32 v117, v31 offset:1540
 ds_read_b32 v119, v31 offset:1536
 ds_read_b32 v108, v30 offset:2052
 ds_read_b32 v110, v30 offset:2048
 ds_read_b32 v111, v30 offset:2048
 ds_read_b32 v112, v30 offset:2308
 ds_read_b32 v114, v30 offset:2304
 ds_read_b32 v115, v30 offset:2304
 s_waitcnt lgkmcnt(13)
 v_bfi_b32 v120, s85, v128, v127
 v_mov_b32 v121, v126
 v_bfi_b32 v122, s85, v126, v125
 v_mov_b32_e64 v123, v124
 ds_write_b128 v35, v[120:123] offset:3072
 v_bfi_b32 v124, s85, v139, v138
 v_bfi_b32 v125, s85, v137, v136
 v_bfi_b32 v126, s85, v135, v134
 v_bfi_b32 v127, s85, v133, v132
 ds_write_b128 v35, v[124:127] offset:3584
 s_waitcnt lgkmcnt(8)
 v_bfi_b32 v118, s85, v117, v119
 ds_write_b128 v34, v[116:119] offset:2048
 s_waitcnt lgkmcnt(7)
 v_bfi_b32 v109, v37, v108, v110
 s_waitcnt lgkmcnt(6)
 ds_write_b128 v34, v[108:111] offset:1024
 s_waitcnt lgkmcnt(5)
 v_bfi_b32 v113, v37, v112, v114
 s_waitcnt lgkmcnt(4)
 ds_write_b128 v34, v[112:115] offset:0
 ds_read_b128 v[48:51], v185 offset:0
 ds_read_b128 v[52:55], v185 offset:1024
 ds_read_b128 v[56:59], v185 offset:2048
 ds_read_b128 v[60:63], v185 offset:3072
 s_lshl_b32 s91, s90, 12
 s_add_u32 s91, s91, 4194304
 s_waitcnt lgkmcnt(3)
 buffer_store_dwordx4 v[48:51], v184, s[76:79], s91 offen offset:0 sc1
 s_waitcnt lgkmcnt(2)
 buffer_store_dwordx4 v[52:55], v184, s[76:79], s91 offen offset:1024 sc1
 s_waitcnt lgkmcnt(1)
 buffer_store_dwordx4 v[56:59], v184, s[76:79], s91 offen offset:2048 sc1
 s_waitcnt lgkmcnt(0)
 buffer_store_dwordx4 v[60:63], v184, s[76:79], s91 offen offset:3072 sc1
 s_lshl_b32 s6, s90, 7
 s_add_u32 s6, s6, 196608
 s_mov_b32 s7, s6
 s_add_u32 s90, s90, 192
 v_mov_b32 v8, v14
 v_mov_b32 v9, v15
 v_mov_b32 v10, v16
 v_mov_b32 v11, v17
 v_mov_b32 v12, v18
 v_mov_b32 v13, v19
 s_cmp_lt_u32 s90, 320
 s_cbranch_scc1 s_kloop
 s_waitcnt vmcnt(0)
 buffer_store_dword v253, v38, s[76:79], s6 offen sc1
 s_cmp_ge_u32 s2, 240
 s_cbranch_scc1 s_done
 s_mov_b32 s60, s32
 s_mov_b32 s61, s33
 s_mov_b32 s62, 256
 s_mov_b32 s63, 0x20000
 s_and_b32 s72, s2, 7
 s_lshr_b32 s69, s72, 1
 s_lshl_b32 s69, s69, 2
 s_lshr_b32 s73, s2, 3
 s_sub_u32 s73, s73, 26
 s_add_u32 s69, s69, s73
 s_and_b32 s83, s72, 1
 s_add_u32 s83, s83, 8
 s_lshl_b32 s83, s83, 7
 s_mul_i32 s84, s68, 5120
 v_and_b32 v23, 63, v0
 v_mov_b32 v22, 0
 s_mov_b32 s48, s14
 s_mov_b32 s49, s15
 s_mov_b32 s50, 819200
 s_mov_b32 s51, 0x20000
 s_mov_b32 s52, s34
 s_mov_b32 s53, s35
 s_mov_b32 s54, 13631488
 s_mov_b32 s55, 0x20000
 s_mul_i32 s78, s69, 327680
 s_add_u32 s78, s78, s83
 s_add_u32 s56, s30, s78
 s_addc_u32 s57, s31, 0
 s_mov_b32 s58, 0
 s_mov_b32 s59, 0x20000
 s_sub_u32 s58, 5242880, s78
 s_lshr_b32 s100, s83, 7
 s_and_b32 s79, s100, 3
 s_cmp_ge_u32 s100, 8
 s_cselect_b32 s100, 4, s79
 s_mul_i32 s100, s100, 0
 s_lshr_b32 s100, s100, 3
 s_lshr_b32 s79, s68, 1
 s_add_u32 s79, s79, s100
 s_and_b32 s85, s68, 1
 s_mul_i32 s85, s85, 40
 s_lshl_b32 s78, s69, 2
 s_add_u32 s78, s78, s68
 s_mul_i32 s78, s78, 40960
 s_add_u32 s92, s78, 393216
 v_lshrrev_b32 v24, 3, v23
 v_add_u32 v24, s85, v24
 v_add_u32 v24, 0, v24
 v_lshrrev_b32 v25, 4, v24
 v_and_b32_e64 v26, 7, v24
 v_lshl_add_u32 v25, v25, 3, v26
 v_bfe_u32 v26, v24, 3, 1
 v_mad_u32_u24 v26, v26, 20, v25
 v_add_u32 v27, 20, v26
 v_cmp_le_u32 vcc, 20, v25
 s_nop 1
 v_cndmask_b32 v26, v26, v27, vcc
 v_mul_u32_u24 v26, 1280, v26
 v_bfe_u32 v24, v24, 1, 1
 v_lshlrev_b32 v24, 2, v24
 v_and_b32 v25, 7, v0
 v_xor_b32_e64 v24, v24, v25
 v_lshl_add_u32 v24, v24, 4, v26
 v_accvgpr_write_b32 a225, v24
 v_lshrrev_b32 v24, 3, v23
 v_add_u32 v24, s85, v24
 v_add_u32 v24, 8, v24
 v_lshrrev_b32 v25, 4, v24
 v_and_b32_e64 v26, 7, v24
 v_lshl_add_u32 v25, v25, 3, v26
 v_bfe_u32 v26, v24, 3, 1
 v_mad_u32_u24 v26, v26, 20, v25
 v_add_u32 v27, 20, v26
 v_cmp_le_u32 vcc, 20, v25
 s_nop 1
 v_cndmask_b32 v26, v26, v27, vcc
 v_mul_u32_u24 v26, 1280, v26
 v_bfe_u32 v24, v24, 1, 1
 v_lshlrev_b32 v24, 2, v24
 v_and_b32 v25, 7, v0
 v_xor_b32_e64 v24, v24, v25
 v_lshl_add_u32 v24, v24, 4, v26
 v_accvgpr_write_b32 a226, v24
 v_lshrrev_b32 v24, 3, v23
 v_add_u32 v24, s85, v24
 v_add_u32 v24, 16, v24
 v_lshrrev_b32 v25, 4, v24
 v_and_b32_e64 v26, 7, v24
 v_lshl_add_u32 v25, v25, 3, v26
 v_bfe_u32 v26, v24, 3, 1
 v_mad_u32_u24 v26, v26, 20, v25
 v_add_u32 v27, 20, v26
 v_cmp_le_u32 vcc, 20, v25
 s_nop 1
 v_cndmask_b32 v26, v26, v27, vcc
 v_mul_u32_u24 v26, 1280, v26
 v_bfe_u32 v24, v24, 1, 1
 v_lshlrev_b32 v24, 2, v24
 v_and_b32 v25, 7, v0
 v_xor_b32_e64 v24, v24, v25
 v_lshl_add_u32 v24, v24, 4, v26
 v_accvgpr_write_b32 a227, v24
 v_lshrrev_b32 v24, 3, v23
 v_add_u32 v24, s85, v24
 v_add_u32 v24, 24, v24
 v_lshrrev_b32 v25, 4, v24
 v_and_b32_e64 v26, 7, v24
 v_lshl_add_u32 v25, v25, 3, v26
 v_bfe_u32 v26, v24, 3, 1
 v_mad_u32_u24 v26, v26, 20, v25
 v_add_u32 v27, 20, v26
 v_cmp_le_u32 vcc, 20, v25
 s_nop 1
 v_cndmask_b32 v26, v26, v27, vcc
 v_mul_u32_u24 v26, 1280, v26
 v_bfe_u32 v24, v24, 1, 1
 v_lshlrev_b32 v24, 2, v24
 v_and_b32 v25, 7, v0
 v_xor_b32_e64 v24, v24, v25
 v_lshl_add_u32 v24, v24, 4, v26
 v_accvgpr_write_b32 a228, v24
 v_lshrrev_b32 v24, 3, v23
 v_add_u32 v24, s85, v24
 v_add_u32 v24, 32, v24
 v_lshrrev_b32 v25, 4, v24
 v_and_b32_e64 v26, 7, v24
 v_lshl_add_u32 v25, v25, 3, v26
 v_bfe_u32 v26, v24, 3, 1
 v_mad_u32_u24 v26, v26, 20, v25
 v_add_u32 v27, 20, v26
 v_cmp_le_u32 vcc, 20, v25
 s_nop 1
 v_cndmask_b32 v26, v26, v27, vcc
 v_mul_u32_u24 v26, 1280, v26
 v_bfe_u32 v24, v24, 1, 1
 v_lshlrev_b32 v24, 2, v24
 v_and_b32 v25, 7, v0
 v_xor_b32_e64 v24, v24, v25
 v_lshl_add_u32 v24, v24, 4, v26
 v_accvgpr_write_b32 a229, v24
 v_bfe_u32 v24, v0, 5, 1
 v_mul_u32_u24 v24, 1024, v24
 v_bfe_u32 v25, v0, 2, 2
 v_mul_u32_u24 v25, 128, v25
 v_bfe_u32 v26, v0, 4, 1
 v_lshl_add_u32 v24, v26, 5, v24
 v_and_b32_e64 v26, 3, v0
 v_lshl_add_u32 v24, v26, 3, v24
 v_add_u32_e64 v27, v24, v25
 v_bfe_u32 v24, v0, 3, 1
 v_lshl_add_u32 v27, v24, 6, v27
 v_accvgpr_write_b32 a230, v27
 s_add_u32 s78, s84, 126976
 v_and_b32_e64 v24, 31, v0
 v_mul_u32_u24 v24, 144, v24
 v_bfe_u32 v25, v0, 5, 1
 v_lshl_add_u32 v24, v25, 3, v24
 v_add_u32_e64 v24, s78, v24
 v_accvgpr_write_b32 a231, v24
 v_lshrrev_b32 v24, 3, v23
 v_and_b32 v25, 7, v0
 v_lshlrev_b32_e64 v25, 4, v25
 v_mul_u32_u24 v26, 144, v24
 v_add3_u32 v26, v26, v25, s78
 v_mul_u32_u24 v24, 2560, v24
 v_add_u32_e64 v24, v24, v25
 v_accvgpr_write_b32 a232, v26
 v_accvgpr_write_b32 a233, v24
 v_accvgpr_read_b32 v1, a225
 v_accvgpr_read_b32 v2, a226
 v_accvgpr_read_b32 v3, a227
 v_accvgpr_read_b32 v4, a228
 v_accvgpr_read_b32 v5, a229
 s_add_u32 s86, s79, 6
 s_and_b32 s86, s86, 7
 s_mul_i32 s86, s86, 102400
 s_add_u32 s86, s86, s83
 s_add_u32 m0, s84, 61440
 s_nop 0
 buffer_load_dwordx4 v1, s[48:51], s86 offen  lds
 s_add_u32 m0, s84, 62464
 s_nop 0
 buffer_load_dwordx4 v2, s[48:51], s86 offen  lds
 s_add_u32 m0, s84, 63488
 s_nop 0
 buffer_load_dwordx4 v3, s[48:51], s86 offen  lds
 s_add_u32 m0, s84, 64512
 s_nop 0
 buffer_load_dwordx4 v4, s[48:51], s86 offen  lds
 s_add_u32 m0, s84, 65536
 s_nop 0
 buffer_load_dwordx4 v5, s[48:51], s86 offen  lds
 s_add_u32 s86, s79, 0
 s_and_b32 s86, s86, 7
 s_mul_i32 s86, s86, 102400
 s_add_u32 s86, s86, s83
 s_add_u32 m0, s84, 0
 s_nop 0
 buffer_load_dwordx4 v1, s[48:51], s86 offen  lds
 s_add_u32 m0, s84, 1024
 s_nop 0
 buffer_load_dwordx4 v2, s[48:51], s86 offen  lds
 s_add_u32 m0, s84, 2048
 s_nop 0
 buffer_load_dwordx4 v3, s[48:51], s86 offen  lds
 s_add_u32 m0, s84, 3072
 s_nop 0
 buffer_load_dwordx4 v4, s[48:51], s86 offen  lds
 s_add_u32 m0, s84, 4096
 s_nop 0
 buffer_load_dwordx4 v5, s[48:51], s86 offen  lds
 s_add_u32 s86, s79, 2
 s_and_b32 s86, s86, 7
 s_mul_i32 s86, s86, 102400
 s_add_u32 s86, s86, s83
 s_add_u32 m0, s84, 20480
 s_nop 0
 buffer_load_dwordx4 v1, s[48:51], s86 offen  lds
 s_add_u32 m0, s84, 21504
 s_nop 0
 buffer_load_dwordx4 v2, s[48:51], s86 offen  lds
 s_add_u32 m0, s84, 22528
 s_nop 0
 buffer_load_dwordx4 v3, s[48:51], s86 offen  lds
 s_add_u32 m0, s84, 23552
 s_nop 0
 buffer_load_dwordx4 v4, s[48:51], s86 offen  lds
 s_add_u32 m0, s84, 24576
 s_nop 0
 buffer_load_dwordx4 v5, s[48:51], s86 offen  lds
 s_add_u32 s86, s79, 4
 s_and_b32 s86, s86, 7
 s_mul_i32 s86, s86, 102400
 s_add_u32 s86, s86, s83
 s_add_u32 m0, s84, 40960
 s_nop 0
 buffer_load_dwordx4 v1, s[48:51], s86 offen  lds
 s_add_u32 m0, s84, 41984
 s_nop 0
 buffer_load_dwordx4 v2, s[48:51], s86 offen  lds
 s_add_u32 m0, s84, 43008
 s_nop 0
 buffer_load_dwordx4 v3, s[48:51], s86 offen  lds
 s_add_u32 m0, s84, 44032
 s_nop 0
 buffer_load_dwordx4 v4, s[48:51], s86 offen  lds
 s_add_u32 m0, s84, 45056
 s_nop 0
 buffer_load_dwordx4 v5, s[48:51], s86 offen  lds
 v_and_b32 v249, 7, v0
 v_lshlrev_b32 v249, 13, v249
 s_lshl_b32 s85, s69, 9
 s_lshl_b32 s81, s68, 7
 s_add_u32 s85, s85, s81
 s_add_u32 s85, s85, 131072
 s_mov_b32 s94, 400000
s_pf:
 buffer_load_dword v248, v249, s[52:55], s85 offen sc1
 s_sub_u32 s94, s94, 1
 s_waitcnt vmcnt(0)
 v_cmp_eq_u32 vcc, v253, v248
 s_cmp_eq_u32 s94, 0
 s_cbranch_scc1 s_pf_x
 s_cmp_eq_u64 vcc, -1
 s_cbranch_scc1 s_pf_x
 s_sleep 8
 s_branch s_pf
s_pf_x:
 s_branch g2_tail
s_done:
 s_cmp_lg_u32 s2, 255
 s_cbranch_scc1 s_fin
 s_cmp_lg_u32 s68, 0
 s_cbranch_scc1 s_fin
 v_add_u32 v187, 0, v1
 v_min_u32 v187, 47, v187
 v_lshlrev_b32 v187, 9, v187
 s_mov_b32 s91, 196608
 s_mov_b32 s94, 400000
s_ep0:
 buffer_load_dword v186, v187, s[76:79], s91 offen sc1
 s_sub_u32 s94, s94, 1
 s_waitcnt vmcnt(0)
 v_cmp_eq_u32 vcc, v253, v186
 s_cmp_eq_u32 s94, 0
 s_cbranch_scc1 s_ep0_x
 s_cmp_eq_u64 vcc, -1
 s_cbranch_scc1 s_ep0_x
 s_sleep 16
 s_branch s_ep0
s_ep0_x:
 v_add_u32 v187, 0, v1
 v_min_u32 v187, 79, v187
 v_lshlrev_b32_e64 v187, 9, v187
 s_mov_b32 s91, 278528
 s_mov_b32 s94, 400000
s_ep1:
 buffer_load_dword v186, v187, s[76:79], s91 offen sc1
 s_sub_u32 s94, s94, 1
 s_waitcnt vmcnt(0)
 v_cmp_eq_u32 vcc, v253, v186
 s_cmp_eq_u32 s94, 0
 s_cbranch_scc1 s_ep1_x
 s_cmp_eq_u64 vcc, -1
 s_cbranch_scc1 s_ep1_x
 s_sleep 16
 s_branch s_ep1
s_ep1_x:
 v_add_u32 v187, 64, v1
 v_min_u32 v187, 79, v187
 v_lshlrev_b32_e64 v187, 9, v187
 s_mov_b32 s91, 278528
 s_mov_b32 s94, 400000
s_ep2:
 buffer_load_dword v186, v187, s[76:79], s91 offen sc1
 s_sub_u32 s94, s94, 1
 s_waitcnt vmcnt(0)
 v_cmp_eq_u32 vcc, v253, v186
 s_cmp_eq_u32 s94, 0
 s_cbranch_scc1 s_ep2_x
 s_cmp_eq_u64 vcc, -1
 s_cbranch_scc1 s_ep2_x
 s_sleep 16
 s_branch s_ep2
s_ep2_x:
 v_add_u32 v187, 0, v1
 v_min_u32 v187, 127, v187
 v_lshlrev_b32_e64 v187, 9, v187
 s_mov_b32 s91, 131072
 s_mov_b32 s94, 400000
s_ep3:
 buffer_load_dword v186, v187, s[76:79], s91 offen sc1
 s_sub_u32 s94, s94, 1
 s_waitcnt vmcnt(0)
 v_cmp_eq_u32 vcc, v253, v186
 s_cmp_eq_u32 s94, 0
 s_cbranch_scc1 s_ep3_x
 s_cmp_eq_u64 vcc, -1
 s_cbranch_scc1 s_ep3_x
 s_sleep 16
 s_branch s_ep3
s_ep3_x:
 v_add_u32 v187, 64, v1
 v_min_u32 v187, 127, v187
 v_lshlrev_b32_e64 v187, 9, v187
 s_mov_b32 s91, 131072
 s_mov_b32 s94, 400000
s_ep4:
 buffer_load_dword v186, v187, s[76:79], s91 offen sc1
 s_sub_u32 s94, s94, 1
 s_waitcnt vmcnt(0)
 v_cmp_eq_u32 vcc, v253, v186
 s_cmp_eq_u32 s94, 0
 s_cbranch_scc1 s_ep4_x
 s_cmp_eq_u64 vcc, -1
 s_cbranch_scc1 s_ep4_x
 s_sleep 16
 s_branch s_ep4
s_ep4_x:
 s_mov_b32 s4, 385024
 buffer_store_dword v253, v38, s[76:79], s4 offen sc1
s_fin:
done:
 s_endpgm
code_end:
.section .rodata,"a"
.p2align 6
.amdhsa_kernel concat_heads__linear_kernel_hedgehog__ssm_conv_s4d__prompt_kernel
  .amdhsa_next_free_vgpr 512
  .amdhsa_next_free_sgpr 102
  .amdhsa_accum_offset 256
  .amdhsa_group_segment_fixed_size 0
  .amdhsa_kernarg_size 112
  .amdhsa_user_sgpr_count 2
  .amdhsa_user_sgpr_kernarg_segment_ptr 1
  .amdhsa_system_sgpr_workgroup_id_x 1
.end_amdhsa_kernel
```
